```python
import torch

def _softmax(x, axis=-1):
    return torch.softmax(x, dim=axis)

def _gelu(x):
    return torch.nn.functional.gelu(x, approximate='tanh')

def _silu(x):
    return torch.nn.functional.silu(x)

def _sigmoid(x):
    return torch.sigmoid(x)

def _layernorm(x, axis=-1, eps=1e-05):
    m = x.mean(dim=axis, keepdim=True)
    v = x.var(dim=axis, keepdim=True, unbiased=False)
    return (x - m) / torch.sqrt(v + eps)

def _scatter_add(tgt, idx, src, axis=0):
    return tgt.clone().index_add_(axis, idx, src)

def _segment_sum(src, seg, n):
    out = torch.zeros((n,) + src.shape[1:], dtype=src.dtype)
    return out.index_add_(0, seg, src)

def _pad(x, pw):
    flat = tuple((v for pair in reversed(pw) for v in pair))
    return torch.nn.functional.pad(x, flat)
kernel_name = 'recurrent_scan__memory_aug_recurrent_mem_tr__glu_gated_bilinear__prompt'

def setup_inputs():

    _w = lambda a: (lambda t: t.to(torch.bfloat16) if t.is_floating_point() else t)(torch.as_tensor(a))

    def _A_setup():
        B, S, Dm = (1, 2048, 512)
        H, Dh = (32, 128)
        M, seg = (8, 32)
        seg = min(seg, S)
        S = S // seg * seg
        return {'x': _w((lambda *s: torch.randn(*s, dtype=torch.bfloat16) * 0.1)(B, S, Dm)), 'mem0': _w((lambda *s: torch.randn(*s, dtype=torch.bfloat16) * 1.6)(B, M, Dm)), 'Wq': _w((lambda *s: torch.randn(*s, dtype=torch.bfloat16) * 0.8)(Dm, H, Dh) * Dm ** (-0.5)), 'Wk': _w((lambda *s: torch.randn(*s, dtype=torch.bfloat16) * 0.8)(Dm, H, Dh) * Dm ** (-0.5)), 'Wv': _w((lambda *s: torch.randn(*s, dtype=torch.bfloat16) * 1.6)(Dm, H, Dh) * Dm ** (-0.5)), 'Wo': _w((lambda *s: torch.randn(*s, dtype=torch.bfloat16) * 1.6)(H, Dh, Dm) * (H * Dh) ** (-0.5)), 'seg_len': seg}
    _A_in = _A_setup()

    def _B_setup():
        B, S, D, F = (1, 2048, 512, 1792)
        return {'x': _w((lambda *s: torch.randn(*s, dtype=torch.bfloat16) * 0.1)(B, S, D)), 'w_gate': _w((lambda *s: torch.randn(*s, dtype=torch.bfloat16) * 0.4)(D, F) * D ** (-0.5)), 'w_up': _w((lambda *s: torch.randn(*s, dtype=torch.bfloat16) * 0.4)(D, F) * D ** (-0.5)), 'w_down': _w((lambda *s: torch.randn(*s, dtype=torch.bfloat16) * 0.4)(F, D) * F ** (-0.5))}
    _B_in = _B_setup()
    return {'A_x': _A_in['x'], 'A_mem0': _A_in['mem0'], 'A_Wq': _A_in['Wq'], 'A_Wk': _A_in['Wk'], 'A_Wv': _A_in['Wv'], 'A_Wo': _A_in['Wo'], 'A_seg_len': _A_in['seg_len'], 'B_x': _B_in['x'], 'B_w_gate': _B_in['w_gate'], 'B_w_up': _B_in['w_up'], 'B_w_down': _B_in['w_down']}

def reference(A_x, A_mem0, A_Wq, A_Wk, A_Wv, A_Wo, A_seg_len, B_x, B_w_gate, B_w_up, B_w_down):

    def _A_ref(x, mem0, Wq, Wk, Wv, Wo, seg_len):
        B, S, Dm = x.shape
        H, Dh = (Wq.shape[1], Wq.shape[2])
        M = mem0.shape[1]
        scale = Dh ** (-0.5)
        n_seg = S // seg_len
        L = M + seg_len
        idx = torch.arange(L)
        mask = (idx[:, None] < M) | (idx[:, None] >= idx[None, :])
        mem = mem0
        outs = []
        for s in range(n_seg):
            xs = x[:, s * seg_len:(s + 1) * seg_len, :].clone()
            h = torch.concatenate([mem, xs], axis=1)
            q = torch.einsum('btd,dhe->bhte', h, Wq)
            k = torch.einsum('btd,dhe->bhte', h, Wk)
            v = torch.einsum('btd,dhe->bhte', h, Wv)
            scores = torch.einsum('bhqe,bhke->bhqk', q, k) * scale
            scores = torch.where(mask[None, None], scores, -1000000000.0)
            p = _softmax(scores, axis=-1)
            o = torch.einsum('bhqk,bhke->bhqe', p, v)
            o = torch.einsum('bhte,hed->btd', o, Wo)
            mem = o[:, :M, :].clone()
            outs.append(o[:, M:, :])
        return torch.concatenate(outs, axis=1)

    def _B_ref(x, w_gate, w_up, w_down):
        g = torch.einsum('bsd,df->bsf', x, w_gate)
        u = torch.einsum('bsd,df->bsf', x, w_up)
        h = g * u
        return torch.einsum('bsf,fd->bsd', h, w_down)
    x = A_x
    xn = _layernorm(x, axis=-1)
    s = _A_ref(xn, A_mem0, A_Wq, A_Wk, A_Wv, A_Wo, A_seg_len)
    g = _silu(_B_ref(xn, B_w_gate, B_w_up, B_w_down))
    return x + s * g
```

```asm
; @launch grid=(256,1,1) block=(256,1,1) lds=163840
.amdgcn_target "amdgcn-amd-amdhsa--gfx950"
.text
.globl recurrent_scan__memory_aug_recurrent_mem_tr__glu_gated_bilinear__prompt_kernel
.p2align 8
.type recurrent_scan__memory_aug_recurrent_mem_tr__glu_gated_bilinear__prompt_kernel,@function
recurrent_scan__memory_aug_recurrent_mem_tr__glu_gated_bilinear__prompt_kernel:
    s_cmp_ge_u32 s2, 256
    s_cbranch_scc1 K_exit
    s_load_dwordx16 s[32:47], s[0:1], 0
    s_load_dwordx8 s[48:55], s[0:1], 64
    s_load_dwordx4 s[56:59], s[0:1], 96
    s_getreg_b32 s60, hwreg(HW_REG_XCC_ID)
    s_and_b32 s60, s60, 15
    v_lshrrev_b32 v1, 6, v0
    s_nop 0
    v_readfirstlane_b32 s61, v1
    s_waitcnt lgkmcnt(0)
    s_mov_b32 s8, s58
    s_and_b32 s9, s59, 0xffff
    s_mov_b32 s10, 0x10000000
    s_mov_b32 s11, 0x20000
    s_mov_b32 s12, s56
    s_and_b32 s13, s57, 0xffff
    s_mov_b32 s14, 0x100
    s_mov_b32 s15, 0x20000
    s_cmp_lg_u32 s60, 3
    s_cbranch_scc1 K_bulk_t
    v_mov_b32 v253, 14336
    s_cmp_lg_u32 s61, 0
    s_cbranch_scc1 TK_1
    s_mov_b64 exec, 1
    v_mov_b32 v251, 1
    v_mov_b32 v252, 0
    buffer_atomic_add v251, v252, s[12:15], 0 offen sc0
    s_waitcnt vmcnt(0)
    ds_write_b32 v253, v251
    s_waitcnt lgkmcnt(0)
    s_mov_b64 exec, -1
TK_1:
    s_barrier
    ds_read_b32 v251, v253
    s_waitcnt lgkmcnt(0)
    v_readfirstlane_b32 s62, v251
    s_barrier
    s_cmp_lt_u32 s62, 32
    s_cbranch_scc1 K_rec
K_bulk_t:
    v_mov_b32 v253, 14336
    s_cmp_lg_u32 s61, 0
    s_cbranch_scc1 TK_2
    s_mov_b64 exec, 1
    v_mov_b32 v251, 1
    v_mov_b32 v252, 128
    buffer_atomic_add v251, v252, s[12:15], 0 offen sc0
    s_waitcnt vmcnt(0)
    ds_write_b32 v253, v251
    s_waitcnt lgkmcnt(0)
    s_mov_b64 exec, -1
TK_2:
    s_barrier
    ds_read_b32 v251, v253
    s_waitcnt lgkmcnt(0)
    v_readfirstlane_b32 s62, v251
    s_barrier
    s_sub_u32 s85, s62, 128
    s_cmp_ge_u32 s85, 4
    s_cbranch_scc1 K_nz
    v_mov_b32 v240, 0
    v_mov_b32 v241, 0
    v_mov_b32 v242, 0
    v_mov_b32 v243, 0
    v_and_b32 v244, 63, v0
    v_lshlrev_b32 v244, 4, v244
    s_lshl_b32 s85, s85, 2
    s_add_u32 s85, s85, s61
    s_mul_i32 s84, s85, 5120
    s_add_u32 s84, s84, 0x7200000
    buffer_store_dwordx4 v[240:243], v244, s[8:11], s84 offen offset:0 sc1
    buffer_store_dwordx4 v[240:243], v244, s[8:11], s84 offen offset:1024 sc1
    buffer_store_dwordx4 v[240:243], v244, s[8:11], s84 offen offset:2048 sc1
    buffer_store_dwordx4 v[240:243], v244, s[8:11], s84 offen offset:3072 sc1
    s_add_u32 s84, s84, 4096
    buffer_store_dwordx4 v[240:243], v244, s[8:11], s84 offen offset:0 sc1
    s_waitcnt vmcnt(0)
    s_barrier
    s_cmp_lg_u32 s61, 0
    s_cbranch_scc1 DA_3
    s_mov_b64 exec, 1
    v_mov_b32 v251, 1
    v_mov_b32 v252, 20
    buffer_atomic_add v251, v252, s[12:15], 0 offen
    s_waitcnt vmcnt(0)
    s_mov_b64 exec, -1
DA_3:
K_nz:
    s_sub_u32 s89, s62, 128
    s_cmp_ge_u32 s89, 96
    s_cbranch_scc1 K_a
    s_mov_b32 s16, s32
    s_and_b32 s17, s33, 0xffff
    s_mov_b32 s18, 0x200000
    s_mov_b32 s19, 0x20000
K_ln:
    s_lshl_b32 s90, s89, 14
    s_lshl_b32 s84, s61, 12
    s_add_u32 s90, s90, s84
    s_add_u32 s91, s90, 2048
    v_and_b32 v208, 63, v0
    v_lshlrev_b32 v208, 4, v208
    buffer_load_dwordx4 v[200:203], v208, s[16:19], s90 offen
    buffer_load_dwordx4 v[204:207], v208, s[16:19], s90 offen offset:1024
    v_and_b32 v158, 63, v0
    v_lshlrev_b32 v158, 4, v158
    buffer_load_dwordx4 v[150:153], v158, s[16:19], s91 offen
    buffer_load_dwordx4 v[154:157], v158, s[16:19], s91 offen offset:1024
    s_mov_b32 s20, s42
    s_and_b32 s21, s43, 0xffff
    s_mov_b32 s22, 0x400000
    s_mov_b32 s23, 0x20000
    s_lshl_b32 s88, s90, 1
    buffer_load_dwordx4 v[100:103], v208, s[20:23], s88 offen offset:0
    buffer_load_dwordx4 v[104:107], v208, s[20:23], s88 offen offset:1024
    buffer_load_dwordx4 v[108:111], v208, s[20:23], s88 offen offset:2048
    buffer_load_dwordx4 v[112:115], v208, s[20:23], s88 offen offset:3072
    s_add_u32 s88, s88, 4096
    buffer_load_dwordx4 v[116:119], v208, s[20:23], s88 offen offset:0
    buffer_load_dwordx4 v[120:123], v208, s[20:23], s88 offen offset:1024
    buffer_load_dwordx4 v[124:127], v208, s[20:23], s88 offen offset:2048
    buffer_load_dwordx4 v[128:131], v208, s[20:23], s88 offen offset:3072
    s_waitcnt vmcnt(10)
    v_lshlrev_b32 v210, 16, v200
    v_and_b32 v211, 0xffff0000, v200
    v_lshlrev_b32 v212, 16, v201
    v_and_b32 v213, 0xffff0000, v201
    v_lshlrev_b32 v214, 16, v202
    v_and_b32 v215, 0xffff0000, v202
    v_lshlrev_b32 v216, 16, v203
    v_and_b32 v217, 0xffff0000, v203
    v_lshlrev_b32 v218, 16, v204
    v_and_b32 v219, 0xffff0000, v204
    v_lshlrev_b32 v220, 16, v205
    v_and_b32 v221, 0xffff0000, v205
    v_lshlrev_b32 v222, 16, v206
    v_and_b32 v223, 0xffff0000, v206
    v_lshlrev_b32 v224, 16, v207
    v_and_b32 v225, 0xffff0000, v207
    v_add_f32 v226, v210, v211
    v_add_f32 v226, v226, v212
    v_add_f32 v226, v226, v213
    v_add_f32 v226, v226, v214
    v_add_f32 v226, v226, v215
    v_add_f32 v226, v226, v216
    v_add_f32 v226, v226, v217
    v_add_f32 v227, v218, v219
    v_add_f32 v227, v227, v220
    v_add_f32 v227, v227, v221
    v_add_f32 v227, v227, v222
    v_add_f32 v227, v227, v223
    v_add_f32 v227, v227, v224
    v_add_f32 v227, v227, v225
    v_add_f32_dpp v226, v226, v226 row_ror:1 row_mask:0xf bank_mask:0xf
    s_nop 0
    v_add_f32_dpp v227, v227, v227 row_ror:1 row_mask:0xf bank_mask:0xf
    v_add_f32_dpp v226, v226, v226 row_ror:2 row_mask:0xf bank_mask:0xf
    s_nop 0
    v_add_f32_dpp v227, v227, v227 row_ror:2 row_mask:0xf bank_mask:0xf
    v_add_f32_dpp v226, v226, v226 row_ror:4 row_mask:0xf bank_mask:0xf
    s_nop 0
    v_add_f32_dpp v227, v227, v227 row_ror:4 row_mask:0xf bank_mask:0xf
    v_add_f32_dpp v226, v226, v226 row_ror:8 row_mask:0xf bank_mask:0xf
    s_nop 0
    v_add_f32_dpp v227, v227, v227 row_ror:8 row_mask:0xf bank_mask:0xf
    v_mov_b32 v228, v226
    v_mov_b32 v229, v227
    s_nop 0
    v_permlane16_swap_b32 v226, v228
    v_permlane16_swap_b32 v227, v229
    v_add_f32 v226, v226, v228
    v_add_f32 v227, v227, v229
    v_mov_b32 v228, v226
    v_mov_b32 v229, v227
    s_nop 0
    v_permlane32_swap_b32 v226, v228
    v_permlane32_swap_b32 v227, v229
    v_add_f32 v226, v226, v228
    v_add_f32 v227, v227, v229
    v_mul_f32 v230, 0x3b000000, v226
    v_mul_f32 v231, 0x3b000000, v227
    v_sub_f32 v232, v210, v230
    v_sub_f32 v233, v211, v230
    v_sub_f32 v234, v212, v230
    v_sub_f32 v235, v213, v230
    v_sub_f32 v236, v214, v230
    v_sub_f32 v237, v215, v230
    v_sub_f32 v238, v216, v230
    v_sub_f32 v239, v217, v230
    v_mul_f32 v226, v232, v232
    v_fmac_f32 v226, v233, v233
    v_fmac_f32 v226, v234, v234
    v_fmac_f32 v226, v235, v235
    v_fmac_f32 v226, v236, v236
    v_fmac_f32 v226, v237, v237
    v_fmac_f32 v226, v238, v238
    v_fmac_f32 v226, v239, v239
    v_sub_f32 v240, v218, v231
    v_sub_f32 v241, v219, v231
    v_sub_f32 v242, v220, v231
    v_sub_f32 v243, v221, v231
    v_sub_f32 v244, v222, v231
    v_sub_f32 v245, v223, v231
    v_sub_f32 v246, v224, v231
    v_sub_f32 v247, v225, v231
    v_mul_f32 v227, v240, v240
    v_fmac_f32 v227, v241, v241
    v_fmac_f32 v227, v242, v242
    v_fmac_f32 v227, v243, v243
    v_fmac_f32 v227, v244, v244
    v_fmac_f32 v227, v245, v245
    v_fmac_f32 v227, v246, v246
    v_fmac_f32 v227, v247, v247
    v_add_f32_dpp v226, v226, v226 row_ror:1 row_mask:0xf bank_mask:0xf
    s_nop 0
    v_add_f32_dpp v227, v227, v227 row_ror:1 row_mask:0xf bank_mask:0xf
    v_add_f32_dpp v226, v226, v226 row_ror:2 row_mask:0xf bank_mask:0xf
    s_nop 0
    v_add_f32_dpp v227, v227, v227 row_ror:2 row_mask:0xf bank_mask:0xf
    v_add_f32_dpp v226, v226, v226 row_ror:4 row_mask:0xf bank_mask:0xf
    s_nop 0
    v_add_f32_dpp v227, v227, v227 row_ror:4 row_mask:0xf bank_mask:0xf
    v_add_f32_dpp v226, v226, v226 row_ror:8 row_mask:0xf bank_mask:0xf
    s_nop 0
    v_add_f32_dpp v227, v227, v227 row_ror:8 row_mask:0xf bank_mask:0xf
    v_mov_b32 v228, v226
    v_mov_b32 v229, v227
    s_nop 0
    v_permlane16_swap_b32 v226, v228
    v_permlane16_swap_b32 v227, v229
    v_add_f32 v226, v226, v228
    v_add_f32 v227, v227, v229
    v_mov_b32 v228, v226
    v_mov_b32 v229, v227
    s_nop 0
    v_permlane32_swap_b32 v226, v228
    v_permlane32_swap_b32 v227, v229
    v_add_f32 v226, v226, v228
    v_add_f32 v227, v227, v229
    v_mul_f32 v226, 0x3b000000, v226
    v_cvt_pk_bf16_f32 v226, v226, v226
    v_and_b32 v226, 0xffff0000, v226
    v_add_f32 v226, 0x3727c5ac, v226
    v_cvt_pk_bf16_f32 v226, v226, v226
    v_and_b32 v226, 0xffff0000, v226
    v_sqrt_f32 v226, v226
    s_nop 0
    v_cvt_pk_bf16_f32 v226, v226, v226
    v_and_b32 v226, 0xffff0000, v226
    v_rcp_f32 v226, v226
    v_cvt_pk_bf16_f32 v230, v230, v230
    v_and_b32 v230, 0xffff0000, v230
    v_mul_f32 v227, 0x3b000000, v227
    v_cvt_pk_bf16_f32 v227, v227, v227
    v_and_b32 v227, 0xffff0000, v227
    v_add_f32 v227, 0x3727c5ac, v227
    v_cvt_pk_bf16_f32 v227, v227, v227
    v_and_b32 v227, 0xffff0000, v227
    v_sqrt_f32 v227, v227
    s_nop 0
    v_cvt_pk_bf16_f32 v227, v227, v227
    v_and_b32 v227, 0xffff0000, v227
    v_rcp_f32 v227, v227
    v_cvt_pk_bf16_f32 v231, v231, v231
    v_and_b32 v231, 0xffff0000, v231
    v_sub_f32 v232, v210, v230
    v_sub_f32 v233, v211, v230
    v_cvt_pk_bf16_f32 v228, v232, v233
    v_lshlrev_b32 v232, 16, v228
    v_and_b32 v233, 0xffff0000, v228
    v_mul_f32 v232, v232, v226
    v_mul_f32 v233, v233, v226
    v_cvt_pk_bf16_f32 v200, v232, v233
    v_sub_f32 v234, v212, v230
    v_sub_f32 v235, v213, v230
    v_cvt_pk_bf16_f32 v228, v234, v235
    v_lshlrev_b32 v234, 16, v228
    v_and_b32 v235, 0xffff0000, v228
    v_mul_f32 v234, v234, v226
    v_mul_f32 v235, v235, v226
    v_cvt_pk_bf16_f32 v201, v234, v235
    v_sub_f32 v236, v214, v230
    v_sub_f32 v237, v215, v230
    v_cvt_pk_bf16_f32 v228, v236, v237
    v_lshlrev_b32 v236, 16, v228
    v_and_b32 v237, 0xffff0000, v228
    v_mul_f32 v236, v236, v226
    v_mul_f32 v237, v237, v226
    v_cvt_pk_bf16_f32 v202, v236, v237
    v_sub_f32 v238, v216, v230
    v_sub_f32 v239, v217, v230
    v_cvt_pk_bf16_f32 v228, v238, v239
    v_lshlrev_b32 v238, 16, v228
    v_and_b32 v239, 0xffff0000, v228
    v_mul_f32 v238, v238, v226
    v_mul_f32 v239, v239, v226
    v_cvt_pk_bf16_f32 v203, v238, v239
    v_sub_f32 v240, v218, v231
    v_sub_f32 v241, v219, v231
    v_cvt_pk_bf16_f32 v229, v240, v241
    v_lshlrev_b32 v240, 16, v229
    v_and_b32 v241, 0xffff0000, v229
    v_mul_f32 v240, v240, v227
    v_mul_f32 v241, v241, v227
    v_cvt_pk_bf16_f32 v204, v240, v241
    v_sub_f32 v242, v220, v231
    v_sub_f32 v243, v221, v231
    v_cvt_pk_bf16_f32 v229, v242, v243
    v_lshlrev_b32 v242, 16, v229
    v_and_b32 v243, 0xffff0000, v229
    v_mul_f32 v242, v242, v227
    v_mul_f32 v243, v243, v227
    v_cvt_pk_bf16_f32 v205, v242, v243
    v_sub_f32 v244, v222, v231
    v_sub_f32 v245, v223, v231
    v_cvt_pk_bf16_f32 v229, v244, v245
    v_lshlrev_b32 v244, 16, v229
    v_and_b32 v245, 0xffff0000, v229
    v_mul_f32 v244, v244, v227
    v_mul_f32 v245, v245, v227
    v_cvt_pk_bf16_f32 v206, v244, v245
    v_sub_f32 v246, v224, v231
    v_sub_f32 v247, v225, v231
    v_cvt_pk_bf16_f32 v229, v246, v247
    v_lshlrev_b32 v246, 16, v229
    v_and_b32 v247, 0xffff0000, v229
    v_mul_f32 v246, v246, v227
    v_mul_f32 v247, v247, v227
    v_cvt_pk_bf16_f32 v207, v246, v247
    buffer_store_dwordx4 v[200:203], v208, s[8:11], s90 offen sc1
    buffer_store_dwordx4 v[204:207], v208, s[8:11], s90 offen offset:1024 sc1
    s_waitcnt vmcnt(10)
    v_lshlrev_b32 v160, 16, v150
    v_and_b32 v161, 0xffff0000, v150
    v_lshlrev_b32 v162, 16, v151
    v_and_b32 v163, 0xffff0000, v151
    v_lshlrev_b32 v164, 16, v152
    v_and_b32 v165, 0xffff0000, v152
    v_lshlrev_b32 v166, 16, v153
    v_and_b32 v167, 0xffff0000, v153
    v_lshlrev_b32 v168, 16, v154
    v_and_b32 v169, 0xffff0000, v154
    v_lshlrev_b32 v170, 16, v155
    v_and_b32 v171, 0xffff0000, v155
    v_lshlrev_b32 v172, 16, v156
    v_and_b32 v173, 0xffff0000, v156
    v_lshlrev_b32 v174, 16, v157
    v_and_b32 v175, 0xffff0000, v157
    v_add_f32 v176, v160, v161
    v_add_f32 v176, v176, v162
    v_add_f32 v176, v176, v163
    v_add_f32 v176, v176, v164
    v_add_f32 v176, v176, v165
    v_add_f32 v176, v176, v166
    v_add_f32 v176, v176, v167
    v_add_f32 v177, v168, v169
    v_add_f32 v177, v177, v170
    v_add_f32 v177, v177, v171
    v_add_f32 v177, v177, v172
    v_add_f32 v177, v177, v173
    v_add_f32 v177, v177, v174
    v_add_f32 v177, v177, v175
    v_add_f32_dpp v176, v176, v176 row_ror:1 row_mask:0xf bank_mask:0xf
    s_nop 0
    v_add_f32_dpp v177, v177, v177 row_ror:1 row_mask:0xf bank_mask:0xf
    v_add_f32_dpp v176, v176, v176 row_ror:2 row_mask:0xf bank_mask:0xf
    s_nop 0
    v_add_f32_dpp v177, v177, v177 row_ror:2 row_mask:0xf bank_mask:0xf
    v_add_f32_dpp v176, v176, v176 row_ror:4 row_mask:0xf bank_mask:0xf
    s_nop 0
    v_add_f32_dpp v177, v177, v177 row_ror:4 row_mask:0xf bank_mask:0xf
    v_add_f32_dpp v176, v176, v176 row_ror:8 row_mask:0xf bank_mask:0xf
    s_nop 0
    v_add_f32_dpp v177, v177, v177 row_ror:8 row_mask:0xf bank_mask:0xf
    v_mov_b32 v178, v176
    v_mov_b32 v179, v177
    s_nop 0
    v_permlane16_swap_b32 v176, v178
    v_permlane16_swap_b32 v177, v179
    v_add_f32 v176, v176, v178
    v_add_f32 v177, v177, v179
    v_mov_b32 v178, v176
    v_mov_b32 v179, v177
    s_nop 0
    v_permlane32_swap_b32 v176, v178
    v_permlane32_swap_b32 v177, v179
    v_add_f32 v176, v176, v178
    v_add_f32 v177, v177, v179
    v_mul_f32 v180, 0x3b000000, v176
    v_mul_f32 v181, 0x3b000000, v177
    v_sub_f32 v182, v160, v180
    v_sub_f32 v183, v161, v180
    v_sub_f32 v184, v162, v180
    v_sub_f32 v185, v163, v180
    v_sub_f32 v186, v164, v180
    v_sub_f32 v187, v165, v180
    v_sub_f32 v188, v166, v180
    v_sub_f32 v189, v167, v180
    v_mul_f32 v176, v182, v182
    v_fmac_f32 v176, v183, v183
    v_fmac_f32 v176, v184, v184
    v_fmac_f32 v176, v185, v185
    v_fmac_f32 v176, v186, v186
    v_fmac_f32 v176, v187, v187
    v_fmac_f32 v176, v188, v188
    v_fmac_f32 v176, v189, v189
    v_sub_f32 v190, v168, v181
    v_sub_f32 v191, v169, v181
    v_sub_f32 v192, v170, v181
    v_sub_f32 v193, v171, v181
    v_sub_f32 v194, v172, v181
    v_sub_f32 v195, v173, v181
    v_sub_f32 v196, v174, v181
    v_sub_f32 v197, v175, v181
    v_mul_f32 v177, v190, v190
    v_fmac_f32 v177, v191, v191
    v_fmac_f32 v177, v192, v192
    v_fmac_f32 v177, v193, v193
    v_fmac_f32 v177, v194, v194
    v_fmac_f32 v177, v195, v195
    v_fmac_f32 v177, v196, v196
    v_fmac_f32 v177, v197, v197
    v_add_f32_dpp v176, v176, v176 row_ror:1 row_mask:0xf bank_mask:0xf
    s_nop 0
    v_add_f32_dpp v177, v177, v177 row_ror:1 row_mask:0xf bank_mask:0xf
    v_add_f32_dpp v176, v176, v176 row_ror:2 row_mask:0xf bank_mask:0xf
    s_nop 0
    v_add_f32_dpp v177, v177, v177 row_ror:2 row_mask:0xf bank_mask:0xf
    v_add_f32_dpp v176, v176, v176 row_ror:4 row_mask:0xf bank_mask:0xf
    s_nop 0
    v_add_f32_dpp v177, v177, v177 row_ror:4 row_mask:0xf bank_mask:0xf
    v_add_f32_dpp v176, v176, v176 row_ror:8 row_mask:0xf bank_mask:0xf
    s_nop 0
    v_add_f32_dpp v177, v177, v177 row_ror:8 row_mask:0xf bank_mask:0xf
    v_mov_b32 v178, v176
    v_mov_b32 v179, v177
    s_nop 0
    v_permlane16_swap_b32 v176, v178
    v_permlane16_swap_b32 v177, v179
    v_add_f32 v176, v176, v178
    v_add_f32 v177, v177, v179
    v_mov_b32 v178, v176
    v_mov_b32 v179, v177
    s_nop 0
    v_permlane32_swap_b32 v176, v178
    v_permlane32_swap_b32 v177, v179
    v_add_f32 v176, v176, v178
    v_add_f32 v177, v177, v179
    v_mul_f32 v176, 0x3b000000, v176
    v_cvt_pk_bf16_f32 v176, v176, v176
    v_and_b32 v176, 0xffff0000, v176
    v_add_f32 v176, 0x3727c5ac, v176
    v_cvt_pk_bf16_f32 v176, v176, v176
    v_and_b32 v176, 0xffff0000, v176
    v_sqrt_f32 v176, v176
    s_nop 0
    v_cvt_pk_bf16_f32 v176, v176, v176
    v_and_b32 v176, 0xffff0000, v176
    v_rcp_f32 v176, v176
    v_cvt_pk_bf16_f32 v180, v180, v180
    v_and_b32 v180, 0xffff0000, v180
    v_mul_f32 v177, 0x3b000000, v177
    v_cvt_pk_bf16_f32 v177, v177, v177
    v_and_b32 v177, 0xffff0000, v177
    v_add_f32 v177, 0x3727c5ac, v177
    v_cvt_pk_bf16_f32 v177, v177, v177
    v_and_b32 v177, 0xffff0000, v177
    v_sqrt_f32 v177, v177
    s_nop 0
    v_cvt_pk_bf16_f32 v177, v177, v177
    v_and_b32 v177, 0xffff0000, v177
    v_rcp_f32 v177, v177
    v_cvt_pk_bf16_f32 v181, v181, v181
    v_and_b32 v181, 0xffff0000, v181
    v_sub_f32 v182, v160, v180
    v_sub_f32 v183, v161, v180
    v_cvt_pk_bf16_f32 v178, v182, v183
    v_lshlrev_b32 v182, 16, v178
    v_and_b32 v183, 0xffff0000, v178
    v_mul_f32 v182, v182, v176
    v_mul_f32 v183, v183, v176
    v_cvt_pk_bf16_f32 v150, v182, v183
    v_sub_f32 v184, v162, v180
    v_sub_f32 v185, v163, v180
    v_cvt_pk_bf16_f32 v178, v184, v185
    v_lshlrev_b32 v184, 16, v178
    v_and_b32 v185, 0xffff0000, v178
    v_mul_f32 v184, v184, v176
    v_mul_f32 v185, v185, v176
    v_cvt_pk_bf16_f32 v151, v184, v185
    v_sub_f32 v186, v164, v180
    v_sub_f32 v187, v165, v180
    v_cvt_pk_bf16_f32 v178, v186, v187
    v_lshlrev_b32 v186, 16, v178
    v_and_b32 v187, 0xffff0000, v178
    v_mul_f32 v186, v186, v176
    v_mul_f32 v187, v187, v176
    v_cvt_pk_bf16_f32 v152, v186, v187
    v_sub_f32 v188, v166, v180
    v_sub_f32 v189, v167, v180
    v_cvt_pk_bf16_f32 v178, v188, v189
    v_lshlrev_b32 v188, 16, v178
    v_and_b32 v189, 0xffff0000, v178
    v_mul_f32 v188, v188, v176
    v_mul_f32 v189, v189, v176
    v_cvt_pk_bf16_f32 v153, v188, v189
    v_sub_f32 v190, v168, v181
    v_sub_f32 v191, v169, v181
    v_cvt_pk_bf16_f32 v179, v190, v191
    v_lshlrev_b32 v190, 16, v179
    v_and_b32 v191, 0xffff0000, v179
    v_mul_f32 v190, v190, v177
    v_mul_f32 v191, v191, v177
    v_cvt_pk_bf16_f32 v154, v190, v191
    v_sub_f32 v192, v170, v181
    v_sub_f32 v193, v171, v181
    v_cvt_pk_bf16_f32 v179, v192, v193
    v_lshlrev_b32 v192, 16, v179
    v_and_b32 v193, 0xffff0000, v179
    v_mul_f32 v192, v192, v177
    v_mul_f32 v193, v193, v177
    v_cvt_pk_bf16_f32 v155, v192, v193
    v_sub_f32 v194, v172, v181
    v_sub_f32 v195, v173, v181
    v_cvt_pk_bf16_f32 v179, v194, v195
    v_lshlrev_b32 v194, 16, v179
    v_and_b32 v195, 0xffff0000, v179
    v_mul_f32 v194, v194, v177
    v_mul_f32 v195, v195, v177
    v_cvt_pk_bf16_f32 v156, v194, v195
    v_sub_f32 v196, v174, v181
    v_sub_f32 v197, v175, v181
    v_cvt_pk_bf16_f32 v179, v196, v197
    v_lshlrev_b32 v196, 16, v179
    v_and_b32 v197, 0xffff0000, v179
    v_mul_f32 v196, v196, v177
    v_mul_f32 v197, v197, v177
    v_cvt_pk_bf16_f32 v157, v196, v197
    buffer_store_dwordx4 v[150:153], v158, s[8:11], s91 offen sc1
    buffer_store_dwordx4 v[154:157], v158, s[8:11], s91 offen offset:1024 sc1
    v_mov_b32 v250, 20
    s_mov_b32 s83, 0
WD_4:
    buffer_load_dword v251, v250, s[12:15], 0 offen sc1
    s_add_u32 s83, s83, 1
    s_cmp_gt_u32 s83, 0x400000
    s_cbranch_scc1 B_fail
    s_waitcnt vmcnt(0)
    v_readfirstlane_b32 s84, v251
    s_nop 0
    s_cmp_ge_u32 s84, 4
    s_cbranch_scc1 WDd_5
    s_sleep 2
    s_branch WD_4
WDd_5:
    s_barrier
    s_cmp_lg_u32 s61, 0
    s_cbranch_scc1 LNF_6
    s_lshl_b32 s85, s89, 2
    s_add_u32 s85, s85, 0x7210000
    s_mov_b64 exec, 1
    v_mov_b32 v250, 0
    v_mov_b32 v251, 1
    buffer_store_dword v251, v250, s[8:11], s85 offen sc1
    s_mov_b64 exec, -1
LNF_6:
    s_add_u32 s89, s89, 96
    s_cmp_lt_u32 s89, 128
    s_cbranch_scc1 K_ln
K_a:
    v_and_b32 v1, 63, v0
    v_and_b32 v2, 15, v1
    v_lshrrev_b32 v3, 4, v1
    v_lshlrev_b32 v4, 4, v1
    s_mov_b32 s95, 0x05040100
    s_mov_b32 s96, 0x07060302
    v_lshlrev_b32 v5, 10, v2
    v_lshl_add_u32 v5, v3, 4, v5
    s_lshr_b32 s84, s61, 1
    s_lshl_b32 s84, s84, 14
    s_and_b32 s85, s61, 1
    s_lshl_b32 s85, s85, 9
    s_add_u32 s84, s84, s85
    v_add_u32 v5, s84, v5
    s_cmp_ge_u32 s62, 218
    s_cbranch_scc1 A_done
    s_cmp_ge_u32 s62, 176
    s_cbranch_scc1 A_h
    s_and_b32 s66, s62, 31
    s_lshr_b32 s64, s62, 5
    s_mov_b32 s65, 4
    s_cmp_lt_u32 s62, 128
    s_cbranch_scc1 A_kv
    s_sub_u32 s84, s62, 128
    s_and_b32 s66, s84, 15
    s_add_u32 s66, s66, 32
    s_lshr_b32 s64, s84, 4
    s_mov_b32 s65, 3
A_kv:
    s_and_b32 s84, s66, 15
    s_lshl_b32 s67, s84, 9
    s_lshl_b32 s85, s61, 7
    s_add_u32 s67, s67, s85
    s_lshl_b32 s68, s84, 14
    s_lshr_b32 s85, s61, 1
    s_lshl_b32 s85, s85, 13
    s_add_u32 s68, s68, s85
    s_and_b32 s86, s61, 1
    s_lshr_b32 s87, s66, 4
    s_lshl_b32 s73, s84, 11
    s_add_u32 s73, s73, 0x7200000
    s_cmp_eq_u32 s87, 1
    s_cbranch_scc1 A_v
    s_lshl_b32 s86, s86, 11
    s_add_u32 s68, s68, s86
    s_cmp_eq_u32 s87, 0
    s_cselect_b32 s16, s38, s36
    s_cselect_b32 s17, s39, s37
    s_cselect_b32 s85, 0, 8
    s_cselect_b32 s84, 0x10, 0x20
    s_add_u32 s73, s73, s85
    s_lshl_b32 s84, s84, 20
    s_add_u32 s68, s68, s84
    s_and_b32 s17, s17, 0xffff
    s_mov_b32 s18, 4194304
    s_mov_b32 s19, 0x20000
    s_branch A_w
A_v:
    s_lshl_b32 s86, s86, 12
    s_add_u32 s68, s68, s86
    s_add_u32 s68, s68, 0x3000000
    s_add_u32 s73, s73, 16
    s_mov_b32 s16, s40
    s_and_b32 s17, s41, 0xffff
    s_mov_b32 s18, 0x400000
    s_mov_b32 s19, 0x20000
A_w:
    s_mov_b32 s84, 65536
    v_mul_lo_u32 v6, v3, s84
    v_lshl_add_u32 v6, v2, 3, v6
    s_add_u32 s84, s67, 0
    buffer_load_dwordx2 v[100:101], v6, s[16:19], s84 offen
    s_add_u32 s84, s67, 8192
    buffer_load_dwordx2 v[102:103], v6, s[16:19], s84 offen
    s_add_u32 s84, s67, 16384
    buffer_load_dwordx2 v[104:105], v6, s[16:19], s84 offen
    s_add_u32 s84, s67, 24576
    buffer_load_dwordx2 v[106:107], v6, s[16:19], s84 offen
    s_add_u32 s84, s67, 32768
    buffer_load_dwordx2 v[108:109], v6, s[16:19], s84 offen
    s_add_u32 s84, s67, 40960
    buffer_load_dwordx2 v[110:111], v6, s[16:19], s84 offen
    s_add_u32 s84, s67, 49152
    buffer_load_dwordx2 v[112:113], v6, s[16:19], s84 offen
    s_add_u32 s84, s67, 57344
    buffer_load_dwordx2 v[114:115], v6, s[16:19], s84 offen
    s_add_u32 s84, s67, 262144
    buffer_load_dwordx2 v[116:117], v6, s[16:19], s84 offen
    s_add_u32 s84, s67, 270336
    buffer_load_dwordx2 v[118:119], v6, s[16:19], s84 offen
    s_add_u32 s84, s67, 278528
    buffer_load_dwordx2 v[120:121], v6, s[16:19], s84 offen
    s_add_u32 s84, s67, 286720
    buffer_load_dwordx2 v[122:123], v6, s[16:19], s84 offen
    s_add_u32 s84, s67, 294912
    buffer_load_dwordx2 v[124:125], v6, s[16:19], s84 offen
    s_add_u32 s84, s67, 303104
    buffer_load_dwordx2 v[126:127], v6, s[16:19], s84 offen
    s_add_u32 s84, s67, 311296
    buffer_load_dwordx2 v[128:129], v6, s[16:19], s84 offen
    s_add_u32 s84, s67, 319488
    buffer_load_dwordx2 v[130:131], v6, s[16:19], s84 offen
    s_add_u32 s84, s67, 524288
    buffer_load_dwordx2 v[132:133], v6, s[16:19], s84 offen
    s_add_u32 s84, s67, 532480
    buffer_load_dwordx2 v[134:135], v6, s[16:19], s84 offen
    s_add_u32 s84, s67, 540672
    buffer_load_dwordx2 v[136:137], v6, s[16:19], s84 offen
    s_add_u32 s84, s67, 548864
    buffer_load_dwordx2 v[138:139], v6, s[16:19], s84 offen
    s_add_u32 s84, s67, 557056
    buffer_load_dwordx2 v[140:141], v6, s[16:19], s84 offen
    s_add_u32 s84, s67, 565248
    buffer_load_dwordx2 v[142:143], v6, s[16:19], s84 offen
    s_add_u32 s84, s67, 573440
    buffer_load_dwordx2 v[144:145], v6, s[16:19], s84 offen
    s_add_u32 s84, s67, 581632
    buffer_load_dwordx2 v[146:147], v6, s[16:19], s84 offen
    s_add_u32 s84, s67, 786432
    buffer_load_dwordx2 v[148:149], v6, s[16:19], s84 offen
    s_add_u32 s84, s67, 794624
    buffer_load_dwordx2 v[150:151], v6, s[16:19], s84 offen
    s_add_u32 s84, s67, 802816
    buffer_load_dwordx2 v[152:153], v6, s[16:19], s84 offen
    s_add_u32 s84, s67, 811008
    buffer_load_dwordx2 v[154:155], v6, s[16:19], s84 offen
    s_add_u32 s84, s67, 819200
    buffer_load_dwordx2 v[156:157], v6, s[16:19], s84 offen
    s_add_u32 s84, s67, 827392
    buffer_load_dwordx2 v[158:159], v6, s[16:19], s84 offen
    s_add_u32 s84, s67, 835584
    buffer_load_dwordx2 v[160:161], v6, s[16:19], s84 offen
    s_add_u32 s84, s67, 843776
    buffer_load_dwordx2 v[162:163], v6, s[16:19], s84 offen
    s_add_u32 s84, s67, 1048576
    buffer_load_dwordx2 v[164:165], v6, s[16:19], s84 offen
    s_add_u32 s84, s67, 1056768
    buffer_load_dwordx2 v[166:167], v6, s[16:19], s84 offen
    s_add_u32 s84, s67, 1064960
    buffer_load_dwordx2 v[168:169], v6, s[16:19], s84 offen
    s_add_u32 s84, s67, 1073152
    buffer_load_dwordx2 v[170:171], v6, s[16:19], s84 offen
    s_add_u32 s84, s67, 1081344
    buffer_load_dwordx2 v[172:173], v6, s[16:19], s84 offen
    s_add_u32 s84, s67, 1089536
    buffer_load_dwordx2 v[174:175], v6, s[16:19], s84 offen
    s_add_u32 s84, s67, 1097728
    buffer_load_dwordx2 v[176:177], v6, s[16:19], s84 offen
    s_add_u32 s84, s67, 1105920
    buffer_load_dwordx2 v[178:179], v6, s[16:19], s84 offen
    s_add_u32 s84, s67, 1310720
    buffer_load_dwordx2 v[180:181], v6, s[16:19], s84 offen
    s_add_u32 s84, s67, 1318912
    buffer_load_dwordx2 v[182:183], v6, s[16:19], s84 offen
    s_add_u32 s84, s67, 1327104
    buffer_load_dwordx2 v[184:185], v6, s[16:19], s84 offen
    s_add_u32 s84, s67, 1335296
    buffer_load_dwordx2 v[186:187], v6, s[16:19], s84 offen
    s_add_u32 s84, s67, 1343488
    buffer_load_dwordx2 v[188:189], v6, s[16:19], s84 offen
    s_add_u32 s84, s67, 1351680
    buffer_load_dwordx2 v[190:191], v6, s[16:19], s84 offen
    s_add_u32 s84, s67, 1359872
    buffer_load_dwordx2 v[192:193], v6, s[16:19], s84 offen
    s_add_u32 s84, s67, 1368064
    buffer_load_dwordx2 v[194:195], v6, s[16:19], s84 offen
    s_waitcnt vmcnt(32)
    v_perm_b32 v80, v102, v100, s95
    v_perm_b32 v81, v106, v104, s95
    v_perm_b32 v82, v110, v108, s95
    v_perm_b32 v83, v114, v112, s95
    v_perm_b32 v84, v102, v100, s96
    v_perm_b32 v85, v106, v104, s96
    v_perm_b32 v86, v110, v108, s96
    v_perm_b32 v87, v114, v112, s96
    v_perm_b32 v88, v103, v101, s95
    v_perm_b32 v89, v107, v105, s95
    v_perm_b32 v90, v111, v109, s95
    v_perm_b32 v91, v115, v113, s95
    v_perm_b32 v92, v103, v101, s96
    v_perm_b32 v93, v107, v105, s96
    v_perm_b32 v94, v111, v109, s96
    v_perm_b32 v95, v115, v113, s96
    v_accvgpr_write_b32 a0, v80
    v_accvgpr_write_b32 a1, v81
    v_accvgpr_write_b32 a2, v82
    v_accvgpr_write_b32 a3, v83
    v_accvgpr_write_b32 a4, v84
    v_accvgpr_write_b32 a5, v85
    v_accvgpr_write_b32 a6, v86
    v_accvgpr_write_b32 a7, v87
    v_accvgpr_write_b32 a8, v88
    v_accvgpr_write_b32 a9, v89
    v_accvgpr_write_b32 a10, v90
    v_accvgpr_write_b32 a11, v91
    v_accvgpr_write_b32 a12, v92
    v_accvgpr_write_b32 a13, v93
    v_accvgpr_write_b32 a14, v94
    v_accvgpr_write_b32 a15, v95
    v_perm_b32 v80, v118, v116, s95
    v_perm_b32 v81, v122, v120, s95
    v_perm_b32 v82, v126, v124, s95
    v_perm_b32 v83, v130, v128, s95
    v_perm_b32 v84, v118, v116, s96
    v_perm_b32 v85, v122, v120, s96
    v_perm_b32 v86, v126, v124, s96
    v_perm_b32 v87, v130, v128, s96
    v_perm_b32 v88, v119, v117, s95
    v_perm_b32 v89, v123, v121, s95
    v_perm_b32 v90, v127, v125, s95
    v_perm_b32 v91, v131, v129, s95
    v_perm_b32 v92, v119, v117, s96
    v_perm_b32 v93, v123, v121, s96
    v_perm_b32 v94, v127, v125, s96
    v_perm_b32 v95, v131, v129, s96
    v_accvgpr_write_b32 a16, v80
    v_accvgpr_write_b32 a17, v81
    v_accvgpr_write_b32 a18, v82
    v_accvgpr_write_b32 a19, v83
    v_accvgpr_write_b32 a20, v84
    v_accvgpr_write_b32 a21, v85
    v_accvgpr_write_b32 a22, v86
    v_accvgpr_write_b32 a23, v87
    v_accvgpr_write_b32 a24, v88
    v_accvgpr_write_b32 a25, v89
    v_accvgpr_write_b32 a26, v90
    v_accvgpr_write_b32 a27, v91
    v_accvgpr_write_b32 a28, v92
    v_accvgpr_write_b32 a29, v93
    v_accvgpr_write_b32 a30, v94
    v_accvgpr_write_b32 a31, v95
    s_add_u32 s84, s67, 1572864
    buffer_load_dwordx2 v[100:101], v6, s[16:19], s84 offen
    s_add_u32 s84, s67, 1581056
    buffer_load_dwordx2 v[102:103], v6, s[16:19], s84 offen
    s_add_u32 s84, s67, 1589248
    buffer_load_dwordx2 v[104:105], v6, s[16:19], s84 offen
    s_add_u32 s84, s67, 1597440
    buffer_load_dwordx2 v[106:107], v6, s[16:19], s84 offen
    s_add_u32 s84, s67, 1605632
    buffer_load_dwordx2 v[108:109], v6, s[16:19], s84 offen
    s_add_u32 s84, s67, 1613824
    buffer_load_dwordx2 v[110:111], v6, s[16:19], s84 offen
    s_add_u32 s84, s67, 1622016
    buffer_load_dwordx2 v[112:113], v6, s[16:19], s84 offen
    s_add_u32 s84, s67, 1630208
    buffer_load_dwordx2 v[114:115], v6, s[16:19], s84 offen
    s_add_u32 s84, s67, 1835008
    buffer_load_dwordx2 v[116:117], v6, s[16:19], s84 offen
    s_add_u32 s84, s67, 1843200
    buffer_load_dwordx2 v[118:119], v6, s[16:19], s84 offen
    s_add_u32 s84, s67, 1851392
    buffer_load_dwordx2 v[120:121], v6, s[16:19], s84 offen
    s_add_u32 s84, s67, 1859584
    buffer_load_dwordx2 v[122:123], v6, s[16:19], s84 offen
    s_add_u32 s84, s67, 1867776
    buffer_load_dwordx2 v[124:125], v6, s[16:19], s84 offen
    s_add_u32 s84, s67, 1875968
    buffer_load_dwordx2 v[126:127], v6, s[16:19], s84 offen
    s_add_u32 s84, s67, 1884160
    buffer_load_dwordx2 v[128:129], v6, s[16:19], s84 offen
    s_add_u32 s84, s67, 1892352
    buffer_load_dwordx2 v[130:131], v6, s[16:19], s84 offen
    s_waitcnt vmcnt(32)
    v_perm_b32 v80, v134, v132, s95
    v_perm_b32 v81, v138, v136, s95
    v_perm_b32 v82, v142, v140, s95
    v_perm_b32 v83, v146, v144, s95
    v_perm_b32 v84, v134, v132, s96
    v_perm_b32 v85, v138, v136, s96
    v_perm_b32 v86, v142, v140, s96
    v_perm_b32 v87, v146, v144, s96
    v_perm_b32 v88, v135, v133, s95
    v_perm_b32 v89, v139, v137, s95
    v_perm_b32 v90, v143, v141, s95
    v_perm_b32 v91, v147, v145, s95
    v_perm_b32 v92, v135, v133, s96
    v_perm_b32 v93, v139, v137, s96
    v_perm_b32 v94, v143, v141, s96
    v_perm_b32 v95, v147, v145, s96
    v_accvgpr_write_b32 a32, v80
    v_accvgpr_write_b32 a33, v81
    v_accvgpr_write_b32 a34, v82
    v_accvgpr_write_b32 a35, v83
    v_accvgpr_write_b32 a36, v84
    v_accvgpr_write_b32 a37, v85
    v_accvgpr_write_b32 a38, v86
    v_accvgpr_write_b32 a39, v87
    v_accvgpr_write_b32 a40, v88
    v_accvgpr_write_b32 a41, v89
    v_accvgpr_write_b32 a42, v90
    v_accvgpr_write_b32 a43, v91
    v_accvgpr_write_b32 a44, v92
    v_accvgpr_write_b32 a45, v93
    v_accvgpr_write_b32 a46, v94
    v_accvgpr_write_b32 a47, v95
    v_perm_b32 v80, v150, v148, s95
    v_perm_b32 v81, v154, v152, s95
    v_perm_b32 v82, v158, v156, s95
    v_perm_b32 v83, v162, v160, s95
    v_perm_b32 v84, v150, v148, s96
    v_perm_b32 v85, v154, v152, s96
    v_perm_b32 v86, v158, v156, s96
    v_perm_b32 v87, v162, v160, s96
    v_perm_b32 v88, v151, v149, s95
    v_perm_b32 v89, v155, v153, s95
    v_perm_b32 v90, v159, v157, s95
    v_perm_b32 v91, v163, v161, s95
    v_perm_b32 v92, v151, v149, s96
    v_perm_b32 v93, v155, v153, s96
    v_perm_b32 v94, v159, v157, s96
    v_perm_b32 v95, v163, v161, s96
    v_accvgpr_write_b32 a48, v80
    v_accvgpr_write_b32 a49, v81
    v_accvgpr_write_b32 a50, v82
    v_accvgpr_write_b32 a51, v83
    v_accvgpr_write_b32 a52, v84
    v_accvgpr_write_b32 a53, v85
    v_accvgpr_write_b32 a54, v86
    v_accvgpr_write_b32 a55, v87
    v_accvgpr_write_b32 a56, v88
    v_accvgpr_write_b32 a57, v89
    v_accvgpr_write_b32 a58, v90
    v_accvgpr_write_b32 a59, v91
    v_accvgpr_write_b32 a60, v92
    v_accvgpr_write_b32 a61, v93
    v_accvgpr_write_b32 a62, v94
    v_accvgpr_write_b32 a63, v95
    s_add_u32 s84, s67, 2097152
    buffer_load_dwordx2 v[132:133], v6, s[16:19], s84 offen
    s_add_u32 s84, s67, 2105344
    buffer_load_dwordx2 v[134:135], v6, s[16:19], s84 offen
    s_add_u32 s84, s67, 2113536
    buffer_load_dwordx2 v[136:137], v6, s[16:19], s84 offen
    s_add_u32 s84, s67, 2121728
    buffer_load_dwordx2 v[138:139], v6, s[16:19], s84 offen
    s_add_u32 s84, s67, 2129920
    buffer_load_dwordx2 v[140:141], v6, s[16:19], s84 offen
    s_add_u32 s84, s67, 2138112
    buffer_load_dwordx2 v[142:143], v6, s[16:19], s84 offen
    s_add_u32 s84, s67, 2146304
    buffer_load_dwordx2 v[144:145], v6, s[16:19], s84 offen
    s_add_u32 s84, s67, 2154496
    buffer_load_dwordx2 v[146:147], v6, s[16:19], s84 offen
    s_add_u32 s84, s67, 2359296
    buffer_load_dwordx2 v[148:149], v6, s[16:19], s84 offen
    s_add_u32 s84, s67, 2367488
    buffer_load_dwordx2 v[150:151], v6, s[16:19], s84 offen
    s_add_u32 s84, s67, 2375680
    buffer_load_dwordx2 v[152:153], v6, s[16:19], s84 offen
    s_add_u32 s84, s67, 2383872
    buffer_load_dwordx2 v[154:155], v6, s[16:19], s84 offen
    s_add_u32 s84, s67, 2392064
    buffer_load_dwordx2 v[156:157], v6, s[16:19], s84 offen
    s_add_u32 s84, s67, 2400256
    buffer_load_dwordx2 v[158:159], v6, s[16:19], s84 offen
    s_add_u32 s84, s67, 2408448
    buffer_load_dwordx2 v[160:161], v6, s[16:19], s84 offen
    s_add_u32 s84, s67, 2416640
    buffer_load_dwordx2 v[162:163], v6, s[16:19], s84 offen
    s_waitcnt vmcnt(32)
    v_perm_b32 v80, v166, v164, s95
    v_perm_b32 v81, v170, v168, s95
    v_perm_b32 v82, v174, v172, s95
    v_perm_b32 v83, v178, v176, s95
    v_perm_b32 v84, v166, v164, s96
    v_perm_b32 v85, v170, v168, s96
    v_perm_b32 v86, v174, v172, s96
    v_perm_b32 v87, v178, v176, s96
    v_perm_b32 v88, v167, v165, s95
    v_perm_b32 v89, v171, v169, s95
    v_perm_b32 v90, v175, v173, s95
    v_perm_b32 v91, v179, v177, s95
    v_perm_b32 v92, v167, v165, s96
    v_perm_b32 v93, v171, v169, s96
    v_perm_b32 v94, v175, v173, s96
    v_perm_b32 v95, v179, v177, s96
    v_accvgpr_write_b32 a64, v80
    v_accvgpr_write_b32 a65, v81
    v_accvgpr_write_b32 a66, v82
    v_accvgpr_write_b32 a67, v83
    v_accvgpr_write_b32 a68, v84
    v_accvgpr_write_b32 a69, v85
    v_accvgpr_write_b32 a70, v86
    v_accvgpr_write_b32 a71, v87
    v_accvgpr_write_b32 a72, v88
    v_accvgpr_write_b32 a73, v89
    v_accvgpr_write_b32 a74, v90
    v_accvgpr_write_b32 a75, v91
    v_accvgpr_write_b32 a76, v92
    v_accvgpr_write_b32 a77, v93
    v_accvgpr_write_b32 a78, v94
    v_accvgpr_write_b32 a79, v95
    v_perm_b32 v80, v182, v180, s95
    v_perm_b32 v81, v186, v184, s95
    v_perm_b32 v82, v190, v188, s95
    v_perm_b32 v83, v194, v192, s95
    v_perm_b32 v84, v182, v180, s96
    v_perm_b32 v85, v186, v184, s96
    v_perm_b32 v86, v190, v188, s96
    v_perm_b32 v87, v194, v192, s96
    v_perm_b32 v88, v183, v181, s95
    v_perm_b32 v89, v187, v185, s95
    v_perm_b32 v90, v191, v189, s95
    v_perm_b32 v91, v195, v193, s95
    v_perm_b32 v92, v183, v181, s96
    v_perm_b32 v93, v187, v185, s96
    v_perm_b32 v94, v191, v189, s96
    v_perm_b32 v95, v195, v193, s96
    v_accvgpr_write_b32 a80, v80
    v_accvgpr_write_b32 a81, v81
    v_accvgpr_write_b32 a82, v82
    v_accvgpr_write_b32 a83, v83
    v_accvgpr_write_b32 a84, v84
    v_accvgpr_write_b32 a85, v85
    v_accvgpr_write_b32 a86, v86
    v_accvgpr_write_b32 a87, v87
    v_accvgpr_write_b32 a88, v88
    v_accvgpr_write_b32 a89, v89
    v_accvgpr_write_b32 a90, v90
    v_accvgpr_write_b32 a91, v91
    v_accvgpr_write_b32 a92, v92
    v_accvgpr_write_b32 a93, v93
    v_accvgpr_write_b32 a94, v94
    v_accvgpr_write_b32 a95, v95
    s_add_u32 s84, s67, 2621440
    buffer_load_dwordx2 v[164:165], v6, s[16:19], s84 offen
    s_add_u32 s84, s67, 2629632
    buffer_load_dwordx2 v[166:167], v6, s[16:19], s84 offen
    s_add_u32 s84, s67, 2637824
    buffer_load_dwordx2 v[168:169], v6, s[16:19], s84 offen
    s_add_u32 s84, s67, 2646016
    buffer_load_dwordx2 v[170:171], v6, s[16:19], s84 offen
    s_add_u32 s84, s67, 2654208
    buffer_load_dwordx2 v[172:173], v6, s[16:19], s84 offen
    s_add_u32 s84, s67, 2662400
    buffer_load_dwordx2 v[174:175], v6, s[16:19], s84 offen
    s_add_u32 s84, s67, 2670592
    buffer_load_dwordx2 v[176:177], v6, s[16:19], s84 offen
    s_add_u32 s84, s67, 2678784
    buffer_load_dwordx2 v[178:179], v6, s[16:19], s84 offen
    s_add_u32 s84, s67, 2883584
    buffer_load_dwordx2 v[180:181], v6, s[16:19], s84 offen
    s_add_u32 s84, s67, 2891776
    buffer_load_dwordx2 v[182:183], v6, s[16:19], s84 offen
    s_add_u32 s84, s67, 2899968
    buffer_load_dwordx2 v[184:185], v6, s[16:19], s84 offen
    s_add_u32 s84, s67, 2908160
    buffer_load_dwordx2 v[186:187], v6, s[16:19], s84 offen
    s_add_u32 s84, s67, 2916352
    buffer_load_dwordx2 v[188:189], v6, s[16:19], s84 offen
    s_add_u32 s84, s67, 2924544
    buffer_load_dwordx2 v[190:191], v6, s[16:19], s84 offen
    s_add_u32 s84, s67, 2932736
    buffer_load_dwordx2 v[192:193], v6, s[16:19], s84 offen
    s_add_u32 s84, s67, 2940928
    buffer_load_dwordx2 v[194:195], v6, s[16:19], s84 offen
    s_waitcnt vmcnt(32)
    v_perm_b32 v80, v102, v100, s95
    v_perm_b32 v81, v106, v104, s95
    v_perm_b32 v82, v110, v108, s95
    v_perm_b32 v83, v114, v112, s95
    v_perm_b32 v84, v102, v100, s96
    v_perm_b32 v85, v106, v104, s96
    v_perm_b32 v86, v110, v108, s96
    v_perm_b32 v87, v114, v112, s96
    v_perm_b32 v88, v103, v101, s95
    v_perm_b32 v89, v107, v105, s95
    v_perm_b32 v90, v111, v109, s95
    v_perm_b32 v91, v115, v113, s95
    v_perm_b32 v92, v103, v101, s96
    v_perm_b32 v93, v107, v105, s96
    v_perm_b32 v94, v111, v109, s96
    v_perm_b32 v95, v115, v113, s96
    v_accvgpr_write_b32 a96, v80
    v_accvgpr_write_b32 a97, v81
    v_accvgpr_write_b32 a98, v82
    v_accvgpr_write_b32 a99, v83
    v_accvgpr_write_b32 a100, v84
    v_accvgpr_write_b32 a101, v85
    v_accvgpr_write_b32 a102, v86
    v_accvgpr_write_b32 a103, v87
    v_accvgpr_write_b32 a104, v88
    v_accvgpr_write_b32 a105, v89
    v_accvgpr_write_b32 a106, v90
    v_accvgpr_write_b32 a107, v91
    v_accvgpr_write_b32 a108, v92
    v_accvgpr_write_b32 a109, v93
    v_accvgpr_write_b32 a110, v94
    v_accvgpr_write_b32 a111, v95
    v_perm_b32 v80, v118, v116, s95
    v_perm_b32 v81, v122, v120, s95
    v_perm_b32 v82, v126, v124, s95
    v_perm_b32 v83, v130, v128, s95
    v_perm_b32 v84, v118, v116, s96
    v_perm_b32 v85, v122, v120, s96
    v_perm_b32 v86, v126, v124, s96
    v_perm_b32 v87, v130, v128, s96
    v_perm_b32 v88, v119, v117, s95
    v_perm_b32 v89, v123, v121, s95
    v_perm_b32 v90, v127, v125, s95
    v_perm_b32 v91, v131, v129, s95
    v_perm_b32 v92, v119, v117, s96
    v_perm_b32 v93, v123, v121, s96
    v_perm_b32 v94, v127, v125, s96
    v_perm_b32 v95, v131, v129, s96
    v_accvgpr_write_b32 a112, v80
    v_accvgpr_write_b32 a113, v81
    v_accvgpr_write_b32 a114, v82
    v_accvgpr_write_b32 a115, v83
    v_accvgpr_write_b32 a116, v84
    v_accvgpr_write_b32 a117, v85
    v_accvgpr_write_b32 a118, v86
    v_accvgpr_write_b32 a119, v87
    v_accvgpr_write_b32 a120, v88
    v_accvgpr_write_b32 a121, v89
    v_accvgpr_write_b32 a122, v90
    v_accvgpr_write_b32 a123, v91
    v_accvgpr_write_b32 a124, v92
    v_accvgpr_write_b32 a125, v93
    v_accvgpr_write_b32 a126, v94
    v_accvgpr_write_b32 a127, v95
    s_add_u32 s84, s67, 3145728
    buffer_load_dwordx2 v[100:101], v6, s[16:19], s84 offen
    s_add_u32 s84, s67, 3153920
    buffer_load_dwordx2 v[102:103], v6, s[16:19], s84 offen
    s_add_u32 s84, s67, 3162112
    buffer_load_dwordx2 v[104:105], v6, s[16:19], s84 offen
    s_add_u32 s84, s67, 3170304
    buffer_load_dwordx2 v[106:107], v6, s[16:19], s84 offen
    s_add_u32 s84, s67, 3178496
    buffer_load_dwordx2 v[108:109], v6, s[16:19], s84 offen
    s_add_u32 s84, s67, 3186688
    buffer_load_dwordx2 v[110:111], v6, s[16:19], s84 offen
    s_add_u32 s84, s67, 3194880
    buffer_load_dwordx2 v[112:113], v6, s[16:19], s84 offen
    s_add_u32 s84, s67, 3203072
    buffer_load_dwordx2 v[114:115], v6, s[16:19], s84 offen
    s_add_u32 s84, s67, 3407872
    buffer_load_dwordx2 v[116:117], v6, s[16:19], s84 offen
    s_add_u32 s84, s67, 3416064
    buffer_load_dwordx2 v[118:119], v6, s[16:19], s84 offen
    s_add_u32 s84, s67, 3424256
    buffer_load_dwordx2 v[120:121], v6, s[16:19], s84 offen
    s_add_u32 s84, s67, 3432448
    buffer_load_dwordx2 v[122:123], v6, s[16:19], s84 offen
    s_add_u32 s84, s67, 3440640
    buffer_load_dwordx2 v[124:125], v6, s[16:19], s84 offen
    s_add_u32 s84, s67, 3448832
    buffer_load_dwordx2 v[126:127], v6, s[16:19], s84 offen
    s_add_u32 s84, s67, 3457024
    buffer_load_dwordx2 v[128:129], v6, s[16:19], s84 offen
    s_add_u32 s84, s67, 3465216
    buffer_load_dwordx2 v[130:131], v6, s[16:19], s84 offen
    s_waitcnt vmcnt(32)
    v_perm_b32 v80, v134, v132, s95
    v_perm_b32 v81, v138, v136, s95
    v_perm_b32 v82, v142, v140, s95
    v_perm_b32 v83, v146, v144, s95
    v_perm_b32 v84, v134, v132, s96
    v_perm_b32 v85, v138, v136, s96
    v_perm_b32 v86, v142, v140, s96
    v_perm_b32 v87, v146, v144, s96
    v_perm_b32 v88, v135, v133, s95
    v_perm_b32 v89, v139, v137, s95
    v_perm_b32 v90, v143, v141, s95
    v_perm_b32 v91, v147, v145, s95
    v_perm_b32 v92, v135, v133, s96
    v_perm_b32 v93, v139, v137, s96
    v_perm_b32 v94, v143, v141, s96
    v_perm_b32 v95, v147, v145, s96
    v_accvgpr_write_b32 a128, v80
    v_accvgpr_write_b32 a129, v81
    v_accvgpr_write_b32 a130, v82
    v_accvgpr_write_b32 a131, v83
    v_accvgpr_write_b32 a132, v84
    v_accvgpr_write_b32 a133, v85
    v_accvgpr_write_b32 a134, v86
    v_accvgpr_write_b32 a135, v87
    v_accvgpr_write_b32 a136, v88
    v_accvgpr_write_b32 a137, v89
    v_accvgpr_write_b32 a138, v90
    v_accvgpr_write_b32 a139, v91
    v_accvgpr_write_b32 a140, v92
    v_accvgpr_write_b32 a141, v93
    v_accvgpr_write_b32 a142, v94
    v_accvgpr_write_b32 a143, v95
    v_perm_b32 v80, v150, v148, s95
    v_perm_b32 v81, v154, v152, s95
    v_perm_b32 v82, v158, v156, s95
    v_perm_b32 v83, v162, v160, s95
    v_perm_b32 v84, v150, v148, s96
    v_perm_b32 v85, v154, v152, s96
    v_perm_b32 v86, v158, v156, s96
    v_perm_b32 v87, v162, v160, s96
    v_perm_b32 v88, v151, v149, s95
    v_perm_b32 v89, v155, v153, s95
    v_perm_b32 v90, v159, v157, s95
    v_perm_b32 v91, v163, v161, s95
    v_perm_b32 v92, v151, v149, s96
    v_perm_b32 v93, v155, v153, s96
    v_perm_b32 v94, v159, v157, s96
    v_perm_b32 v95, v163, v161, s96
    v_accvgpr_write_b32 a144, v80
    v_accvgpr_write_b32 a145, v81
    v_accvgpr_write_b32 a146, v82
    v_accvgpr_write_b32 a147, v83
    v_accvgpr_write_b32 a148, v84
    v_accvgpr_write_b32 a149, v85
    v_accvgpr_write_b32 a150, v86
    v_accvgpr_write_b32 a151, v87
    v_accvgpr_write_b32 a152, v88
    v_accvgpr_write_b32 a153, v89
    v_accvgpr_write_b32 a154, v90
    v_accvgpr_write_b32 a155, v91
    v_accvgpr_write_b32 a156, v92
    v_accvgpr_write_b32 a157, v93
    v_accvgpr_write_b32 a158, v94
    v_accvgpr_write_b32 a159, v95
    s_add_u32 s84, s67, 3670016
    buffer_load_dwordx2 v[132:133], v6, s[16:19], s84 offen
    s_add_u32 s84, s67, 3678208
    buffer_load_dwordx2 v[134:135], v6, s[16:19], s84 offen
    s_add_u32 s84, s67, 3686400
    buffer_load_dwordx2 v[136:137], v6, s[16:19], s84 offen
    s_add_u32 s84, s67, 3694592
    buffer_load_dwordx2 v[138:139], v6, s[16:19], s84 offen
    s_add_u32 s84, s67, 3702784
    buffer_load_dwordx2 v[140:141], v6, s[16:19], s84 offen
    s_add_u32 s84, s67, 3710976
    buffer_load_dwordx2 v[142:143], v6, s[16:19], s84 offen
    s_add_u32 s84, s67, 3719168
    buffer_load_dwordx2 v[144:145], v6, s[16:19], s84 offen
    s_add_u32 s84, s67, 3727360
    buffer_load_dwordx2 v[146:147], v6, s[16:19], s84 offen
    s_add_u32 s84, s67, 3932160
    buffer_load_dwordx2 v[148:149], v6, s[16:19], s84 offen
    s_add_u32 s84, s67, 3940352
    buffer_load_dwordx2 v[150:151], v6, s[16:19], s84 offen
    s_add_u32 s84, s67, 3948544
    buffer_load_dwordx2 v[152:153], v6, s[16:19], s84 offen
    s_add_u32 s84, s67, 3956736
    buffer_load_dwordx2 v[154:155], v6, s[16:19], s84 offen
    s_add_u32 s84, s67, 3964928
    buffer_load_dwordx2 v[156:157], v6, s[16:19], s84 offen
    s_add_u32 s84, s67, 3973120
    buffer_load_dwordx2 v[158:159], v6, s[16:19], s84 offen
    s_add_u32 s84, s67, 3981312
    buffer_load_dwordx2 v[160:161], v6, s[16:19], s84 offen
    s_add_u32 s84, s67, 3989504
    buffer_load_dwordx2 v[162:163], v6, s[16:19], s84 offen
    s_waitcnt vmcnt(32)
    v_perm_b32 v80, v166, v164, s95
    v_perm_b32 v81, v170, v168, s95
    v_perm_b32 v82, v174, v172, s95
    v_perm_b32 v83, v178, v176, s95
    v_perm_b32 v84, v166, v164, s96
    v_perm_b32 v85, v170, v168, s96
    v_perm_b32 v86, v174, v172, s96
    v_perm_b32 v87, v178, v176, s96
    v_perm_b32 v88, v167, v165, s95
    v_perm_b32 v89, v171, v169, s95
    v_perm_b32 v90, v175, v173, s95
    v_perm_b32 v91, v179, v177, s95
    v_perm_b32 v92, v167, v165, s96
    v_perm_b32 v93, v171, v169, s96
    v_perm_b32 v94, v175, v173, s96
    v_perm_b32 v95, v179, v177, s96
    v_accvgpr_write_b32 a160, v80
    v_accvgpr_write_b32 a161, v81
    v_accvgpr_write_b32 a162, v82
    v_accvgpr_write_b32 a163, v83
    v_accvgpr_write_b32 a164, v84
    v_accvgpr_write_b32 a165, v85
    v_accvgpr_write_b32 a166, v86
    v_accvgpr_write_b32 a167, v87
    v_accvgpr_write_b32 a168, v88
    v_accvgpr_write_b32 a169, v89
    v_accvgpr_write_b32 a170, v90
    v_accvgpr_write_b32 a171, v91
    v_accvgpr_write_b32 a172, v92
    v_accvgpr_write_b32 a173, v93
    v_accvgpr_write_b32 a174, v94
    v_accvgpr_write_b32 a175, v95
    v_perm_b32 v80, v182, v180, s95
    v_perm_b32 v81, v186, v184, s95
    v_perm_b32 v82, v190, v188, s95
    v_perm_b32 v83, v194, v192, s95
    v_perm_b32 v84, v182, v180, s96
    v_perm_b32 v85, v186, v184, s96
    v_perm_b32 v86, v190, v188, s96
    v_perm_b32 v87, v194, v192, s96
    v_perm_b32 v88, v183, v181, s95
    v_perm_b32 v89, v187, v185, s95
    v_perm_b32 v90, v191, v189, s95
    v_perm_b32 v91, v195, v193, s95
    v_perm_b32 v92, v183, v181, s96
    v_perm_b32 v93, v187, v185, s96
    v_perm_b32 v94, v191, v189, s96
    v_perm_b32 v95, v195, v193, s96
    v_accvgpr_write_b32 a176, v80
    v_accvgpr_write_b32 a177, v81
    v_accvgpr_write_b32 a178, v82
    v_accvgpr_write_b32 a179, v83
    v_accvgpr_write_b32 a180, v84
    v_accvgpr_write_b32 a181, v85
    v_accvgpr_write_b32 a182, v86
    v_accvgpr_write_b32 a183, v87
    v_accvgpr_write_b32 a184, v88
    v_accvgpr_write_b32 a185, v89
    v_accvgpr_write_b32 a186, v90
    v_accvgpr_write_b32 a187, v91
    v_accvgpr_write_b32 a188, v92
    v_accvgpr_write_b32 a189, v93
    v_accvgpr_write_b32 a190, v94
    v_accvgpr_write_b32 a191, v95
    s_waitcnt vmcnt(16)
    v_perm_b32 v80, v102, v100, s95
    v_perm_b32 v81, v106, v104, s95
    v_perm_b32 v82, v110, v108, s95
    v_perm_b32 v83, v114, v112, s95
    v_perm_b32 v84, v102, v100, s96
    v_perm_b32 v85, v106, v104, s96
    v_perm_b32 v86, v110, v108, s96
    v_perm_b32 v87, v114, v112, s96
    v_perm_b32 v88, v103, v101, s95
    v_perm_b32 v89, v107, v105, s95
    v_perm_b32 v90, v111, v109, s95
    v_perm_b32 v91, v115, v113, s95
    v_perm_b32 v92, v103, v101, s96
    v_perm_b32 v93, v107, v105, s96
    v_perm_b32 v94, v111, v109, s96
    v_perm_b32 v95, v115, v113, s96
    v_accvgpr_write_b32 a192, v80
    v_accvgpr_write_b32 a193, v81
    v_accvgpr_write_b32 a194, v82
    v_accvgpr_write_b32 a195, v83
    v_accvgpr_write_b32 a196, v84
    v_accvgpr_write_b32 a197, v85
    v_accvgpr_write_b32 a198, v86
    v_accvgpr_write_b32 a199, v87
    v_accvgpr_write_b32 a200, v88
    v_accvgpr_write_b32 a201, v89
    v_accvgpr_write_b32 a202, v90
    v_accvgpr_write_b32 a203, v91
    v_accvgpr_write_b32 a204, v92
    v_accvgpr_write_b32 a205, v93
    v_accvgpr_write_b32 a206, v94
    v_accvgpr_write_b32 a207, v95
    v_perm_b32 v80, v118, v116, s95
    v_perm_b32 v81, v122, v120, s95
    v_perm_b32 v82, v126, v124, s95
    v_perm_b32 v83, v130, v128, s95
    v_perm_b32 v84, v118, v116, s96
    v_perm_b32 v85, v122, v120, s96
    v_perm_b32 v86, v126, v124, s96
    v_perm_b32 v87, v130, v128, s96
    v_perm_b32 v88, v119, v117, s95
    v_perm_b32 v89, v123, v121, s95
    v_perm_b32 v90, v127, v125, s95
    v_perm_b32 v91, v131, v129, s95
    v_perm_b32 v92, v119, v117, s96
    v_perm_b32 v93, v123, v121, s96
    v_perm_b32 v94, v127, v125, s96
    v_perm_b32 v95, v131, v129, s96
    v_accvgpr_write_b32 a208, v80
    v_accvgpr_write_b32 a209, v81
    v_accvgpr_write_b32 a210, v82
    v_accvgpr_write_b32 a211, v83
    v_accvgpr_write_b32 a212, v84
    v_accvgpr_write_b32 a213, v85
    v_accvgpr_write_b32 a214, v86
    v_accvgpr_write_b32 a215, v87
    v_accvgpr_write_b32 a216, v88
    v_accvgpr_write_b32 a217, v89
    v_accvgpr_write_b32 a218, v90
    v_accvgpr_write_b32 a219, v91
    v_accvgpr_write_b32 a220, v92
    v_accvgpr_write_b32 a221, v93
    v_accvgpr_write_b32 a222, v94
    v_accvgpr_write_b32 a223, v95
    s_waitcnt vmcnt(0)
    v_perm_b32 v80, v134, v132, s95
    v_perm_b32 v81, v138, v136, s95
    v_perm_b32 v82, v142, v140, s95
    v_perm_b32 v83, v146, v144, s95
    v_perm_b32 v84, v134, v132, s96
    v_perm_b32 v85, v138, v136, s96
    v_perm_b32 v86, v142, v140, s96
    v_perm_b32 v87, v146, v144, s96
    v_perm_b32 v88, v135, v133, s95
    v_perm_b32 v89, v139, v137, s95
    v_perm_b32 v90, v143, v141, s95
    v_perm_b32 v91, v147, v145, s95
    v_perm_b32 v92, v135, v133, s96
    v_perm_b32 v93, v139, v137, s96
    v_perm_b32 v94, v143, v141, s96
    v_perm_b32 v95, v147, v145, s96
    v_accvgpr_write_b32 a224, v80
    v_accvgpr_write_b32 a225, v81
    v_accvgpr_write_b32 a226, v82
    v_accvgpr_write_b32 a227, v83
    v_accvgpr_write_b32 a228, v84
    v_accvgpr_write_b32 a229, v85
    v_accvgpr_write_b32 a230, v86
    v_accvgpr_write_b32 a231, v87
    v_accvgpr_write_b32 a232, v88
    v_accvgpr_write_b32 a233, v89
    v_accvgpr_write_b32 a234, v90
    v_accvgpr_write_b32 a235, v91
    v_accvgpr_write_b32 a236, v92
    v_accvgpr_write_b32 a237, v93
    v_accvgpr_write_b32 a238, v94
    v_accvgpr_write_b32 a239, v95
    v_perm_b32 v80, v150, v148, s95
    v_perm_b32 v81, v154, v152, s95
    v_perm_b32 v82, v158, v156, s95
    v_perm_b32 v83, v162, v160, s95
    v_perm_b32 v84, v150, v148, s96
    v_perm_b32 v85, v154, v152, s96
    v_perm_b32 v86, v158, v156, s96
    v_perm_b32 v87, v162, v160, s96
    v_perm_b32 v88, v151, v149, s95
    v_perm_b32 v89, v155, v153, s95
    v_perm_b32 v90, v159, v157, s95
    v_perm_b32 v91, v163, v161, s95
    v_perm_b32 v92, v151, v149, s96
    v_perm_b32 v93, v155, v153, s96
    v_perm_b32 v94, v159, v157, s96
    v_perm_b32 v95, v163, v161, s96
    v_accvgpr_write_b32 a240, v80
    v_accvgpr_write_b32 a241, v81
    v_accvgpr_write_b32 a242, v82
    v_accvgpr_write_b32 a243, v83
    v_accvgpr_write_b32 a244, v84
    v_accvgpr_write_b32 a245, v85
    v_accvgpr_write_b32 a246, v86
    v_accvgpr_write_b32 a247, v87
    v_accvgpr_write_b32 a248, v88
    v_accvgpr_write_b32 a249, v89
    v_accvgpr_write_b32 a250, v90
    v_accvgpr_write_b32 a251, v91
    v_accvgpr_write_b32 a252, v92
    v_accvgpr_write_b32 a253, v93
    v_accvgpr_write_b32 a254, v94
    v_accvgpr_write_b32 a255, v95
    v_mov_b32 v16, 20
    s_mov_b32 s83, 0
WD_7:
    buffer_load_dword v17, v16, s[12:15], 0 offen sc1
    s_add_u32 s83, s83, 1
    s_cmp_gt_u32 s83, 0x400000
    s_cbranch_scc1 B_fail
    s_waitcnt vmcnt(0)
    v_readfirstlane_b32 s84, v17
    s_nop 0
    s_cmp_ge_u32 s84, 4
    s_cbranch_scc1 WDd_8
    s_sleep 2
    s_branch WD_7
WDd_8:
    v_lshrrev_b32 v18, 1, v4
    s_mov_b32 s85, 0x7210000
    s_mov_b32 s83, 0
WX_9:
    buffer_load_dwordx2 v[16:17], v18, s[8:11], s85 offen sc1
    s_add_u32 s83, s83, 1
    s_cmp_gt_u32 s83, 0x400000
    s_cbranch_scc1 B_fail
    s_waitcnt vmcnt(0)
    v_min_u32 v16, v16, v17
    v_cmp_eq_u32 vcc, 0, v16
    s_cbranch_vccz WXd_10
    s_sleep 2
    s_branch WX_9
WXd_10:
    s_lshr_b32 s87, s66, 4
    s_cmp_eq_u32 s87, 1
    s_cbranch_scc1 A_vloop
    s_lshl_b32 s70, s61, 13
    s_lshl_b32 s69, s64, 15
    s_add_u32 m0, s70, 0
    s_nop 0
    buffer_load_dwordx4 v5, s[8:11], s69 offen offset:0 sc1 lds
    s_add_u32 m0, s70, 960
    s_nop 0
    buffer_load_dwordx4 v5, s[8:11], s69 offen offset:64 sc1 lds
    s_add_u32 m0, s70, 1920
    s_nop 0
    buffer_load_dwordx4 v5, s[8:11], s69 offen offset:128 sc1 lds
    s_add_u32 m0, s70, 2880
    s_nop 0
    buffer_load_dwordx4 v5, s[8:11], s69 offen offset:192 sc1 lds
    s_add_u32 m0, s70, 3840
    s_nop 0
    buffer_load_dwordx4 v5, s[8:11], s69 offen offset:256 sc1 lds
    s_add_u32 m0, s70, 4800
    s_nop 0
    buffer_load_dwordx4 v5, s[8:11], s69 offen offset:320 sc1 lds
    s_add_u32 m0, s70, 5760
    s_nop 0
    buffer_load_dwordx4 v5, s[8:11], s69 offen offset:384 sc1 lds
    s_add_u32 m0, s70, 6720
    s_nop 0
    buffer_load_dwordx4 v5, s[8:11], s69 offen offset:448 sc1 lds
    s_mov_b32 s72, 0
    v_mov_b32 v7, v4
    s_waitcnt vmcnt(0)
    s_barrier
Aqk_loop:
    s_add_u32 s85, s64, s65
    s_min_u32 s85, s85, 63
    s_lshl_b32 s69, s85, 15
    s_xor_b32 s70, s70, 32768
    ds_read_b128 v[16:19], v7 offset:0
    ds_read_b128 v[20:23], v7 offset:16384
    ds_read_b128 v[24:27], v7 offset:1024
    ds_read_b128 v[28:31], v7 offset:17408
    s_add_u32 m0, s70, 0
    s_nop 0
    buffer_load_dwordx4 v5, s[8:11], s69 offen offset:0 sc1 lds
    s_add_u32 m0, s70, 960
    s_nop 0
    buffer_load_dwordx4 v5, s[8:11], s69 offen offset:64 sc1 lds
    s_add_u32 m0, s70, 1920
    s_nop 0
    buffer_load_dwordx4 v5, s[8:11], s69 offen offset:128 sc1 lds
    s_add_u32 m0, s70, 2880
    s_nop 0
    buffer_load_dwordx4 v5, s[8:11], s69 offen offset:192 sc1 lds
    s_add_u32 m0, s70, 3840
    s_nop 0
    buffer_load_dwordx4 v5, s[8:11], s69 offen offset:256 sc1 lds
    s_add_u32 m0, s70, 4800
    s_nop 0
    buffer_load_dwordx4 v5, s[8:11], s69 offen offset:320 sc1 lds
    s_add_u32 m0, s70, 5760
    s_nop 0
    buffer_load_dwordx4 v5, s[8:11], s69 offen offset:384 sc1 lds
    s_add_u32 m0, s70, 6720
    s_nop 0
    buffer_load_dwordx4 v5, s[8:11], s69 offen offset:448 sc1 lds
    ds_read_b128 v[32:35], v7 offset:2048
    ds_read_b128 v[36:39], v7 offset:18432
    s_waitcnt lgkmcnt(4)
    v_mfma_f32_16x16x32_bf16 v[48:51], a[0:3], v[16:19], 0
    v_mfma_f32_16x16x32_bf16 v[52:55], a[4:7], v[16:19], 0
    v_mfma_f32_16x16x32_bf16 v[56:59], a[8:11], v[16:19], 0
    v_mfma_f32_16x16x32_bf16 v[60:63], a[12:15], v[16:19], 0
    v_mfma_f32_16x16x32_bf16 v[64:67], a[0:3], v[20:23], 0
    v_mfma_f32_16x16x32_bf16 v[68:71], a[4:7], v[20:23], 0
    v_mfma_f32_16x16x32_bf16 v[72:75], a[8:11], v[20:23], 0
    v_mfma_f32_16x16x32_bf16 v[76:79], a[12:15], v[20:23], 0
    ds_read_b128 v[16:19], v7 offset:3072
    ds_read_b128 v[20:23], v7 offset:19456
    s_waitcnt lgkmcnt(4)
    v_mfma_f32_16x16x32_bf16 v[48:51], a[16:19], v[24:27], v[48:51]
    v_mfma_f32_16x16x32_bf16 v[52:55], a[20:23], v[24:27], v[52:55]
    v_mfma_f32_16x16x32_bf16 v[56:59], a[24:27], v[24:27], v[56:59]
    v_mfma_f32_16x16x32_bf16 v[60:63], a[28:31], v[24:27], v[60:63]
    v_mfma_f32_16x16x32_bf16 v[64:67], a[16:19], v[28:31], v[64:67]
    v_mfma_f32_16x16x32_bf16 v[68:71], a[20:23], v[28:31], v[68:71]
    v_mfma_f32_16x16x32_bf16 v[72:75], a[24:27], v[28:31], v[72:75]
    v_mfma_f32_16x16x32_bf16 v[76:79], a[28:31], v[28:31], v[76:79]
    ds_read_b128 v[24:27], v7 offset:4096
    ds_read_b128 v[28:31], v7 offset:20480
    s_waitcnt lgkmcnt(4)
    v_mfma_f32_16x16x32_bf16 v[48:51], a[32:35], v[32:35], v[48:51]
    v_mfma_f32_16x16x32_bf16 v[52:55], a[36:39], v[32:35], v[52:55]
    v_mfma_f32_16x16x32_bf16 v[56:59], a[40:43], v[32:35], v[56:59]
    v_mfma_f32_16x16x32_bf16 v[60:63], a[44:47], v[32:35], v[60:63]
    v_mfma_f32_16x16x32_bf16 v[64:67], a[32:35], v[36:39], v[64:67]
    v_mfma_f32_16x16x32_bf16 v[68:71], a[36:39], v[36:39], v[68:71]
    v_mfma_f32_16x16x32_bf16 v[72:75], a[40:43], v[36:39], v[72:75]
    v_mfma_f32_16x16x32_bf16 v[76:79], a[44:47], v[36:39], v[76:79]
    ds_read_b128 v[32:35], v7 offset:5120
    ds_read_b128 v[36:39], v7 offset:21504
    s_waitcnt lgkmcnt(4)
    v_mfma_f32_16x16x32_bf16 v[48:51], a[48:51], v[16:19], v[48:51]
    v_mfma_f32_16x16x32_bf16 v[52:55], a[52:55], v[16:19], v[52:55]
    v_mfma_f32_16x16x32_bf16 v[56:59], a[56:59], v[16:19], v[56:59]
    v_mfma_f32_16x16x32_bf16 v[60:63], a[60:63], v[16:19], v[60:63]
    v_mfma_f32_16x16x32_bf16 v[64:67], a[48:51], v[20:23], v[64:67]
    v_mfma_f32_16x16x32_bf16 v[68:71], a[52:55], v[20:23], v[68:71]
    v_mfma_f32_16x16x32_bf16 v[72:75], a[56:59], v[20:23], v[72:75]
    v_mfma_f32_16x16x32_bf16 v[76:79], a[60:63], v[20:23], v[76:79]
    ds_read_b128 v[16:19], v7 offset:6144
    ds_read_b128 v[20:23], v7 offset:22528
    s_waitcnt lgkmcnt(4)
    v_mfma_f32_16x16x32_bf16 v[48:51], a[64:67], v[24:27], v[48:51]
    v_mfma_f32_16x16x32_bf16 v[52:55], a[68:71], v[24:27], v[52:55]
    v_mfma_f32_16x16x32_bf16 v[56:59], a[72:75], v[24:27], v[56:59]
    v_mfma_f32_16x16x32_bf16 v[60:63], a[76:79], v[24:27], v[60:63]
    v_mfma_f32_16x16x32_bf16 v[64:67], a[64:67], v[28:31], v[64:67]
    v_mfma_f32_16x16x32_bf16 v[68:71], a[68:71], v[28:31], v[68:71]
    v_mfma_f32_16x16x32_bf16 v[72:75], a[72:75], v[28:31], v[72:75]
    v_mfma_f32_16x16x32_bf16 v[76:79], a[76:79], v[28:31], v[76:79]
    ds_read_b128 v[24:27], v7 offset:7168
    ds_read_b128 v[28:31], v7 offset:23552
    s_waitcnt lgkmcnt(4)
    v_mfma_f32_16x16x32_bf16 v[48:51], a[80:83], v[32:35], v[48:51]
    v_mfma_f32_16x16x32_bf16 v[52:55], a[84:87], v[32:35], v[52:55]
    v_mfma_f32_16x16x32_bf16 v[56:59], a[88:91], v[32:35], v[56:59]
    v_mfma_f32_16x16x32_bf16 v[60:63], a[92:95], v[32:35], v[60:63]
    v_mfma_f32_16x16x32_bf16 v[64:67], a[80:83], v[36:39], v[64:67]
    v_mfma_f32_16x16x32_bf16 v[68:71], a[84:87], v[36:39], v[68:71]
    v_mfma_f32_16x16x32_bf16 v[72:75], a[88:91], v[36:39], v[72:75]
    v_mfma_f32_16x16x32_bf16 v[76:79], a[92:95], v[36:39], v[76:79]
    ds_read_b128 v[32:35], v7 offset:8192
    ds_read_b128 v[36:39], v7 offset:24576
    s_waitcnt lgkmcnt(4)
    v_mfma_f32_16x16x32_bf16 v[48:51], a[96:99], v[16:19], v[48:51]
    v_mfma_f32_16x16x32_bf16 v[52:55], a[100:103], v[16:19], v[52:55]
    v_mfma_f32_16x16x32_bf16 v[56:59], a[104:107], v[16:19], v[56:59]
    v_mfma_f32_16x16x32_bf16 v[60:63], a[108:111], v[16:19], v[60:63]
    v_mfma_f32_16x16x32_bf16 v[64:67], a[96:99], v[20:23], v[64:67]
    v_mfma_f32_16x16x32_bf16 v[68:71], a[100:103], v[20:23], v[68:71]
    v_mfma_f32_16x16x32_bf16 v[72:75], a[104:107], v[20:23], v[72:75]
    v_mfma_f32_16x16x32_bf16 v[76:79], a[108:111], v[20:23], v[76:79]
    ds_read_b128 v[16:19], v7 offset:9216
    ds_read_b128 v[20:23], v7 offset:25600
    s_waitcnt lgkmcnt(4)
    v_mfma_f32_16x16x32_bf16 v[48:51], a[112:115], v[24:27], v[48:51]
    v_mfma_f32_16x16x32_bf16 v[52:55], a[116:119], v[24:27], v[52:55]
    v_mfma_f32_16x16x32_bf16 v[56:59], a[120:123], v[24:27], v[56:59]
    v_mfma_f32_16x16x32_bf16 v[60:63], a[124:127], v[24:27], v[60:63]
    v_mfma_f32_16x16x32_bf16 v[64:67], a[112:115], v[28:31], v[64:67]
    v_mfma_f32_16x16x32_bf16 v[68:71], a[116:119], v[28:31], v[68:71]
    v_mfma_f32_16x16x32_bf16 v[72:75], a[120:123], v[28:31], v[72:75]
    v_mfma_f32_16x16x32_bf16 v[76:79], a[124:127], v[28:31], v[76:79]
    ds_read_b128 v[24:27], v7 offset:10240
    ds_read_b128 v[28:31], v7 offset:26624
    s_waitcnt lgkmcnt(4)
    v_mfma_f32_16x16x32_bf16 v[48:51], a[128:131], v[32:35], v[48:51]
    v_mfma_f32_16x16x32_bf16 v[52:55], a[132:135], v[32:35], v[52:55]
    v_mfma_f32_16x16x32_bf16 v[56:59], a[136:139], v[32:35], v[56:59]
    v_mfma_f32_16x16x32_bf16 v[60:63], a[140:143], v[32:35], v[60:63]
    v_mfma_f32_16x16x32_bf16 v[64:67], a[128:131], v[36:39], v[64:67]
    v_mfma_f32_16x16x32_bf16 v[68:71], a[132:135], v[36:39], v[68:71]
    v_mfma_f32_16x16x32_bf16 v[72:75], a[136:139], v[36:39], v[72:75]
    v_mfma_f32_16x16x32_bf16 v[76:79], a[140:143], v[36:39], v[76:79]
    s_waitcnt vmcnt(8)
    s_barrier
    s_or_b32 s84, s61, s72
    s_cmp_lg_u32 s84, 0x100
    s_cbranch_scc1 Aqk_nf_11
    s_mov_b64 exec, 1
    v_mov_b32 v250, 0
    v_mov_b32 v251, 1
    buffer_store_dword v251, v250, s[8:11], s71 offen sc1
    s_mov_b64 exec, -1
Aqk_nf_11:
    ds_read_b128 v[32:35], v7 offset:11264
    ds_read_b128 v[36:39], v7 offset:27648
    s_waitcnt lgkmcnt(4)
    v_mfma_f32_16x16x32_bf16 v[48:51], a[144:147], v[16:19], v[48:51]
    v_mfma_f32_16x16x32_bf16 v[52:55], a[148:151], v[16:19], v[52:55]
    v_mfma_f32_16x16x32_bf16 v[56:59], a[152:155], v[16:19], v[56:59]
    v_mfma_f32_16x16x32_bf16 v[60:63], a[156:159], v[16:19], v[60:63]
    v_mfma_f32_16x16x32_bf16 v[64:67], a[144:147], v[20:23], v[64:67]
    v_mfma_f32_16x16x32_bf16 v[68:71], a[148:151], v[20:23], v[68:71]
    v_mfma_f32_16x16x32_bf16 v[72:75], a[152:155], v[20:23], v[72:75]
    v_mfma_f32_16x16x32_bf16 v[76:79], a[156:159], v[20:23], v[76:79]
    ds_read_b128 v[16:19], v7 offset:12288
    ds_read_b128 v[20:23], v7 offset:28672
    s_waitcnt lgkmcnt(4)
    v_mfma_f32_16x16x32_bf16 v[48:51], a[160:163], v[24:27], v[48:51]
    v_mfma_f32_16x16x32_bf16 v[52:55], a[164:167], v[24:27], v[52:55]
    v_mfma_f32_16x16x32_bf16 v[56:59], a[168:171], v[24:27], v[56:59]
    v_mfma_f32_16x16x32_bf16 v[60:63], a[172:175], v[24:27], v[60:63]
    v_mfma_f32_16x16x32_bf16 v[64:67], a[160:163], v[28:31], v[64:67]
    v_mfma_f32_16x16x32_bf16 v[68:71], a[164:167], v[28:31], v[68:71]
    v_mfma_f32_16x16x32_bf16 v[72:75], a[168:171], v[28:31], v[72:75]
    v_mfma_f32_16x16x32_bf16 v[76:79], a[172:175], v[28:31], v[76:79]
    ds_read_b128 v[24:27], v7 offset:13312
    ds_read_b128 v[28:31], v7 offset:29696
    s_waitcnt lgkmcnt(4)
    v_mfma_f32_16x16x32_bf16 v[48:51], a[176:179], v[32:35], v[48:51]
    v_mfma_f32_16x16x32_bf16 v[52:55], a[180:183], v[32:35], v[52:55]
    v_mfma_f32_16x16x32_bf16 v[56:59], a[184:187], v[32:35], v[56:59]
    v_mfma_f32_16x16x32_bf16 v[60:63], a[188:191], v[32:35], v[60:63]
    v_mfma_f32_16x16x32_bf16 v[64:67], a[176:179], v[36:39], v[64:67]
    v_mfma_f32_16x16x32_bf16 v[68:71], a[180:183], v[36:39], v[68:71]
    v_mfma_f32_16x16x32_bf16 v[72:75], a[184:187], v[36:39], v[72:75]
    v_mfma_f32_16x16x32_bf16 v[76:79], a[188:191], v[36:39], v[76:79]
    ds_read_b128 v[32:35], v7 offset:14336
    ds_read_b128 v[36:39], v7 offset:30720
    s_waitcnt lgkmcnt(4)
    v_mfma_f32_16x16x32_bf16 v[48:51], a[192:195], v[16:19], v[48:51]
    v_mfma_f32_16x16x32_bf16 v[52:55], a[196:199], v[16:19], v[52:55]
    v_mfma_f32_16x16x32_bf16 v[56:59], a[200:203], v[16:19], v[56:59]
    v_mfma_f32_16x16x32_bf16 v[60:63], a[204:207], v[16:19], v[60:63]
    v_mfma_f32_16x16x32_bf16 v[64:67], a[192:195], v[20:23], v[64:67]
    v_mfma_f32_16x16x32_bf16 v[68:71], a[196:199], v[20:23], v[68:71]
    v_mfma_f32_16x16x32_bf16 v[72:75], a[200:203], v[20:23], v[72:75]
    v_mfma_f32_16x16x32_bf16 v[76:79], a[204:207], v[20:23], v[76:79]
    ds_read_b128 v[16:19], v7 offset:15360
    ds_read_b128 v[20:23], v7 offset:31744
    s_waitcnt lgkmcnt(4)
    v_mfma_f32_16x16x32_bf16 v[48:51], a[208:211], v[24:27], v[48:51]
    v_mfma_f32_16x16x32_bf16 v[52:55], a[212:215], v[24:27], v[52:55]
    v_mfma_f32_16x16x32_bf16 v[56:59], a[216:219], v[24:27], v[56:59]
    v_mfma_f32_16x16x32_bf16 v[60:63], a[220:223], v[24:27], v[60:63]
    v_mfma_f32_16x16x32_bf16 v[64:67], a[208:211], v[28:31], v[64:67]
    v_mfma_f32_16x16x32_bf16 v[68:71], a[212:215], v[28:31], v[68:71]
    v_mfma_f32_16x16x32_bf16 v[72:75], a[216:219], v[28:31], v[72:75]
    v_mfma_f32_16x16x32_bf16 v[76:79], a[220:223], v[28:31], v[76:79]
    s_waitcnt lgkmcnt(2)
    v_mfma_f32_16x16x32_bf16 v[48:51], a[224:227], v[32:35], v[48:51]
    v_mfma_f32_16x16x32_bf16 v[52:55], a[228:231], v[32:35], v[52:55]
    v_mfma_f32_16x16x32_bf16 v[56:59], a[232:235], v[32:35], v[56:59]
    v_mfma_f32_16x16x32_bf16 v[60:63], a[236:239], v[32:35], v[60:63]
    v_mfma_f32_16x16x32_bf16 v[64:67], a[224:227], v[36:39], v[64:67]
    v_mfma_f32_16x16x32_bf16 v[68:71], a[228:231], v[36:39], v[68:71]
    v_mfma_f32_16x16x32_bf16 v[72:75], a[232:235], v[36:39], v[72:75]
    v_mfma_f32_16x16x32_bf16 v[76:79], a[236:239], v[36:39], v[76:79]
    s_waitcnt lgkmcnt(0)
    v_mfma_f32_16x16x32_bf16 v[48:51], a[240:243], v[16:19], v[48:51]
    v_mfma_f32_16x16x32_bf16 v[52:55], a[244:247], v[16:19], v[52:55]
    v_mfma_f32_16x16x32_bf16 v[56:59], a[248:251], v[16:19], v[56:59]
    v_mfma_f32_16x16x32_bf16 v[60:63], a[252:255], v[16:19], v[60:63]
    v_mfma_f32_16x16x32_bf16 v[64:67], a[240:243], v[20:23], v[64:67]
    v_mfma_f32_16x16x32_bf16 v[68:71], a[244:247], v[20:23], v[68:71]
    v_mfma_f32_16x16x32_bf16 v[72:75], a[248:251], v[20:23], v[72:75]
    v_mfma_f32_16x16x32_bf16 v[76:79], a[252:255], v[20:23], v[76:79]
    s_waitcnt vmcnt(0)
    s_barrier
    s_lshl_b32 s84, s64, 18
    s_add_u32 s84, s84, s68
    s_add_u32 s85, s84, 4096
    v_cvt_pk_bf16_f32 v80, v48, v52
    v_cvt_pk_bf16_f32 v81, v56, v60
    v_cvt_pk_bf16_f32 v82, v49, v53
    v_cvt_pk_bf16_f32 v83, v57, v61
    v_cvt_pk_bf16_f32 v84, v50, v54
    v_cvt_pk_bf16_f32 v85, v58, v62
    v_cvt_pk_bf16_f32 v86, v51, v55
    v_cvt_pk_bf16_f32 v87, v59, v63
    buffer_store_dwordx4 v[80:83], v4, s[8:11], s84 offen offset:0 sc1
    buffer_store_dwordx4 v[84:87], v4, s[8:11], s84 offen offset:1024 sc1
    v_cvt_pk_bf16_f32 v88, v64, v68
    v_cvt_pk_bf16_f32 v89, v72, v76
    v_cvt_pk_bf16_f32 v90, v65, v69
    v_cvt_pk_bf16_f32 v91, v73, v77
    v_cvt_pk_bf16_f32 v92, v66, v70
    v_cvt_pk_bf16_f32 v93, v74, v78
    v_cvt_pk_bf16_f32 v94, v67, v71
    v_cvt_pk_bf16_f32 v95, v75, v79
    buffer_store_dwordx4 v[88:91], v4, s[8:11], s85 offen offset:0 sc1
    buffer_store_dwordx4 v[92:95], v4, s[8:11], s85 offen offset:1024 sc1
    s_lshl_b32 s84, s64, 5
    s_add_u32 s71, s84, s73
    s_mov_b32 s72, 0x100
    v_xor_b32 v7, 32768, v7
    s_add_u32 s64, s64, s65
    s_cmp_lt_u32 s64, 64
    s_cbranch_scc1 Aqk_loop
    s_waitcnt vmcnt(0)
    s_barrier
    s_cmp_lg_u32 s61, 0
    s_cbranch_scc1 Aqk_nf_12
    s_mov_b64 exec, 1
    v_mov_b32 v250, 0
    v_mov_b32 v251, 1
    buffer_store_dword v251, v250, s[8:11], s71 offen sc1
    s_mov_b64 exec, -1
Aqk_nf_12:
    s_branch A_done
A_vloop:
    s_lshl_b32 s70, s61, 13
    s_lshl_b32 s69, s64, 15
    s_add_u32 m0, s70, 0
    s_nop 0
    buffer_load_dwordx4 v5, s[8:11], s69 offen offset:0 sc1 lds
    s_add_u32 m0, s70, 960
    s_nop 0
    buffer_load_dwordx4 v5, s[8:11], s69 offen offset:64 sc1 lds
    s_add_u32 m0, s70, 1920
    s_nop 0
    buffer_load_dwordx4 v5, s[8:11], s69 offen offset:128 sc1 lds
    s_add_u32 m0, s70, 2880
    s_nop 0
    buffer_load_dwordx4 v5, s[8:11], s69 offen offset:192 sc1 lds
    s_add_u32 m0, s70, 3840
    s_nop 0
    buffer_load_dwordx4 v5, s[8:11], s69 offen offset:256 sc1 lds
    s_add_u32 m0, s70, 4800
    s_nop 0
    buffer_load_dwordx4 v5, s[8:11], s69 offen offset:320 sc1 lds
    s_add_u32 m0, s70, 5760
    s_nop 0
    buffer_load_dwordx4 v5, s[8:11], s69 offen offset:384 sc1 lds
    s_add_u32 m0, s70, 6720
    s_nop 0
    buffer_load_dwordx4 v5, s[8:11], s69 offen offset:448 sc1 lds
    s_mov_b32 s72, 0
    v_mov_b32 v7, v4
    s_waitcnt vmcnt(0)
    s_barrier
Av_loop:
    s_add_u32 s85, s64, s65
    s_min_u32 s85, s85, 63
    s_lshl_b32 s69, s85, 15
    s_xor_b32 s70, s70, 32768
    ds_read_b128 v[16:19], v7 offset:0
    ds_read_b128 v[20:23], v7 offset:16384
    ds_read_b128 v[24:27], v7 offset:1024
    ds_read_b128 v[28:31], v7 offset:17408
    s_add_u32 m0, s70, 0
    s_nop 0
    buffer_load_dwordx4 v5, s[8:11], s69 offen offset:0 sc1 lds
    s_add_u32 m0, s70, 960
    s_nop 0
    buffer_load_dwordx4 v5, s[8:11], s69 offen offset:64 sc1 lds
    s_add_u32 m0, s70, 1920
    s_nop 0
    buffer_load_dwordx4 v5, s[8:11], s69 offen offset:128 sc1 lds
    s_add_u32 m0, s70, 2880
    s_nop 0
    buffer_load_dwordx4 v5, s[8:11], s69 offen offset:192 sc1 lds
    s_add_u32 m0, s70, 3840
    s_nop 0
    buffer_load_dwordx4 v5, s[8:11], s69 offen offset:256 sc1 lds
    s_add_u32 m0, s70, 4800
    s_nop 0
    buffer_load_dwordx4 v5, s[8:11], s69 offen offset:320 sc1 lds
    s_add_u32 m0, s70, 5760
    s_nop 0
    buffer_load_dwordx4 v5, s[8:11], s69 offen offset:384 sc1 lds
    s_add_u32 m0, s70, 6720
    s_nop 0
    buffer_load_dwordx4 v5, s[8:11], s69 offen offset:448 sc1 lds
    ds_read_b128 v[32:35], v7 offset:2048
    ds_read_b128 v[36:39], v7 offset:18432
    s_waitcnt lgkmcnt(4)
    v_mfma_f32_16x16x32_bf16 v[48:51], v[16:19], a[0:3], 0
    v_mfma_f32_16x16x32_bf16 v[52:55], v[16:19], a[4:7], 0
    v_mfma_f32_16x16x32_bf16 v[56:59], v[16:19], a[8:11], 0
    v_mfma_f32_16x16x32_bf16 v[60:63], v[16:19], a[12:15], 0
    v_mfma_f32_16x16x32_bf16 v[64:67], v[20:23], a[0:3], 0
    v_mfma_f32_16x16x32_bf16 v[68:71], v[20:23], a[4:7], 0
    v_mfma_f32_16x16x32_bf16 v[72:75], v[20:23], a[8:11], 0
    v_mfma_f32_16x16x32_bf16 v[76:79], v[20:23], a[12:15], 0
    ds_read_b128 v[16:19], v7 offset:3072
    ds_read_b128 v[20:23], v7 offset:19456
    s_waitcnt lgkmcnt(4)
    v_mfma_f32_16x16x32_bf16 v[48:51], v[24:27], a[16:19], v[48:51]
    v_mfma_f32_16x16x32_bf16 v[52:55], v[24:27], a[20:23], v[52:55]
    v_mfma_f32_16x16x32_bf16 v[56:59], v[24:27], a[24:27], v[56:59]
    v_mfma_f32_16x16x32_bf16 v[60:63], v[24:27], a[28:31], v[60:63]
    v_mfma_f32_16x16x32_bf16 v[64:67], v[28:31], a[16:19], v[64:67]
    v_mfma_f32_16x16x32_bf16 v[68:71], v[28:31], a[20:23], v[68:71]
    v_mfma_f32_16x16x32_bf16 v[72:75], v[28:31], a[24:27], v[72:75]
    v_mfma_f32_16x16x32_bf16 v[76:79], v[28:31], a[28:31], v[76:79]
    ds_read_b128 v[24:27], v7 offset:4096
    ds_read_b128 v[28:31], v7 offset:20480
    s_waitcnt lgkmcnt(4)
    v_mfma_f32_16x16x32_bf16 v[48:51], v[32:35], a[32:35], v[48:51]
    v_mfma_f32_16x16x32_bf16 v[52:55], v[32:35], a[36:39], v[52:55]
    v_mfma_f32_16x16x32_bf16 v[56:59], v[32:35], a[40:43], v[56:59]
    v_mfma_f32_16x16x32_bf16 v[60:63], v[32:35], a[44:47], v[60:63]
    v_mfma_f32_16x16x32_bf16 v[64:67], v[36:39], a[32:35], v[64:67]
    v_mfma_f32_16x16x32_bf16 v[68:71], v[36:39], a[36:39], v[68:71]
    v_mfma_f32_16x16x32_bf16 v[72:75], v[36:39], a[40:43], v[72:75]
    v_mfma_f32_16x16x32_bf16 v[76:79], v[36:39], a[44:47], v[76:79]
    ds_read_b128 v[32:35], v7 offset:5120
    ds_read_b128 v[36:39], v7 offset:21504
    s_waitcnt lgkmcnt(4)
    v_mfma_f32_16x16x32_bf16 v[48:51], v[16:19], a[48:51], v[48:51]
    v_mfma_f32_16x16x32_bf16 v[52:55], v[16:19], a[52:55], v[52:55]
    v_mfma_f32_16x16x32_bf16 v[56:59], v[16:19], a[56:59], v[56:59]
    v_mfma_f32_16x16x32_bf16 v[60:63], v[16:19], a[60:63], v[60:63]
    v_mfma_f32_16x16x32_bf16 v[64:67], v[20:23], a[48:51], v[64:67]
    v_mfma_f32_16x16x32_bf16 v[68:71], v[20:23], a[52:55], v[68:71]
    v_mfma_f32_16x16x32_bf16 v[72:75], v[20:23], a[56:59], v[72:75]
    v_mfma_f32_16x16x32_bf16 v[76:79], v[20:23], a[60:63], v[76:79]
    ds_read_b128 v[16:19], v7 offset:6144
    ds_read_b128 v[20:23], v7 offset:22528
    s_waitcnt lgkmcnt(4)
    v_mfma_f32_16x16x32_bf16 v[48:51], v[24:27], a[64:67], v[48:51]
    v_mfma_f32_16x16x32_bf16 v[52:55], v[24:27], a[68:71], v[52:55]
    v_mfma_f32_16x16x32_bf16 v[56:59], v[24:27], a[72:75], v[56:59]
    v_mfma_f32_16x16x32_bf16 v[60:63], v[24:27], a[76:79], v[60:63]
    v_mfma_f32_16x16x32_bf16 v[64:67], v[28:31], a[64:67], v[64:67]
    v_mfma_f32_16x16x32_bf16 v[68:71], v[28:31], a[68:71], v[68:71]
    v_mfma_f32_16x16x32_bf16 v[72:75], v[28:31], a[72:75], v[72:75]
    v_mfma_f32_16x16x32_bf16 v[76:79], v[28:31], a[76:79], v[76:79]
    ds_read_b128 v[24:27], v7 offset:7168
    ds_read_b128 v[28:31], v7 offset:23552
    s_waitcnt lgkmcnt(4)
    v_mfma_f32_16x16x32_bf16 v[48:51], v[32:35], a[80:83], v[48:51]
    v_mfma_f32_16x16x32_bf16 v[52:55], v[32:35], a[84:87], v[52:55]
    v_mfma_f32_16x16x32_bf16 v[56:59], v[32:35], a[88:91], v[56:59]
    v_mfma_f32_16x16x32_bf16 v[60:63], v[32:35], a[92:95], v[60:63]
    v_mfma_f32_16x16x32_bf16 v[64:67], v[36:39], a[80:83], v[64:67]
    v_mfma_f32_16x16x32_bf16 v[68:71], v[36:39], a[84:87], v[68:71]
    v_mfma_f32_16x16x32_bf16 v[72:75], v[36:39], a[88:91], v[72:75]
    v_mfma_f32_16x16x32_bf16 v[76:79], v[36:39], a[92:95], v[76:79]
    ds_read_b128 v[32:35], v7 offset:8192
    ds_read_b128 v[36:39], v7 offset:24576
    s_waitcnt lgkmcnt(4)
    v_mfma_f32_16x16x32_bf16 v[48:51], v[16:19], a[96:99], v[48:51]
    v_mfma_f32_16x16x32_bf16 v[52:55], v[16:19], a[100:103], v[52:55]
    v_mfma_f32_16x16x32_bf16 v[56:59], v[16:19], a[104:107], v[56:59]
    v_mfma_f32_16x16x32_bf16 v[60:63], v[16:19], a[108:111], v[60:63]
    v_mfma_f32_16x16x32_bf16 v[64:67], v[20:23], a[96:99], v[64:67]
    v_mfma_f32_16x16x32_bf16 v[68:71], v[20:23], a[100:103], v[68:71]
    v_mfma_f32_16x16x32_bf16 v[72:75], v[20:23], a[104:107], v[72:75]
    v_mfma_f32_16x16x32_bf16 v[76:79], v[20:23], a[108:111], v[76:79]
    ds_read_b128 v[16:19], v7 offset:9216
    ds_read_b128 v[20:23], v7 offset:25600
    s_waitcnt lgkmcnt(4)
    v_mfma_f32_16x16x32_bf16 v[48:51], v[24:27], a[112:115], v[48:51]
    v_mfma_f32_16x16x32_bf16 v[52:55], v[24:27], a[116:119], v[52:55]
    v_mfma_f32_16x16x32_bf16 v[56:59], v[24:27], a[120:123], v[56:59]
    v_mfma_f32_16x16x32_bf16 v[60:63], v[24:27], a[124:127], v[60:63]
    v_mfma_f32_16x16x32_bf16 v[64:67], v[28:31], a[112:115], v[64:67]
    v_mfma_f32_16x16x32_bf16 v[68:71], v[28:31], a[116:119], v[68:71]
    v_mfma_f32_16x16x32_bf16 v[72:75], v[28:31], a[120:123], v[72:75]
    v_mfma_f32_16x16x32_bf16 v[76:79], v[28:31], a[124:127], v[76:79]
    ds_read_b128 v[24:27], v7 offset:10240
    ds_read_b128 v[28:31], v7 offset:26624
    s_waitcnt lgkmcnt(4)
    v_mfma_f32_16x16x32_bf16 v[48:51], v[32:35], a[128:131], v[48:51]
    v_mfma_f32_16x16x32_bf16 v[52:55], v[32:35], a[132:135], v[52:55]
    v_mfma_f32_16x16x32_bf16 v[56:59], v[32:35], a[136:139], v[56:59]
    v_mfma_f32_16x16x32_bf16 v[60:63], v[32:35], a[140:143], v[60:63]
    v_mfma_f32_16x16x32_bf16 v[64:67], v[36:39], a[128:131], v[64:67]
    v_mfma_f32_16x16x32_bf16 v[68:71], v[36:39], a[132:135], v[68:71]
    v_mfma_f32_16x16x32_bf16 v[72:75], v[36:39], a[136:139], v[72:75]
    v_mfma_f32_16x16x32_bf16 v[76:79], v[36:39], a[140:143], v[76:79]
    s_waitcnt vmcnt(8)
    s_barrier
    s_or_b32 s84, s61, s72
    s_cmp_lg_u32 s84, 0x100
    s_cbranch_scc1 Av_nf_13
    s_mov_b64 exec, 1
    v_mov_b32 v250, 0
    v_mov_b32 v251, 1
    buffer_store_dword v251, v250, s[8:11], s71 offen sc1
    s_mov_b64 exec, -1
Av_nf_13:
    ds_read_b128 v[32:35], v7 offset:11264
    ds_read_b128 v[36:39], v7 offset:27648
    s_waitcnt lgkmcnt(4)
    v_mfma_f32_16x16x32_bf16 v[48:51], v[16:19], a[144:147], v[48:51]
    v_mfma_f32_16x16x32_bf16 v[52:55], v[16:19], a[148:151], v[52:55]
    v_mfma_f32_16x16x32_bf16 v[56:59], v[16:19], a[152:155], v[56:59]
    v_mfma_f32_16x16x32_bf16 v[60:63], v[16:19], a[156:159], v[60:63]
    v_mfma_f32_16x16x32_bf16 v[64:67], v[20:23], a[144:147], v[64:67]
    v_mfma_f32_16x16x32_bf16 v[68:71], v[20:23], a[148:151], v[68:71]
    v_mfma_f32_16x16x32_bf16 v[72:75], v[20:23], a[152:155], v[72:75]
    v_mfma_f32_16x16x32_bf16 v[76:79], v[20:23], a[156:159], v[76:79]
    ds_read_b128 v[16:19], v7 offset:12288
    ds_read_b128 v[20:23], v7 offset:28672
    s_waitcnt lgkmcnt(4)
    v_mfma_f32_16x16x32_bf16 v[48:51], v[24:27], a[160:163], v[48:51]
    v_mfma_f32_16x16x32_bf16 v[52:55], v[24:27], a[164:167], v[52:55]
    v_mfma_f32_16x16x32_bf16 v[56:59], v[24:27], a[168:171], v[56:59]
    v_mfma_f32_16x16x32_bf16 v[60:63], v[24:27], a[172:175], v[60:63]
    v_mfma_f32_16x16x32_bf16 v[64:67], v[28:31], a[160:163], v[64:67]
    v_mfma_f32_16x16x32_bf16 v[68:71], v[28:31], a[164:167], v[68:71]
    v_mfma_f32_16x16x32_bf16 v[72:75], v[28:31], a[168:171], v[72:75]
    v_mfma_f32_16x16x32_bf16 v[76:79], v[28:31], a[172:175], v[76:79]
    ds_read_b128 v[24:27], v7 offset:13312
    ds_read_b128 v[28:31], v7 offset:29696
    s_waitcnt lgkmcnt(4)
    v_mfma_f32_16x16x32_bf16 v[48:51], v[32:35], a[176:179], v[48:51]
    v_mfma_f32_16x16x32_bf16 v[52:55], v[32:35], a[180:183], v[52:55]
    v_mfma_f32_16x16x32_bf16 v[56:59], v[32:35], a[184:187], v[56:59]
    v_mfma_f32_16x16x32_bf16 v[60:63], v[32:35], a[188:191], v[60:63]
    v_mfma_f32_16x16x32_bf16 v[64:67], v[36:39], a[176:179], v[64:67]
    v_mfma_f32_16x16x32_bf16 v[68:71], v[36:39], a[180:183], v[68:71]
    v_mfma_f32_16x16x32_bf16 v[72:75], v[36:39], a[184:187], v[72:75]
    v_mfma_f32_16x16x32_bf16 v[76:79], v[36:39], a[188:191], v[76:79]
    ds_read_b128 v[32:35], v7 offset:14336
    ds_read_b128 v[36:39], v7 offset:30720
    s_waitcnt lgkmcnt(4)
    v_mfma_f32_16x16x32_bf16 v[48:51], v[16:19], a[192:195], v[48:51]
    v_mfma_f32_16x16x32_bf16 v[52:55], v[16:19], a[196:199], v[52:55]
    v_mfma_f32_16x16x32_bf16 v[56:59], v[16:19], a[200:203], v[56:59]
    v_mfma_f32_16x16x32_bf16 v[60:63], v[16:19], a[204:207], v[60:63]
    v_mfma_f32_16x16x32_bf16 v[64:67], v[20:23], a[192:195], v[64:67]
    v_mfma_f32_16x16x32_bf16 v[68:71], v[20:23], a[196:199], v[68:71]
    v_mfma_f32_16x16x32_bf16 v[72:75], v[20:23], a[200:203], v[72:75]
    v_mfma_f32_16x16x32_bf16 v[76:79], v[20:23], a[204:207], v[76:79]
    ds_read_b128 v[16:19], v7 offset:15360
    ds_read_b128 v[20:23], v7 offset:31744
    s_waitcnt lgkmcnt(4)
    v_mfma_f32_16x16x32_bf16 v[48:51], v[24:27], a[208:211], v[48:51]
    v_mfma_f32_16x16x32_bf16 v[52:55], v[24:27], a[212:215], v[52:55]
    v_mfma_f32_16x16x32_bf16 v[56:59], v[24:27], a[216:219], v[56:59]
    v_mfma_f32_16x16x32_bf16 v[60:63], v[24:27], a[220:223], v[60:63]
    v_mfma_f32_16x16x32_bf16 v[64:67], v[28:31], a[208:211], v[64:67]
    v_mfma_f32_16x16x32_bf16 v[68:71], v[28:31], a[212:215], v[68:71]
    v_mfma_f32_16x16x32_bf16 v[72:75], v[28:31], a[216:219], v[72:75]
    v_mfma_f32_16x16x32_bf16 v[76:79], v[28:31], a[220:223], v[76:79]
    s_waitcnt lgkmcnt(2)
    v_mfma_f32_16x16x32_bf16 v[48:51], v[32:35], a[224:227], v[48:51]
    v_mfma_f32_16x16x32_bf16 v[52:55], v[32:35], a[228:231], v[52:55]
    v_mfma_f32_16x16x32_bf16 v[56:59], v[32:35], a[232:235], v[56:59]
    v_mfma_f32_16x16x32_bf16 v[60:63], v[32:35], a[236:239], v[60:63]
    v_mfma_f32_16x16x32_bf16 v[64:67], v[36:39], a[224:227], v[64:67]
    v_mfma_f32_16x16x32_bf16 v[68:71], v[36:39], a[228:231], v[68:71]
    v_mfma_f32_16x16x32_bf16 v[72:75], v[36:39], a[232:235], v[72:75]
    v_mfma_f32_16x16x32_bf16 v[76:79], v[36:39], a[236:239], v[76:79]
    s_waitcnt lgkmcnt(0)
    v_mfma_f32_16x16x32_bf16 v[48:51], v[16:19], a[240:243], v[48:51]
    v_mfma_f32_16x16x32_bf16 v[52:55], v[16:19], a[244:247], v[52:55]
    v_mfma_f32_16x16x32_bf16 v[56:59], v[16:19], a[248:251], v[56:59]
    v_mfma_f32_16x16x32_bf16 v[60:63], v[16:19], a[252:255], v[60:63]
    v_mfma_f32_16x16x32_bf16 v[64:67], v[20:23], a[240:243], v[64:67]
    v_mfma_f32_16x16x32_bf16 v[68:71], v[20:23], a[244:247], v[68:71]
    v_mfma_f32_16x16x32_bf16 v[72:75], v[20:23], a[248:251], v[72:75]
    v_mfma_f32_16x16x32_bf16 v[76:79], v[20:23], a[252:255], v[76:79]
    s_waitcnt vmcnt(0)
    s_barrier
    s_lshl_b32 s84, s64, 18
    s_add_u32 s84, s84, s68
    v_cvt_pk_bf16_f32 v80, v48, v49
    v_cvt_pk_bf16_f32 v81, v50, v51
    v_cvt_pk_bf16_f32 v82, v64, v65
    v_cvt_pk_bf16_f32 v83, v66, v67
    buffer_store_dwordx4 v[80:83], v4, s[8:11], s84 offen offset:0 sc1
    v_cvt_pk_bf16_f32 v84, v52, v53
    v_cvt_pk_bf16_f32 v85, v54, v55
    v_cvt_pk_bf16_f32 v86, v68, v69
    v_cvt_pk_bf16_f32 v87, v70, v71
    buffer_store_dwordx4 v[84:87], v4, s[8:11], s84 offen offset:1024 sc1
    v_cvt_pk_bf16_f32 v88, v56, v57
    v_cvt_pk_bf16_f32 v89, v58, v59
    v_cvt_pk_bf16_f32 v90, v72, v73
    v_cvt_pk_bf16_f32 v91, v74, v75
    buffer_store_dwordx4 v[88:91], v4, s[8:11], s84 offen offset:2048 sc1
    v_cvt_pk_bf16_f32 v92, v60, v61
    v_cvt_pk_bf16_f32 v93, v62, v63
    v_cvt_pk_bf16_f32 v94, v76, v77
    v_cvt_pk_bf16_f32 v95, v78, v79
    buffer_store_dwordx4 v[92:95], v4, s[8:11], s84 offen offset:3072 sc1
    s_lshl_b32 s84, s64, 5
    s_add_u32 s71, s84, s73
    s_mov_b32 s72, 0x100
    v_xor_b32 v7, 32768, v7
    s_add_u32 s64, s64, s65
    s_cmp_lt_u32 s64, 64
    s_cbranch_scc1 Av_loop
    s_waitcnt vmcnt(0)
    s_barrier
    s_cmp_lg_u32 s61, 0
    s_cbranch_scc1 Av_nf_14
    s_mov_b64 exec, 1
    v_mov_b32 v250, 0
    v_mov_b32 v251, 1
    buffer_store_dword v251, v250, s[8:11], s71 offen sc1
    s_mov_b64 exec, -1
Av_nf_14:
    s_branch A_done
A_h:
    s_sub_u32 s84, s62, 176
    s_mov_b32 s64, 0
    s_cmp_ge_u32 s84, 14
    s_cselect_b32 s85, 14, 0
    s_sub_u32 s84, s84, s85
    s_lshr_b32 s85, s85, 3
    s_add_u32 s64, s64, s85
    s_cmp_ge_u32 s84, 14
    s_cselect_b32 s85, 14, 0
    s_sub_u32 s84, s84, s85
    s_lshr_b32 s85, s85, 3
    s_add_u32 s64, s64, s85
    s_add_u32 s66, s84, 48
    s_mov_b32 s65, 3
    s_lshl_b32 s84, s84, 2
    s_add_u32 s73, s84, 0x720f000
    s_add_u32 s84, s84, s61
    s_lshl_b32 s67, s84, 6
    s_lshl_b32 s68, s84, 10
    s_add_u32 s68, s68, 0x5000000
    s_mov_b32 s16, s48
    s_and_b32 s17, s49, 0xffff
    s_mov_b32 s18, 0x1c0000
    s_mov_b32 s19, 0x20000
    s_mov_b32 s20, s50
    s_and_b32 s21, s51, 0xffff
    s_mov_b32 s22, 0x1c0000
    s_mov_b32 s23, 0x20000
    s_mov_b32 s84, 28672
    v_mul_lo_u32 v6, v3, s84
    v_lshl_add_u32 v6, v2, 2, v6
    s_add_u32 s84, s67, 0
    buffer_load_dword v100, v6, s[16:19], s84 offen
    buffer_load_dword v101, v6, s[20:23], s84 offen
    s_add_u32 s84, s67, 3584
    buffer_load_dword v102, v6, s[16:19], s84 offen
    buffer_load_dword v103, v6, s[20:23], s84 offen
    s_add_u32 s84, s67, 7168
    buffer_load_dword v104, v6, s[16:19], s84 offen
    buffer_load_dword v105, v6, s[20:23], s84 offen
    s_add_u32 s84, s67, 10752
    buffer_load_dword v106, v6, s[16:19], s84 offen
    buffer_load_dword v107, v6, s[20:23], s84 offen
    s_add_u32 s84, s67, 14336
    buffer_load_dword v108, v6, s[16:19], s84 offen
    buffer_load_dword v109, v6, s[20:23], s84 offen
    s_add_u32 s84, s67, 17920
    buffer_load_dword v110, v6, s[16:19], s84 offen
    buffer_load_dword v111, v6, s[20:23], s84 offen
    s_add_u32 s84, s67, 21504
    buffer_load_dword v112, v6, s[16:19], s84 offen
    buffer_load_dword v113, v6, s[20:23], s84 offen
    s_add_u32 s84, s67, 25088
    buffer_load_dword v114, v6, s[16:19], s84 offen
    buffer_load_dword v115, v6, s[20:23], s84 offen
    s_add_u32 s84, s67, 114688
    buffer_load_dword v116, v6, s[16:19], s84 offen
    buffer_load_dword v117, v6, s[20:23], s84 offen
    s_add_u32 s84, s67, 118272
    buffer_load_dword v118, v6, s[16:19], s84 offen
    buffer_load_dword v119, v6, s[20:23], s84 offen
    s_add_u32 s84, s67, 121856
    buffer_load_dword v120, v6, s[16:19], s84 offen
    buffer_load_dword v121, v6, s[20:23], s84 offen
    s_add_u32 s84, s67, 125440
    buffer_load_dword v122, v6, s[16:19], s84 offen
    buffer_load_dword v123, v6, s[20:23], s84 offen
    s_add_u32 s84, s67, 129024
    buffer_load_dword v124, v6, s[16:19], s84 offen
    buffer_load_dword v125, v6, s[20:23], s84 offen
    s_add_u32 s84, s67, 132608
    buffer_load_dword v126, v6, s[16:19], s84 offen
    buffer_load_dword v127, v6, s[20:23], s84 offen
    s_add_u32 s84, s67, 136192
    buffer_load_dword v128, v6, s[16:19], s84 offen
    buffer_load_dword v129, v6, s[20:23], s84 offen
    s_add_u32 s84, s67, 139776
    buffer_load_dword v130, v6, s[16:19], s84 offen
    buffer_load_dword v131, v6, s[20:23], s84 offen
    s_add_u32 s84, s67, 229376
    buffer_load_dword v132, v6, s[16:19], s84 offen
    buffer_load_dword v133, v6, s[20:23], s84 offen
    s_add_u32 s84, s67, 232960
    buffer_load_dword v134, v6, s[16:19], s84 offen
    buffer_load_dword v135, v6, s[20:23], s84 offen
    s_add_u32 s84, s67, 236544
    buffer_load_dword v136, v6, s[16:19], s84 offen
    buffer_load_dword v137, v6, s[20:23], s84 offen
    s_add_u32 s84, s67, 240128
    buffer_load_dword v138, v6, s[16:19], s84 offen
    buffer_load_dword v139, v6, s[20:23], s84 offen
    s_add_u32 s84, s67, 243712
    buffer_load_dword v140, v6, s[16:19], s84 offen
    buffer_load_dword v141, v6, s[20:23], s84 offen
    s_add_u32 s84, s67, 247296
    buffer_load_dword v142, v6, s[16:19], s84 offen
    buffer_load_dword v143, v6, s[20:23], s84 offen
    s_add_u32 s84, s67, 250880
    buffer_load_dword v144, v6, s[16:19], s84 offen
    buffer_load_dword v145, v6, s[20:23], s84 offen
    s_add_u32 s84, s67, 254464
    buffer_load_dword v146, v6, s[16:19], s84 offen
    buffer_load_dword v147, v6, s[20:23], s84 offen
    s_add_u32 s84, s67, 344064
    buffer_load_dword v148, v6, s[16:19], s84 offen
    buffer_load_dword v149, v6, s[20:23], s84 offen
    s_add_u32 s84, s67, 347648
    buffer_load_dword v150, v6, s[16:19], s84 offen
    buffer_load_dword v151, v6, s[20:23], s84 offen
    s_add_u32 s84, s67, 351232
    buffer_load_dword v152, v6, s[16:19], s84 offen
    buffer_load_dword v153, v6, s[20:23], s84 offen
    s_add_u32 s84, s67, 354816
    buffer_load_dword v154, v6, s[16:19], s84 offen
    buffer_load_dword v155, v6, s[20:23], s84 offen
    s_add_u32 s84, s67, 358400
    buffer_load_dword v156, v6, s[16:19], s84 offen
    buffer_load_dword v157, v6, s[20:23], s84 offen
    s_add_u32 s84, s67, 361984
    buffer_load_dword v158, v6, s[16:19], s84 offen
    buffer_load_dword v159, v6, s[20:23], s84 offen
    s_add_u32 s84, s67, 365568
    buffer_load_dword v160, v6, s[16:19], s84 offen
    buffer_load_dword v161, v6, s[20:23], s84 offen
    s_add_u32 s84, s67, 369152
    buffer_load_dword v162, v6, s[16:19], s84 offen
    buffer_load_dword v163, v6, s[20:23], s84 offen
    s_waitcnt vmcnt(32)
    v_perm_b32 v80, v102, v100, s95
    v_perm_b32 v81, v106, v104, s95
    v_perm_b32 v82, v110, v108, s95
    v_perm_b32 v83, v114, v112, s95
    v_perm_b32 v84, v102, v100, s96
    v_perm_b32 v85, v106, v104, s96
    v_perm_b32 v86, v110, v108, s96
    v_perm_b32 v87, v114, v112, s96
    v_perm_b32 v88, v103, v101, s95
    v_perm_b32 v89, v107, v105, s95
    v_perm_b32 v90, v111, v109, s95
    v_perm_b32 v91, v115, v113, s95
    v_perm_b32 v92, v103, v101, s96
    v_perm_b32 v93, v107, v105, s96
    v_perm_b32 v94, v111, v109, s96
    v_perm_b32 v95, v115, v113, s96
    v_accvgpr_write_b32 a0, v80
    v_accvgpr_write_b32 a1, v81
    v_accvgpr_write_b32 a2, v82
    v_accvgpr_write_b32 a3, v83
    v_accvgpr_write_b32 a4, v84
    v_accvgpr_write_b32 a5, v85
    v_accvgpr_write_b32 a6, v86
    v_accvgpr_write_b32 a7, v87
    v_accvgpr_write_b32 a8, v88
    v_accvgpr_write_b32 a9, v89
    v_accvgpr_write_b32 a10, v90
    v_accvgpr_write_b32 a11, v91
    v_accvgpr_write_b32 a12, v92
    v_accvgpr_write_b32 a13, v93
    v_accvgpr_write_b32 a14, v94
    v_accvgpr_write_b32 a15, v95
    v_perm_b32 v80, v118, v116, s95
    v_perm_b32 v81, v122, v120, s95
    v_perm_b32 v82, v126, v124, s95
    v_perm_b32 v83, v130, v128, s95
    v_perm_b32 v84, v118, v116, s96
    v_perm_b32 v85, v122, v120, s96
    v_perm_b32 v86, v126, v124, s96
    v_perm_b32 v87, v130, v128, s96
    v_perm_b32 v88, v119, v117, s95
    v_perm_b32 v89, v123, v121, s95
    v_perm_b32 v90, v127, v125, s95
    v_perm_b32 v91, v131, v129, s95
    v_perm_b32 v92, v119, v117, s96
    v_perm_b32 v93, v123, v121, s96
    v_perm_b32 v94, v127, v125, s96
    v_perm_b32 v95, v131, v129, s96
    v_accvgpr_write_b32 a16, v80
    v_accvgpr_write_b32 a17, v81
    v_accvgpr_write_b32 a18, v82
    v_accvgpr_write_b32 a19, v83
    v_accvgpr_write_b32 a20, v84
    v_accvgpr_write_b32 a21, v85
    v_accvgpr_write_b32 a22, v86
    v_accvgpr_write_b32 a23, v87
    v_accvgpr_write_b32 a24, v88
    v_accvgpr_write_b32 a25, v89
    v_accvgpr_write_b32 a26, v90
    v_accvgpr_write_b32 a27, v91
    v_accvgpr_write_b32 a28, v92
    v_accvgpr_write_b32 a29, v93
    v_accvgpr_write_b32 a30, v94
    v_accvgpr_write_b32 a31, v95
    s_add_u32 s84, s67, 458752
    buffer_load_dword v164, v6, s[16:19], s84 offen
    buffer_load_dword v165, v6, s[20:23], s84 offen
    s_add_u32 s84, s67, 462336
    buffer_load_dword v166, v6, s[16:19], s84 offen
    buffer_load_dword v167, v6, s[20:23], s84 offen
    s_add_u32 s84, s67, 465920
    buffer_load_dword v168, v6, s[16:19], s84 offen
    buffer_load_dword v169, v6, s[20:23], s84 offen
    s_add_u32 s84, s67, 469504
    buffer_load_dword v170, v6, s[16:19], s84 offen
    buffer_load_dword v171, v6, s[20:23], s84 offen
    s_add_u32 s84, s67, 473088
    buffer_load_dword v172, v6, s[16:19], s84 offen
    buffer_load_dword v173, v6, s[20:23], s84 offen
    s_add_u32 s84, s67, 476672
    buffer_load_dword v174, v6, s[16:19], s84 offen
    buffer_load_dword v175, v6, s[20:23], s84 offen
    s_add_u32 s84, s67, 480256
    buffer_load_dword v176, v6, s[16:19], s84 offen
    buffer_load_dword v177, v6, s[20:23], s84 offen
    s_add_u32 s84, s67, 483840
    buffer_load_dword v178, v6, s[16:19], s84 offen
    buffer_load_dword v179, v6, s[20:23], s84 offen
    s_add_u32 s84, s67, 573440
    buffer_load_dword v180, v6, s[16:19], s84 offen
    buffer_load_dword v181, v6, s[20:23], s84 offen
    s_add_u32 s84, s67, 577024
    buffer_load_dword v182, v6, s[16:19], s84 offen
    buffer_load_dword v183, v6, s[20:23], s84 offen
    s_add_u32 s84, s67, 580608
    buffer_load_dword v184, v6, s[16:19], s84 offen
    buffer_load_dword v185, v6, s[20:23], s84 offen
    s_add_u32 s84, s67, 584192
    buffer_load_dword v186, v6, s[16:19], s84 offen
    buffer_load_dword v187, v6, s[20:23], s84 offen
    s_add_u32 s84, s67, 587776
    buffer_load_dword v188, v6, s[16:19], s84 offen
    buffer_load_dword v189, v6, s[20:23], s84 offen
    s_add_u32 s84, s67, 591360
    buffer_load_dword v190, v6, s[16:19], s84 offen
    buffer_load_dword v191, v6, s[20:23], s84 offen
    s_add_u32 s84, s67, 594944
    buffer_load_dword v192, v6, s[16:19], s84 offen
    buffer_load_dword v193, v6, s[20:23], s84 offen
    s_add_u32 s84, s67, 598528
    buffer_load_dword v194, v6, s[16:19], s84 offen
    buffer_load_dword v195, v6, s[20:23], s84 offen
    s_waitcnt vmcnt(32)
    v_perm_b32 v80, v134, v132, s95
    v_perm_b32 v81, v138, v136, s95
    v_perm_b32 v82, v142, v140, s95
    v_perm_b32 v83, v146, v144, s95
    v_perm_b32 v84, v134, v132, s96
    v_perm_b32 v85, v138, v136, s96
    v_perm_b32 v86, v142, v140, s96
    v_perm_b32 v87, v146, v144, s96
    v_perm_b32 v88, v135, v133, s95
    v_perm_b32 v89, v139, v137, s95
    v_perm_b32 v90, v143, v141, s95
    v_perm_b32 v91, v147, v145, s95
    v_perm_b32 v92, v135, v133, s96
    v_perm_b32 v93, v139, v137, s96
    v_perm_b32 v94, v143, v141, s96
    v_perm_b32 v95, v147, v145, s96
    v_accvgpr_write_b32 a32, v80
    v_accvgpr_write_b32 a33, v81
    v_accvgpr_write_b32 a34, v82
    v_accvgpr_write_b32 a35, v83
    v_accvgpr_write_b32 a36, v84
    v_accvgpr_write_b32 a37, v85
    v_accvgpr_write_b32 a38, v86
    v_accvgpr_write_b32 a39, v87
    v_accvgpr_write_b32 a40, v88
    v_accvgpr_write_b32 a41, v89
    v_accvgpr_write_b32 a42, v90
    v_accvgpr_write_b32 a43, v91
    v_accvgpr_write_b32 a44, v92
    v_accvgpr_write_b32 a45, v93
    v_accvgpr_write_b32 a46, v94
    v_accvgpr_write_b32 a47, v95
    v_perm_b32 v80, v150, v148, s95
    v_perm_b32 v81, v154, v152, s95
    v_perm_b32 v82, v158, v156, s95
    v_perm_b32 v83, v162, v160, s95
    v_perm_b32 v84, v150, v148, s96
    v_perm_b32 v85, v154, v152, s96
    v_perm_b32 v86, v158, v156, s96
    v_perm_b32 v87, v162, v160, s96
    v_perm_b32 v88, v151, v149, s95
    v_perm_b32 v89, v155, v153, s95
    v_perm_b32 v90, v159, v157, s95
    v_perm_b32 v91, v163, v161, s95
    v_perm_b32 v92, v151, v149, s96
    v_perm_b32 v93, v155, v153, s96
    v_perm_b32 v94, v159, v157, s96
    v_perm_b32 v95, v163, v161, s96
    v_accvgpr_write_b32 a48, v80
    v_accvgpr_write_b32 a49, v81
    v_accvgpr_write_b32 a50, v82
    v_accvgpr_write_b32 a51, v83
    v_accvgpr_write_b32 a52, v84
    v_accvgpr_write_b32 a53, v85
    v_accvgpr_write_b32 a54, v86
    v_accvgpr_write_b32 a55, v87
    v_accvgpr_write_b32 a56, v88
    v_accvgpr_write_b32 a57, v89
    v_accvgpr_write_b32 a58, v90
    v_accvgpr_write_b32 a59, v91
    v_accvgpr_write_b32 a60, v92
    v_accvgpr_write_b32 a61, v93
    v_accvgpr_write_b32 a62, v94
    v_accvgpr_write_b32 a63, v95
    s_add_u32 s84, s67, 688128
    buffer_load_dword v100, v6, s[16:19], s84 offen
    buffer_load_dword v101, v6, s[20:23], s84 offen
    s_add_u32 s84, s67, 691712
    buffer_load_dword v102, v6, s[16:19], s84 offen
    buffer_load_dword v103, v6, s[20:23], s84 offen
    s_add_u32 s84, s67, 695296
    buffer_load_dword v104, v6, s[16:19], s84 offen
    buffer_load_dword v105, v6, s[20:23], s84 offen
    s_add_u32 s84, s67, 698880
    buffer_load_dword v106, v6, s[16:19], s84 offen
    buffer_load_dword v107, v6, s[20:23], s84 offen
    s_add_u32 s84, s67, 702464
    buffer_load_dword v108, v6, s[16:19], s84 offen
    buffer_load_dword v109, v6, s[20:23], s84 offen
    s_add_u32 s84, s67, 706048
    buffer_load_dword v110, v6, s[16:19], s84 offen
    buffer_load_dword v111, v6, s[20:23], s84 offen
    s_add_u32 s84, s67, 709632
    buffer_load_dword v112, v6, s[16:19], s84 offen
    buffer_load_dword v113, v6, s[20:23], s84 offen
    s_add_u32 s84, s67, 713216
    buffer_load_dword v114, v6, s[16:19], s84 offen
    buffer_load_dword v115, v6, s[20:23], s84 offen
    s_add_u32 s84, s67, 802816
    buffer_load_dword v116, v6, s[16:19], s84 offen
    buffer_load_dword v117, v6, s[20:23], s84 offen
    s_add_u32 s84, s67, 806400
    buffer_load_dword v118, v6, s[16:19], s84 offen
    buffer_load_dword v119, v6, s[20:23], s84 offen
    s_add_u32 s84, s67, 809984
    buffer_load_dword v120, v6, s[16:19], s84 offen
    buffer_load_dword v121, v6, s[20:23], s84 offen
    s_add_u32 s84, s67, 813568
    buffer_load_dword v122, v6, s[16:19], s84 offen
    buffer_load_dword v123, v6, s[20:23], s84 offen
    s_add_u32 s84, s67, 817152
    buffer_load_dword v124, v6, s[16:19], s84 offen
    buffer_load_dword v125, v6, s[20:23], s84 offen
    s_add_u32 s84, s67, 820736
    buffer_load_dword v126, v6, s[16:19], s84 offen
    buffer_load_dword v127, v6, s[20:23], s84 offen
    s_add_u32 s84, s67, 824320
    buffer_load_dword v128, v6, s[16:19], s84 offen
    buffer_load_dword v129, v6, s[20:23], s84 offen
    s_add_u32 s84, s67, 827904
    buffer_load_dword v130, v6, s[16:19], s84 offen
    buffer_load_dword v131, v6, s[20:23], s84 offen
    s_waitcnt vmcnt(32)
    v_perm_b32 v80, v166, v164, s95
    v_perm_b32 v81, v170, v168, s95
    v_perm_b32 v82, v174, v172, s95
    v_perm_b32 v83, v178, v176, s95
    v_perm_b32 v84, v166, v164, s96
    v_perm_b32 v85, v170, v168, s96
    v_perm_b32 v86, v174, v172, s96
    v_perm_b32 v87, v178, v176, s96
    v_perm_b32 v88, v167, v165, s95
    v_perm_b32 v89, v171, v169, s95
    v_perm_b32 v90, v175, v173, s95
    v_perm_b32 v91, v179, v177, s95
    v_perm_b32 v92, v167, v165, s96
    v_perm_b32 v93, v171, v169, s96
    v_perm_b32 v94, v175, v173, s96
    v_perm_b32 v95, v179, v177, s96
    v_accvgpr_write_b32 a64, v80
    v_accvgpr_write_b32 a65, v81
    v_accvgpr_write_b32 a66, v82
    v_accvgpr_write_b32 a67, v83
    v_accvgpr_write_b32 a68, v84
    v_accvgpr_write_b32 a69, v85
    v_accvgpr_write_b32 a70, v86
    v_accvgpr_write_b32 a71, v87
    v_accvgpr_write_b32 a72, v88
    v_accvgpr_write_b32 a73, v89
    v_accvgpr_write_b32 a74, v90
    v_accvgpr_write_b32 a75, v91
    v_accvgpr_write_b32 a76, v92
    v_accvgpr_write_b32 a77, v93
    v_accvgpr_write_b32 a78, v94
    v_accvgpr_write_b32 a79, v95
    v_perm_b32 v80, v182, v180, s95
    v_perm_b32 v81, v186, v184, s95
    v_perm_b32 v82, v190, v188, s95
    v_perm_b32 v83, v194, v192, s95
    v_perm_b32 v84, v182, v180, s96
    v_perm_b32 v85, v186, v184, s96
    v_perm_b32 v86, v190, v188, s96
    v_perm_b32 v87, v194, v192, s96
    v_perm_b32 v88, v183, v181, s95
    v_perm_b32 v89, v187, v185, s95
    v_perm_b32 v90, v191, v189, s95
    v_perm_b32 v91, v195, v193, s95
    v_perm_b32 v92, v183, v181, s96
    v_perm_b32 v93, v187, v185, s96
    v_perm_b32 v94, v191, v189, s96
    v_perm_b32 v95, v195, v193, s96
    v_accvgpr_write_b32 a80, v80
    v_accvgpr_write_b32 a81, v81
    v_accvgpr_write_b32 a82, v82
    v_accvgpr_write_b32 a83, v83
    v_accvgpr_write_b32 a84, v84
    v_accvgpr_write_b32 a85, v85
    v_accvgpr_write_b32 a86, v86
    v_accvgpr_write_b32 a87, v87
    v_accvgpr_write_b32 a88, v88
    v_accvgpr_write_b32 a89, v89
    v_accvgpr_write_b32 a90, v90
    v_accvgpr_write_b32 a91, v91
    v_accvgpr_write_b32 a92, v92
    v_accvgpr_write_b32 a93, v93
    v_accvgpr_write_b32 a94, v94
    v_accvgpr_write_b32 a95, v95
    s_add_u32 s84, s67, 917504
    buffer_load_dword v132, v6, s[16:19], s84 offen
    buffer_load_dword v133, v6, s[20:23], s84 offen
    s_add_u32 s84, s67, 921088
    buffer_load_dword v134, v6, s[16:19], s84 offen
    buffer_load_dword v135, v6, s[20:23], s84 offen
    s_add_u32 s84, s67, 924672
    buffer_load_dword v136, v6, s[16:19], s84 offen
    buffer_load_dword v137, v6, s[20:23], s84 offen
    s_add_u32 s84, s67, 928256
    buffer_load_dword v138, v6, s[16:19], s84 offen
    buffer_load_dword v139, v6, s[20:23], s84 offen
    s_add_u32 s84, s67, 931840
    buffer_load_dword v140, v6, s[16:19], s84 offen
    buffer_load_dword v141, v6, s[20:23], s84 offen
    s_add_u32 s84, s67, 935424
    buffer_load_dword v142, v6, s[16:19], s84 offen
    buffer_load_dword v143, v6, s[20:23], s84 offen
    s_add_u32 s84, s67, 939008
    buffer_load_dword v144, v6, s[16:19], s84 offen
    buffer_load_dword v145, v6, s[20:23], s84 offen
    s_add_u32 s84, s67, 942592
    buffer_load_dword v146, v6, s[16:19], s84 offen
    buffer_load_dword v147, v6, s[20:23], s84 offen
    s_add_u32 s84, s67, 1032192
    buffer_load_dword v148, v6, s[16:19], s84 offen
    buffer_load_dword v149, v6, s[20:23], s84 offen
    s_add_u32 s84, s67, 1035776
    buffer_load_dword v150, v6, s[16:19], s84 offen
    buffer_load_dword v151, v6, s[20:23], s84 offen
    s_add_u32 s84, s67, 1039360
    buffer_load_dword v152, v6, s[16:19], s84 offen
    buffer_load_dword v153, v6, s[20:23], s84 offen
    s_add_u32 s84, s67, 1042944
    buffer_load_dword v154, v6, s[16:19], s84 offen
    buffer_load_dword v155, v6, s[20:23], s84 offen
    s_add_u32 s84, s67, 1046528
    buffer_load_dword v156, v6, s[16:19], s84 offen
    buffer_load_dword v157, v6, s[20:23], s84 offen
    s_add_u32 s84, s67, 1050112
    buffer_load_dword v158, v6, s[16:19], s84 offen
    buffer_load_dword v159, v6, s[20:23], s84 offen
    s_add_u32 s84, s67, 1053696
    buffer_load_dword v160, v6, s[16:19], s84 offen
    buffer_load_dword v161, v6, s[20:23], s84 offen
    s_add_u32 s84, s67, 1057280
    buffer_load_dword v162, v6, s[16:19], s84 offen
    buffer_load_dword v163, v6, s[20:23], s84 offen
    s_waitcnt vmcnt(32)
    v_perm_b32 v80, v102, v100, s95
    v_perm_b32 v81, v106, v104, s95
    v_perm_b32 v82, v110, v108, s95
    v_perm_b32 v83, v114, v112, s95
    v_perm_b32 v84, v102, v100, s96
    v_perm_b32 v85, v106, v104, s96
    v_perm_b32 v86, v110, v108, s96
    v_perm_b32 v87, v114, v112, s96
    v_perm_b32 v88, v103, v101, s95
    v_perm_b32 v89, v107, v105, s95
    v_perm_b32 v90, v111, v109, s95
    v_perm_b32 v91, v115, v113, s95
    v_perm_b32 v92, v103, v101, s96
    v_perm_b32 v93, v107, v105, s96
    v_perm_b32 v94, v111, v109, s96
    v_perm_b32 v95, v115, v113, s96
    v_accvgpr_write_b32 a96, v80
    v_accvgpr_write_b32 a97, v81
    v_accvgpr_write_b32 a98, v82
    v_accvgpr_write_b32 a99, v83
    v_accvgpr_write_b32 a100, v84
    v_accvgpr_write_b32 a101, v85
    v_accvgpr_write_b32 a102, v86
    v_accvgpr_write_b32 a103, v87
    v_accvgpr_write_b32 a104, v88
    v_accvgpr_write_b32 a105, v89
    v_accvgpr_write_b32 a106, v90
    v_accvgpr_write_b32 a107, v91
    v_accvgpr_write_b32 a108, v92
    v_accvgpr_write_b32 a109, v93
    v_accvgpr_write_b32 a110, v94
    v_accvgpr_write_b32 a111, v95
    v_perm_b32 v80, v118, v116, s95
    v_perm_b32 v81, v122, v120, s95
    v_perm_b32 v82, v126, v124, s95
    v_perm_b32 v83, v130, v128, s95
    v_perm_b32 v84, v118, v116, s96
    v_perm_b32 v85, v122, v120, s96
    v_perm_b32 v86, v126, v124, s96
    v_perm_b32 v87, v130, v128, s96
    v_perm_b32 v88, v119, v117, s95
    v_perm_b32 v89, v123, v121, s95
    v_perm_b32 v90, v127, v125, s95
    v_perm_b32 v91, v131, v129, s95
    v_perm_b32 v92, v119, v117, s96
    v_perm_b32 v93, v123, v121, s96
    v_perm_b32 v94, v127, v125, s96
    v_perm_b32 v95, v131, v129, s96
    v_accvgpr_write_b32 a112, v80
    v_accvgpr_write_b32 a113, v81
    v_accvgpr_write_b32 a114, v82
    v_accvgpr_write_b32 a115, v83
    v_accvgpr_write_b32 a116, v84
    v_accvgpr_write_b32 a117, v85
    v_accvgpr_write_b32 a118, v86
    v_accvgpr_write_b32 a119, v87
    v_accvgpr_write_b32 a120, v88
    v_accvgpr_write_b32 a121, v89
    v_accvgpr_write_b32 a122, v90
    v_accvgpr_write_b32 a123, v91
    v_accvgpr_write_b32 a124, v92
    v_accvgpr_write_b32 a125, v93
    v_accvgpr_write_b32 a126, v94
    v_accvgpr_write_b32 a127, v95
    s_add_u32 s84, s67, 1146880
    buffer_load_dword v164, v6, s[16:19], s84 offen
    buffer_load_dword v165, v6, s[20:23], s84 offen
    s_add_u32 s84, s67, 1150464
    buffer_load_dword v166, v6, s[16:19], s84 offen
    buffer_load_dword v167, v6, s[20:23], s84 offen
    s_add_u32 s84, s67, 1154048
    buffer_load_dword v168, v6, s[16:19], s84 offen
    buffer_load_dword v169, v6, s[20:23], s84 offen
    s_add_u32 s84, s67, 1157632
    buffer_load_dword v170, v6, s[16:19], s84 offen
    buffer_load_dword v171, v6, s[20:23], s84 offen
    s_add_u32 s84, s67, 1161216
    buffer_load_dword v172, v6, s[16:19], s84 offen
    buffer_load_dword v173, v6, s[20:23], s84 offen
    s_add_u32 s84, s67, 1164800
    buffer_load_dword v174, v6, s[16:19], s84 offen
    buffer_load_dword v175, v6, s[20:23], s84 offen
    s_add_u32 s84, s67, 1168384
    buffer_load_dword v176, v6, s[16:19], s84 offen
    buffer_load_dword v177, v6, s[20:23], s84 offen
    s_add_u32 s84, s67, 1171968
    buffer_load_dword v178, v6, s[16:19], s84 offen
    buffer_load_dword v179, v6, s[20:23], s84 offen
    s_add_u32 s84, s67, 1261568
    buffer_load_dword v180, v6, s[16:19], s84 offen
    buffer_load_dword v181, v6, s[20:23], s84 offen
    s_add_u32 s84, s67, 1265152
    buffer_load_dword v182, v6, s[16:19], s84 offen
    buffer_load_dword v183, v6, s[20:23], s84 offen
    s_add_u32 s84, s67, 1268736
    buffer_load_dword v184, v6, s[16:19], s84 offen
    buffer_load_dword v185, v6, s[20:23], s84 offen
    s_add_u32 s84, s67, 1272320
    buffer_load_dword v186, v6, s[16:19], s84 offen
    buffer_load_dword v187, v6, s[20:23], s84 offen
    s_add_u32 s84, s67, 1275904
    buffer_load_dword v188, v6, s[16:19], s84 offen
    buffer_load_dword v189, v6, s[20:23], s84 offen
    s_add_u32 s84, s67, 1279488
    buffer_load_dword v190, v6, s[16:19], s84 offen
    buffer_load_dword v191, v6, s[20:23], s84 offen
    s_add_u32 s84, s67, 1283072
    buffer_load_dword v192, v6, s[16:19], s84 offen
    buffer_load_dword v193, v6, s[20:23], s84 offen
    s_add_u32 s84, s67, 1286656
    buffer_load_dword v194, v6, s[16:19], s84 offen
    buffer_load_dword v195, v6, s[20:23], s84 offen
    s_waitcnt vmcnt(32)
    v_perm_b32 v80, v134, v132, s95
    v_perm_b32 v81, v138, v136, s95
    v_perm_b32 v82, v142, v140, s95
    v_perm_b32 v83, v146, v144, s95
    v_perm_b32 v84, v134, v132, s96
    v_perm_b32 v85, v138, v136, s96
    v_perm_b32 v86, v142, v140, s96
    v_perm_b32 v87, v146, v144, s96
    v_perm_b32 v88, v135, v133, s95
    v_perm_b32 v89, v139, v137, s95
    v_perm_b32 v90, v143, v141, s95
    v_perm_b32 v91, v147, v145, s95
    v_perm_b32 v92, v135, v133, s96
    v_perm_b32 v93, v139, v137, s96
    v_perm_b32 v94, v143, v141, s96
    v_perm_b32 v95, v147, v145, s96
    v_accvgpr_write_b32 a128, v80
    v_accvgpr_write_b32 a129, v81
    v_accvgpr_write_b32 a130, v82
    v_accvgpr_write_b32 a131, v83
    v_accvgpr_write_b32 a132, v84
    v_accvgpr_write_b32 a133, v85
    v_accvgpr_write_b32 a134, v86
    v_accvgpr_write_b32 a135, v87
    v_accvgpr_write_b32 a136, v88
    v_accvgpr_write_b32 a137, v89
    v_accvgpr_write_b32 a138, v90
    v_accvgpr_write_b32 a139, v91
    v_accvgpr_write_b32 a140, v92
    v_accvgpr_write_b32 a141, v93
    v_accvgpr_write_b32 a142, v94
    v_accvgpr_write_b32 a143, v95
    v_perm_b32 v80, v150, v148, s95
    v_perm_b32 v81, v154, v152, s95
    v_perm_b32 v82, v158, v156, s95
    v_perm_b32 v83, v162, v160, s95
    v_perm_b32 v84, v150, v148, s96
    v_perm_b32 v85, v154, v152, s96
    v_perm_b32 v86, v158, v156, s96
    v_perm_b32 v87, v162, v160, s96
    v_perm_b32 v88, v151, v149, s95
    v_perm_b32 v89, v155, v153, s95
    v_perm_b32 v90, v159, v157, s95
    v_perm_b32 v91, v163, v161, s95
    v_perm_b32 v92, v151, v149, s96
    v_perm_b32 v93, v155, v153, s96
    v_perm_b32 v94, v159, v157, s96
    v_perm_b32 v95, v163, v161, s96
    v_accvgpr_write_b32 a144, v80
    v_accvgpr_write_b32 a145, v81
    v_accvgpr_write_b32 a146, v82
    v_accvgpr_write_b32 a147, v83
    v_accvgpr_write_b32 a148, v84
    v_accvgpr_write_b32 a149, v85
    v_accvgpr_write_b32 a150, v86
    v_accvgpr_write_b32 a151, v87
    v_accvgpr_write_b32 a152, v88
    v_accvgpr_write_b32 a153, v89
    v_accvgpr_write_b32 a154, v90
    v_accvgpr_write_b32 a155, v91
    v_accvgpr_write_b32 a156, v92
    v_accvgpr_write_b32 a157, v93
    v_accvgpr_write_b32 a158, v94
    v_accvgpr_write_b32 a159, v95
    s_add_u32 s84, s67, 1376256
    buffer_load_dword v100, v6, s[16:19], s84 offen
    buffer_load_dword v101, v6, s[20:23], s84 offen
    s_add_u32 s84, s67, 1379840
    buffer_load_dword v102, v6, s[16:19], s84 offen
    buffer_load_dword v103, v6, s[20:23], s84 offen
    s_add_u32 s84, s67, 1383424
    buffer_load_dword v104, v6, s[16:19], s84 offen
    buffer_load_dword v105, v6, s[20:23], s84 offen
    s_add_u32 s84, s67, 1387008
    buffer_load_dword v106, v6, s[16:19], s84 offen
    buffer_load_dword v107, v6, s[20:23], s84 offen
    s_add_u32 s84, s67, 1390592
    buffer_load_dword v108, v6, s[16:19], s84 offen
    buffer_load_dword v109, v6, s[20:23], s84 offen
    s_add_u32 s84, s67, 1394176
    buffer_load_dword v110, v6, s[16:19], s84 offen
    buffer_load_dword v111, v6, s[20:23], s84 offen
    s_add_u32 s84, s67, 1397760
    buffer_load_dword v112, v6, s[16:19], s84 offen
    buffer_load_dword v113, v6, s[20:23], s84 offen
    s_add_u32 s84, s67, 1401344
    buffer_load_dword v114, v6, s[16:19], s84 offen
    buffer_load_dword v115, v6, s[20:23], s84 offen
    s_add_u32 s84, s67, 1490944
    buffer_load_dword v116, v6, s[16:19], s84 offen
    buffer_load_dword v117, v6, s[20:23], s84 offen
    s_add_u32 s84, s67, 1494528
    buffer_load_dword v118, v6, s[16:19], s84 offen
    buffer_load_dword v119, v6, s[20:23], s84 offen
    s_add_u32 s84, s67, 1498112
    buffer_load_dword v120, v6, s[16:19], s84 offen
    buffer_load_dword v121, v6, s[20:23], s84 offen
    s_add_u32 s84, s67, 1501696
    buffer_load_dword v122, v6, s[16:19], s84 offen
    buffer_load_dword v123, v6, s[20:23], s84 offen
    s_add_u32 s84, s67, 1505280
    buffer_load_dword v124, v6, s[16:19], s84 offen
    buffer_load_dword v125, v6, s[20:23], s84 offen
    s_add_u32 s84, s67, 1508864
    buffer_load_dword v126, v6, s[16:19], s84 offen
    buffer_load_dword v127, v6, s[20:23], s84 offen
    s_add_u32 s84, s67, 1512448
    buffer_load_dword v128, v6, s[16:19], s84 offen
    buffer_load_dword v129, v6, s[20:23], s84 offen
    s_add_u32 s84, s67, 1516032
    buffer_load_dword v130, v6, s[16:19], s84 offen
    buffer_load_dword v131, v6, s[20:23], s84 offen
    s_waitcnt vmcnt(32)
    v_perm_b32 v80, v166, v164, s95
    v_perm_b32 v81, v170, v168, s95
    v_perm_b32 v82, v174, v172, s95
    v_perm_b32 v83, v178, v176, s95
    v_perm_b32 v84, v166, v164, s96
    v_perm_b32 v85, v170, v168, s96
    v_perm_b32 v86, v174, v172, s96
    v_perm_b32 v87, v178, v176, s96
    v_perm_b32 v88, v167, v165, s95
    v_perm_b32 v89, v171, v169, s95
    v_perm_b32 v90, v175, v173, s95
    v_perm_b32 v91, v179, v177, s95
    v_perm_b32 v92, v167, v165, s96
    v_perm_b32 v93, v171, v169, s96
    v_perm_b32 v94, v175, v173, s96
    v_perm_b32 v95, v179, v177, s96
    v_accvgpr_write_b32 a160, v80
    v_accvgpr_write_b32 a161, v81
    v_accvgpr_write_b32 a162, v82
    v_accvgpr_write_b32 a163, v83
    v_accvgpr_write_b32 a164, v84
    v_accvgpr_write_b32 a165, v85
    v_accvgpr_write_b32 a166, v86
    v_accvgpr_write_b32 a167, v87
    v_accvgpr_write_b32 a168, v88
    v_accvgpr_write_b32 a169, v89
    v_accvgpr_write_b32 a170, v90
    v_accvgpr_write_b32 a171, v91
    v_accvgpr_write_b32 a172, v92
    v_accvgpr_write_b32 a173, v93
    v_accvgpr_write_b32 a174, v94
    v_accvgpr_write_b32 a175, v95
    v_perm_b32 v80, v182, v180, s95
    v_perm_b32 v81, v186, v184, s95
    v_perm_b32 v82, v190, v188, s95
    v_perm_b32 v83, v194, v192, s95
    v_perm_b32 v84, v182, v180, s96
    v_perm_b32 v85, v186, v184, s96
    v_perm_b32 v86, v190, v188, s96
    v_perm_b32 v87, v194, v192, s96
    v_perm_b32 v88, v183, v181, s95
    v_perm_b32 v89, v187, v185, s95
    v_perm_b32 v90, v191, v189, s95
    v_perm_b32 v91, v195, v193, s95
    v_perm_b32 v92, v183, v181, s96
    v_perm_b32 v93, v187, v185, s96
    v_perm_b32 v94, v191, v189, s96
    v_perm_b32 v95, v195, v193, s96
    v_accvgpr_write_b32 a176, v80
    v_accvgpr_write_b32 a177, v81
    v_accvgpr_write_b32 a178, v82
    v_accvgpr_write_b32 a179, v83
    v_accvgpr_write_b32 a180, v84
    v_accvgpr_write_b32 a181, v85
    v_accvgpr_write_b32 a182, v86
    v_accvgpr_write_b32 a183, v87
    v_accvgpr_write_b32 a184, v88
    v_accvgpr_write_b32 a185, v89
    v_accvgpr_write_b32 a186, v90
    v_accvgpr_write_b32 a187, v91
    v_accvgpr_write_b32 a188, v92
    v_accvgpr_write_b32 a189, v93
    v_accvgpr_write_b32 a190, v94
    v_accvgpr_write_b32 a191, v95
    s_add_u32 s84, s67, 1605632
    buffer_load_dword v132, v6, s[16:19], s84 offen
    buffer_load_dword v133, v6, s[20:23], s84 offen
    s_add_u32 s84, s67, 1609216
    buffer_load_dword v134, v6, s[16:19], s84 offen
    buffer_load_dword v135, v6, s[20:23], s84 offen
    s_add_u32 s84, s67, 1612800
    buffer_load_dword v136, v6, s[16:19], s84 offen
    buffer_load_dword v137, v6, s[20:23], s84 offen
    s_add_u32 s84, s67, 1616384
    buffer_load_dword v138, v6, s[16:19], s84 offen
    buffer_load_dword v139, v6, s[20:23], s84 offen
    s_add_u32 s84, s67, 1619968
    buffer_load_dword v140, v6, s[16:19], s84 offen
    buffer_load_dword v141, v6, s[20:23], s84 offen
    s_add_u32 s84, s67, 1623552
    buffer_load_dword v142, v6, s[16:19], s84 offen
    buffer_load_dword v143, v6, s[20:23], s84 offen
    s_add_u32 s84, s67, 1627136
    buffer_load_dword v144, v6, s[16:19], s84 offen
    buffer_load_dword v145, v6, s[20:23], s84 offen
    s_add_u32 s84, s67, 1630720
    buffer_load_dword v146, v6, s[16:19], s84 offen
    buffer_load_dword v147, v6, s[20:23], s84 offen
    s_add_u32 s84, s67, 1720320
    buffer_load_dword v148, v6, s[16:19], s84 offen
    buffer_load_dword v149, v6, s[20:23], s84 offen
    s_add_u32 s84, s67, 1723904
    buffer_load_dword v150, v6, s[16:19], s84 offen
    buffer_load_dword v151, v6, s[20:23], s84 offen
    s_add_u32 s84, s67, 1727488
    buffer_load_dword v152, v6, s[16:19], s84 offen
    buffer_load_dword v153, v6, s[20:23], s84 offen
    s_add_u32 s84, s67, 1731072
    buffer_load_dword v154, v6, s[16:19], s84 offen
    buffer_load_dword v155, v6, s[20:23], s84 offen
    s_add_u32 s84, s67, 1734656
    buffer_load_dword v156, v6, s[16:19], s84 offen
    buffer_load_dword v157, v6, s[20:23], s84 offen
    s_add_u32 s84, s67, 1738240
    buffer_load_dword v158, v6, s[16:19], s84 offen
    buffer_load_dword v159, v6, s[20:23], s84 offen
    s_add_u32 s84, s67, 1741824
    buffer_load_dword v160, v6, s[16:19], s84 offen
    buffer_load_dword v161, v6, s[20:23], s84 offen
    s_add_u32 s84, s67, 1745408
    buffer_load_dword v162, v6, s[16:19], s84 offen
    buffer_load_dword v163, v6, s[20:23], s84 offen
    s_waitcnt vmcnt(32)
    v_perm_b32 v80, v102, v100, s95
    v_perm_b32 v81, v106, v104, s95
    v_perm_b32 v82, v110, v108, s95
    v_perm_b32 v83, v114, v112, s95
    v_perm_b32 v84, v102, v100, s96
    v_perm_b32 v85, v106, v104, s96
    v_perm_b32 v86, v110, v108, s96
    v_perm_b32 v87, v114, v112, s96
    v_perm_b32 v88, v103, v101, s95
    v_perm_b32 v89, v107, v105, s95
    v_perm_b32 v90, v111, v109, s95
    v_perm_b32 v91, v115, v113, s95
    v_perm_b32 v92, v103, v101, s96
    v_perm_b32 v93, v107, v105, s96
    v_perm_b32 v94, v111, v109, s96
    v_perm_b32 v95, v115, v113, s96
    v_accvgpr_write_b32 a192, v80
    v_accvgpr_write_b32 a193, v81
    v_accvgpr_write_b32 a194, v82
    v_accvgpr_write_b32 a195, v83
    v_accvgpr_write_b32 a196, v84
    v_accvgpr_write_b32 a197, v85
    v_accvgpr_write_b32 a198, v86
    v_accvgpr_write_b32 a199, v87
    v_accvgpr_write_b32 a200, v88
    v_accvgpr_write_b32 a201, v89
    v_accvgpr_write_b32 a202, v90
    v_accvgpr_write_b32 a203, v91
    v_accvgpr_write_b32 a204, v92
    v_accvgpr_write_b32 a205, v93
    v_accvgpr_write_b32 a206, v94
    v_accvgpr_write_b32 a207, v95
    v_perm_b32 v80, v118, v116, s95
    v_perm_b32 v81, v122, v120, s95
    v_perm_b32 v82, v126, v124, s95
    v_perm_b32 v83, v130, v128, s95
    v_perm_b32 v84, v118, v116, s96
    v_perm_b32 v85, v122, v120, s96
    v_perm_b32 v86, v126, v124, s96
    v_perm_b32 v87, v130, v128, s96
    v_perm_b32 v88, v119, v117, s95
    v_perm_b32 v89, v123, v121, s95
    v_perm_b32 v90, v127, v125, s95
    v_perm_b32 v91, v131, v129, s95
    v_perm_b32 v92, v119, v117, s96
    v_perm_b32 v93, v123, v121, s96
    v_perm_b32 v94, v127, v125, s96
    v_perm_b32 v95, v131, v129, s96
    v_accvgpr_write_b32 a208, v80
    v_accvgpr_write_b32 a209, v81
    v_accvgpr_write_b32 a210, v82
    v_accvgpr_write_b32 a211, v83
    v_accvgpr_write_b32 a212, v84
    v_accvgpr_write_b32 a213, v85
    v_accvgpr_write_b32 a214, v86
    v_accvgpr_write_b32 a215, v87
    v_accvgpr_write_b32 a216, v88
    v_accvgpr_write_b32 a217, v89
    v_accvgpr_write_b32 a218, v90
    v_accvgpr_write_b32 a219, v91
    v_accvgpr_write_b32 a220, v92
    v_accvgpr_write_b32 a221, v93
    v_accvgpr_write_b32 a222, v94
    v_accvgpr_write_b32 a223, v95
    s_waitcnt vmcnt(0)
    v_perm_b32 v80, v134, v132, s95
    v_perm_b32 v81, v138, v136, s95
    v_perm_b32 v82, v142, v140, s95
    v_perm_b32 v83, v146, v144, s95
    v_perm_b32 v84, v134, v132, s96
    v_perm_b32 v85, v138, v136, s96
    v_perm_b32 v86, v142, v140, s96
    v_perm_b32 v87, v146, v144, s96
    v_perm_b32 v88, v135, v133, s95
    v_perm_b32 v89, v139, v137, s95
    v_perm_b32 v90, v143, v141, s95
    v_perm_b32 v91, v147, v145, s95
    v_perm_b32 v92, v135, v133, s96
    v_perm_b32 v93, v139, v137, s96
    v_perm_b32 v94, v143, v141, s96
    v_perm_b32 v95, v147, v145, s96
    v_accvgpr_write_b32 a224, v80
    v_accvgpr_write_b32 a225, v81
    v_accvgpr_write_b32 a226, v82
    v_accvgpr_write_b32 a227, v83
    v_accvgpr_write_b32 a228, v84
    v_accvgpr_write_b32 a229, v85
    v_accvgpr_write_b32 a230, v86
    v_accvgpr_write_b32 a231, v87
    v_accvgpr_write_b32 a232, v88
    v_accvgpr_write_b32 a233, v89
    v_accvgpr_write_b32 a234, v90
    v_accvgpr_write_b32 a235, v91
    v_accvgpr_write_b32 a236, v92
    v_accvgpr_write_b32 a237, v93
    v_accvgpr_write_b32 a238, v94
    v_accvgpr_write_b32 a239, v95
    v_perm_b32 v80, v150, v148, s95
    v_perm_b32 v81, v154, v152, s95
    v_perm_b32 v82, v158, v156, s95
    v_perm_b32 v83, v162, v160, s95
    v_perm_b32 v84, v150, v148, s96
    v_perm_b32 v85, v154, v152, s96
    v_perm_b32 v86, v158, v156, s96
    v_perm_b32 v87, v162, v160, s96
    v_perm_b32 v88, v151, v149, s95
    v_perm_b32 v89, v155, v153, s95
    v_perm_b32 v90, v159, v157, s95
    v_perm_b32 v91, v163, v161, s95
    v_perm_b32 v92, v151, v149, s96
    v_perm_b32 v93, v155, v153, s96
    v_perm_b32 v94, v159, v157, s96
    v_perm_b32 v95, v163, v161, s96
    v_accvgpr_write_b32 a240, v80
    v_accvgpr_write_b32 a241, v81
    v_accvgpr_write_b32 a242, v82
    v_accvgpr_write_b32 a243, v83
    v_accvgpr_write_b32 a244, v84
    v_accvgpr_write_b32 a245, v85
    v_accvgpr_write_b32 a246, v86
    v_accvgpr_write_b32 a247, v87
    v_accvgpr_write_b32 a248, v88
    v_accvgpr_write_b32 a249, v89
    v_accvgpr_write_b32 a250, v90
    v_accvgpr_write_b32 a251, v91
    v_accvgpr_write_b32 a252, v92
    v_accvgpr_write_b32 a253, v93
    v_accvgpr_write_b32 a254, v94
    v_accvgpr_write_b32 a255, v95
    v_mov_b32 v16, 20
    s_mov_b32 s83, 0
WD_15:
    buffer_load_dword v17, v16, s[12:15], 0 offen sc1
    s_add_u32 s83, s83, 1
    s_cmp_gt_u32 s83, 0x400000
    s_cbranch_scc1 B_fail
    s_waitcnt vmcnt(0)
    v_readfirstlane_b32 s84, v17
    s_nop 0
    s_cmp_ge_u32 s84, 4
    s_cbranch_scc1 WDd_16
    s_sleep 2
    s_branch WD_15
WDd_16:
    v_lshrrev_b32 v18, 1, v4
    s_mov_b32 s85, 0x7210000
    s_mov_b32 s83, 0
WX_17:
    buffer_load_dwordx2 v[16:17], v18, s[8:11], s85 offen sc1
    s_add_u32 s83, s83, 1
    s_cmp_gt_u32 s83, 0x400000
    s_cbranch_scc1 B_fail
    s_waitcnt vmcnt(0)
    v_min_u32 v16, v16, v17
    v_cmp_eq_u32 vcc, 0, v16
    s_cbranch_vccz WXd_18
    s_sleep 2
    s_branch WX_17
WXd_18:
    s_lshl_b32 s70, s61, 13
    s_lshl_b32 s69, s64, 15
    s_add_u32 m0, s70, 0
    s_nop 0
    buffer_load_dwordx4 v5, s[8:11], s69 offen offset:0 sc1 lds
    s_add_u32 m0, s70, 960
    s_nop 0
    buffer_load_dwordx4 v5, s[8:11], s69 offen offset:64 sc1 lds
    s_add_u32 m0, s70, 1920
    s_nop 0
    buffer_load_dwordx4 v5, s[8:11], s69 offen offset:128 sc1 lds
    s_add_u32 m0, s70, 2880
    s_nop 0
    buffer_load_dwordx4 v5, s[8:11], s69 offen offset:192 sc1 lds
    s_add_u32 m0, s70, 3840
    s_nop 0
    buffer_load_dwordx4 v5, s[8:11], s69 offen offset:256 sc1 lds
    s_add_u32 m0, s70, 4800
    s_nop 0
    buffer_load_dwordx4 v5, s[8:11], s69 offen offset:320 sc1 lds
    s_add_u32 m0, s70, 5760
    s_nop 0
    buffer_load_dwordx4 v5, s[8:11], s69 offen offset:384 sc1 lds
    s_add_u32 m0, s70, 6720
    s_nop 0
    buffer_load_dwordx4 v5, s[8:11], s69 offen offset:448 sc1 lds
    s_mov_b32 s72, 0
    v_mov_b32 v7, v4
    s_waitcnt vmcnt(0)
    s_barrier
Ah_loop:
    s_add_u32 s85, s64, s65
    s_min_u32 s85, s85, 63
    s_lshl_b32 s69, s85, 15
    s_xor_b32 s70, s70, 32768
    ds_read_b128 v[16:19], v7 offset:0
    ds_read_b128 v[20:23], v7 offset:16384
    ds_read_b128 v[24:27], v7 offset:1024
    ds_read_b128 v[28:31], v7 offset:17408
    s_add_u32 m0, s70, 0
    s_nop 0
    buffer_load_dwordx4 v5, s[8:11], s69 offen offset:0 sc1 lds
    s_add_u32 m0, s70, 960
    s_nop 0
    buffer_load_dwordx4 v5, s[8:11], s69 offen offset:64 sc1 lds
    s_add_u32 m0, s70, 1920
    s_nop 0
    buffer_load_dwordx4 v5, s[8:11], s69 offen offset:128 sc1 lds
    s_add_u32 m0, s70, 2880
    s_nop 0
    buffer_load_dwordx4 v5, s[8:11], s69 offen offset:192 sc1 lds
    s_add_u32 m0, s70, 3840
    s_nop 0
    buffer_load_dwordx4 v5, s[8:11], s69 offen offset:256 sc1 lds
    s_add_u32 m0, s70, 4800
    s_nop 0
    buffer_load_dwordx4 v5, s[8:11], s69 offen offset:320 sc1 lds
    s_add_u32 m0, s70, 5760
    s_nop 0
    buffer_load_dwordx4 v5, s[8:11], s69 offen offset:384 sc1 lds
    s_add_u32 m0, s70, 6720
    s_nop 0
    buffer_load_dwordx4 v5, s[8:11], s69 offen offset:448 sc1 lds
    ds_read_b128 v[32:35], v7 offset:2048
    ds_read_b128 v[36:39], v7 offset:18432
    s_waitcnt lgkmcnt(4)
    v_mfma_f32_16x16x32_bf16 v[48:51], a[0:3], v[16:19], 0
    v_mfma_f32_16x16x32_bf16 v[52:55], a[4:7], v[16:19], 0
    v_mfma_f32_16x16x32_bf16 v[56:59], a[8:11], v[16:19], 0
    v_mfma_f32_16x16x32_bf16 v[60:63], a[12:15], v[16:19], 0
    v_mfma_f32_16x16x32_bf16 v[64:67], a[0:3], v[20:23], 0
    v_mfma_f32_16x16x32_bf16 v[68:71], a[4:7], v[20:23], 0
    v_mfma_f32_16x16x32_bf16 v[72:75], a[8:11], v[20:23], 0
    v_mfma_f32_16x16x32_bf16 v[76:79], a[12:15], v[20:23], 0
    ds_read_b128 v[16:19], v7 offset:3072
    ds_read_b128 v[20:23], v7 offset:19456
    s_waitcnt lgkmcnt(4)
    v_mfma_f32_16x16x32_bf16 v[48:51], a[16:19], v[24:27], v[48:51]
    v_mfma_f32_16x16x32_bf16 v[52:55], a[20:23], v[24:27], v[52:55]
    v_mfma_f32_16x16x32_bf16 v[56:59], a[24:27], v[24:27], v[56:59]
    v_mfma_f32_16x16x32_bf16 v[60:63], a[28:31], v[24:27], v[60:63]
    v_mfma_f32_16x16x32_bf16 v[64:67], a[16:19], v[28:31], v[64:67]
    v_mfma_f32_16x16x32_bf16 v[68:71], a[20:23], v[28:31], v[68:71]
    v_mfma_f32_16x16x32_bf16 v[72:75], a[24:27], v[28:31], v[72:75]
    v_mfma_f32_16x16x32_bf16 v[76:79], a[28:31], v[28:31], v[76:79]
    ds_read_b128 v[24:27], v7 offset:4096
    ds_read_b128 v[28:31], v7 offset:20480
    s_waitcnt lgkmcnt(4)
    v_mfma_f32_16x16x32_bf16 v[48:51], a[32:35], v[32:35], v[48:51]
    v_mfma_f32_16x16x32_bf16 v[52:55], a[36:39], v[32:35], v[52:55]
    v_mfma_f32_16x16x32_bf16 v[56:59], a[40:43], v[32:35], v[56:59]
    v_mfma_f32_16x16x32_bf16 v[60:63], a[44:47], v[32:35], v[60:63]
    v_mfma_f32_16x16x32_bf16 v[64:67], a[32:35], v[36:39], v[64:67]
    v_mfma_f32_16x16x32_bf16 v[68:71], a[36:39], v[36:39], v[68:71]
    v_mfma_f32_16x16x32_bf16 v[72:75], a[40:43], v[36:39], v[72:75]
    v_mfma_f32_16x16x32_bf16 v[76:79], a[44:47], v[36:39], v[76:79]
    ds_read_b128 v[32:35], v7 offset:5120
    ds_read_b128 v[36:39], v7 offset:21504
    s_waitcnt lgkmcnt(4)
    v_mfma_f32_16x16x32_bf16 v[48:51], a[48:51], v[16:19], v[48:51]
    v_mfma_f32_16x16x32_bf16 v[52:55], a[52:55], v[16:19], v[52:55]
    v_mfma_f32_16x16x32_bf16 v[56:59], a[56:59], v[16:19], v[56:59]
    v_mfma_f32_16x16x32_bf16 v[60:63], a[60:63], v[16:19], v[60:63]
    v_mfma_f32_16x16x32_bf16 v[64:67], a[48:51], v[20:23], v[64:67]
    v_mfma_f32_16x16x32_bf16 v[68:71], a[52:55], v[20:23], v[68:71]
    v_mfma_f32_16x16x32_bf16 v[72:75], a[56:59], v[20:23], v[72:75]
    v_mfma_f32_16x16x32_bf16 v[76:79], a[60:63], v[20:23], v[76:79]
    ds_read_b128 v[16:19], v7 offset:6144
    ds_read_b128 v[20:23], v7 offset:22528
    s_waitcnt lgkmcnt(4)
    v_mfma_f32_16x16x32_bf16 v[48:51], a[64:67], v[24:27], v[48:51]
    v_mfma_f32_16x16x32_bf16 v[52:55], a[68:71], v[24:27], v[52:55]
    v_mfma_f32_16x16x32_bf16 v[56:59], a[72:75], v[24:27], v[56:59]
    v_mfma_f32_16x16x32_bf16 v[60:63], a[76:79], v[24:27], v[60:63]
    v_mfma_f32_16x16x32_bf16 v[64:67], a[64:67], v[28:31], v[64:67]
    v_mfma_f32_16x16x32_bf16 v[68:71], a[68:71], v[28:31], v[68:71]
    v_mfma_f32_16x16x32_bf16 v[72:75], a[72:75], v[28:31], v[72:75]
    v_mfma_f32_16x16x32_bf16 v[76:79], a[76:79], v[28:31], v[76:79]
    ds_read_b128 v[24:27], v7 offset:7168
    ds_read_b128 v[28:31], v7 offset:23552
    s_waitcnt lgkmcnt(4)
    v_mfma_f32_16x16x32_bf16 v[48:51], a[80:83], v[32:35], v[48:51]
    v_mfma_f32_16x16x32_bf16 v[52:55], a[84:87], v[32:35], v[52:55]
    v_mfma_f32_16x16x32_bf16 v[56:59], a[88:91], v[32:35], v[56:59]
    v_mfma_f32_16x16x32_bf16 v[60:63], a[92:95], v[32:35], v[60:63]
    v_mfma_f32_16x16x32_bf16 v[64:67], a[80:83], v[36:39], v[64:67]
    v_mfma_f32_16x16x32_bf16 v[68:71], a[84:87], v[36:39], v[68:71]
    v_mfma_f32_16x16x32_bf16 v[72:75], a[88:91], v[36:39], v[72:75]
    v_mfma_f32_16x16x32_bf16 v[76:79], a[92:95], v[36:39], v[76:79]
    ds_read_b128 v[32:35], v7 offset:8192
    ds_read_b128 v[36:39], v7 offset:24576
    s_waitcnt lgkmcnt(4)
    v_mfma_f32_16x16x32_bf16 v[48:51], a[96:99], v[16:19], v[48:51]
    v_mfma_f32_16x16x32_bf16 v[52:55], a[100:103], v[16:19], v[52:55]
    v_mfma_f32_16x16x32_bf16 v[56:59], a[104:107], v[16:19], v[56:59]
    v_mfma_f32_16x16x32_bf16 v[60:63], a[108:111], v[16:19], v[60:63]
    v_mfma_f32_16x16x32_bf16 v[64:67], a[96:99], v[20:23], v[64:67]
    v_mfma_f32_16x16x32_bf16 v[68:71], a[100:103], v[20:23], v[68:71]
    v_mfma_f32_16x16x32_bf16 v[72:75], a[104:107], v[20:23], v[72:75]
    v_mfma_f32_16x16x32_bf16 v[76:79], a[108:111], v[20:23], v[76:79]
    ds_read_b128 v[16:19], v7 offset:9216
    ds_read_b128 v[20:23], v7 offset:25600
    s_waitcnt lgkmcnt(4)
    v_mfma_f32_16x16x32_bf16 v[48:51], a[112:115], v[24:27], v[48:51]
    v_mfma_f32_16x16x32_bf16 v[52:55], a[116:119], v[24:27], v[52:55]
    v_mfma_f32_16x16x32_bf16 v[56:59], a[120:123], v[24:27], v[56:59]
    v_mfma_f32_16x16x32_bf16 v[60:63], a[124:127], v[24:27], v[60:63]
    v_mfma_f32_16x16x32_bf16 v[64:67], a[112:115], v[28:31], v[64:67]
    v_mfma_f32_16x16x32_bf16 v[68:71], a[116:119], v[28:31], v[68:71]
    v_mfma_f32_16x16x32_bf16 v[72:75], a[120:123], v[28:31], v[72:75]
    v_mfma_f32_16x16x32_bf16 v[76:79], a[124:127], v[28:31], v[76:79]
    ds_read_b128 v[24:27], v7 offset:10240
    ds_read_b128 v[28:31], v7 offset:26624
    s_waitcnt lgkmcnt(4)
    v_mfma_f32_16x16x32_bf16 v[48:51], a[128:131], v[32:35], v[48:51]
    v_mfma_f32_16x16x32_bf16 v[52:55], a[132:135], v[32:35], v[52:55]
    v_mfma_f32_16x16x32_bf16 v[56:59], a[136:139], v[32:35], v[56:59]
    v_mfma_f32_16x16x32_bf16 v[60:63], a[140:143], v[32:35], v[60:63]
    v_mfma_f32_16x16x32_bf16 v[64:67], a[128:131], v[36:39], v[64:67]
    v_mfma_f32_16x16x32_bf16 v[68:71], a[132:135], v[36:39], v[68:71]
    v_mfma_f32_16x16x32_bf16 v[72:75], a[136:139], v[36:39], v[72:75]
    v_mfma_f32_16x16x32_bf16 v[76:79], a[140:143], v[36:39], v[76:79]
    s_waitcnt vmcnt(8)
    s_barrier
    s_or_b32 s84, s61, s72
    s_cmp_lg_u32 s84, 0x100
    s_cbranch_scc1 Ah_nf_19
    s_mov_b64 exec, 1
    v_mov_b32 v250, 0
    v_mov_b32 v251, 1
    buffer_store_dword v251, v250, s[8:11], s71 offen sc1
    s_mov_b64 exec, -1
Ah_nf_19:
    ds_read_b128 v[32:35], v7 offset:11264
    ds_read_b128 v[36:39], v7 offset:27648
    s_waitcnt lgkmcnt(4)
    v_mfma_f32_16x16x32_bf16 v[48:51], a[144:147], v[16:19], v[48:51]
    v_mfma_f32_16x16x32_bf16 v[52:55], a[148:151], v[16:19], v[52:55]
    v_mfma_f32_16x16x32_bf16 v[56:59], a[152:155], v[16:19], v[56:59]
    v_mfma_f32_16x16x32_bf16 v[60:63], a[156:159], v[16:19], v[60:63]
    v_mfma_f32_16x16x32_bf16 v[64:67], a[144:147], v[20:23], v[64:67]
    v_mfma_f32_16x16x32_bf16 v[68:71], a[148:151], v[20:23], v[68:71]
    v_mfma_f32_16x16x32_bf16 v[72:75], a[152:155], v[20:23], v[72:75]
    v_mfma_f32_16x16x32_bf16 v[76:79], a[156:159], v[20:23], v[76:79]
    ds_read_b128 v[16:19], v7 offset:12288
    ds_read_b128 v[20:23], v7 offset:28672
    s_waitcnt lgkmcnt(4)
    v_mfma_f32_16x16x32_bf16 v[48:51], a[160:163], v[24:27], v[48:51]
    v_mfma_f32_16x16x32_bf16 v[52:55], a[164:167], v[24:27], v[52:55]
    v_mfma_f32_16x16x32_bf16 v[56:59], a[168:171], v[24:27], v[56:59]
    v_mfma_f32_16x16x32_bf16 v[60:63], a[172:175], v[24:27], v[60:63]
    v_mfma_f32_16x16x32_bf16 v[64:67], a[160:163], v[28:31], v[64:67]
    v_mfma_f32_16x16x32_bf16 v[68:71], a[164:167], v[28:31], v[68:71]
    v_mfma_f32_16x16x32_bf16 v[72:75], a[168:171], v[28:31], v[72:75]
    v_mfma_f32_16x16x32_bf16 v[76:79], a[172:175], v[28:31], v[76:79]
    ds_read_b128 v[24:27], v7 offset:13312
    ds_read_b128 v[28:31], v7 offset:29696
    s_waitcnt lgkmcnt(4)
    v_mfma_f32_16x16x32_bf16 v[48:51], a[176:179], v[32:35], v[48:51]
    v_mfma_f32_16x16x32_bf16 v[52:55], a[180:183], v[32:35], v[52:55]
    v_mfma_f32_16x16x32_bf16 v[56:59], a[184:187], v[32:35], v[56:59]
    v_mfma_f32_16x16x32_bf16 v[60:63], a[188:191], v[32:35], v[60:63]
    v_mfma_f32_16x16x32_bf16 v[64:67], a[176:179], v[36:39], v[64:67]
    v_mfma_f32_16x16x32_bf16 v[68:71], a[180:183], v[36:39], v[68:71]
    v_mfma_f32_16x16x32_bf16 v[72:75], a[184:187], v[36:39], v[72:75]
    v_mfma_f32_16x16x32_bf16 v[76:79], a[188:191], v[36:39], v[76:79]
    ds_read_b128 v[32:35], v7 offset:14336
    ds_read_b128 v[36:39], v7 offset:30720
    s_waitcnt lgkmcnt(4)
    v_mfma_f32_16x16x32_bf16 v[48:51], a[192:195], v[16:19], v[48:51]
    v_mfma_f32_16x16x32_bf16 v[52:55], a[196:199], v[16:19], v[52:55]
    v_mfma_f32_16x16x32_bf16 v[56:59], a[200:203], v[16:19], v[56:59]
    v_mfma_f32_16x16x32_bf16 v[60:63], a[204:207], v[16:19], v[60:63]
    v_mfma_f32_16x16x32_bf16 v[64:67], a[192:195], v[20:23], v[64:67]
    v_mfma_f32_16x16x32_bf16 v[68:71], a[196:199], v[20:23], v[68:71]
    v_mfma_f32_16x16x32_bf16 v[72:75], a[200:203], v[20:23], v[72:75]
    v_mfma_f32_16x16x32_bf16 v[76:79], a[204:207], v[20:23], v[76:79]
    ds_read_b128 v[16:19], v7 offset:15360
    ds_read_b128 v[20:23], v7 offset:31744
    s_waitcnt lgkmcnt(4)
    v_mfma_f32_16x16x32_bf16 v[48:51], a[208:211], v[24:27], v[48:51]
    v_mfma_f32_16x16x32_bf16 v[52:55], a[212:215], v[24:27], v[52:55]
    v_mfma_f32_16x16x32_bf16 v[56:59], a[216:219], v[24:27], v[56:59]
    v_mfma_f32_16x16x32_bf16 v[60:63], a[220:223], v[24:27], v[60:63]
    v_mfma_f32_16x16x32_bf16 v[64:67], a[208:211], v[28:31], v[64:67]
    v_mfma_f32_16x16x32_bf16 v[68:71], a[212:215], v[28:31], v[68:71]
    v_mfma_f32_16x16x32_bf16 v[72:75], a[216:219], v[28:31], v[72:75]
    v_mfma_f32_16x16x32_bf16 v[76:79], a[220:223], v[28:31], v[76:79]
    s_waitcnt lgkmcnt(2)
    v_mfma_f32_16x16x32_bf16 v[48:51], a[224:227], v[32:35], v[48:51]
    v_mfma_f32_16x16x32_bf16 v[52:55], a[228:231], v[32:35], v[52:55]
    v_mfma_f32_16x16x32_bf16 v[56:59], a[232:235], v[32:35], v[56:59]
    v_mfma_f32_16x16x32_bf16 v[60:63], a[236:239], v[32:35], v[60:63]
    v_mfma_f32_16x16x32_bf16 v[64:67], a[224:227], v[36:39], v[64:67]
    v_mfma_f32_16x16x32_bf16 v[68:71], a[228:231], v[36:39], v[68:71]
    v_mfma_f32_16x16x32_bf16 v[72:75], a[232:235], v[36:39], v[72:75]
    v_mfma_f32_16x16x32_bf16 v[76:79], a[236:239], v[36:39], v[76:79]
    s_waitcnt lgkmcnt(0)
    v_mfma_f32_16x16x32_bf16 v[48:51], a[240:243], v[16:19], v[48:51]
    v_mfma_f32_16x16x32_bf16 v[52:55], a[244:247], v[16:19], v[52:55]
    v_mfma_f32_16x16x32_bf16 v[56:59], a[248:251], v[16:19], v[56:59]
    v_mfma_f32_16x16x32_bf16 v[60:63], a[252:255], v[16:19], v[60:63]
    v_mfma_f32_16x16x32_bf16 v[64:67], a[240:243], v[20:23], v[64:67]
    v_mfma_f32_16x16x32_bf16 v[68:71], a[244:247], v[20:23], v[68:71]
    v_mfma_f32_16x16x32_bf16 v[72:75], a[248:251], v[20:23], v[72:75]
    v_mfma_f32_16x16x32_bf16 v[76:79], a[252:255], v[20:23], v[76:79]
    s_waitcnt vmcnt(0)
    s_barrier
    s_mul_i32 s84, s64, 114688
    s_add_u32 s84, s84, s68
    s_add_u32 s85, s84, 57344
    v_cvt_pk_bf16_f32 v48, v48, v52
    v_cvt_pk_bf16_f32 v56, v56, v60
    v_and_b32 v52, 0xffff0000, v48
    v_and_b32 v60, 0xffff0000, v56
    v_lshlrev_b32 v48, 16, v48
    v_lshlrev_b32 v56, 16, v56
    v_mul_f32 v48, v48, v56
    v_mul_f32 v52, v52, v60
    v_cvt_pk_bf16_f32 v80, v48, v52
    v_cvt_pk_bf16_f32 v49, v49, v53
    v_cvt_pk_bf16_f32 v57, v57, v61
    v_and_b32 v53, 0xffff0000, v49
    v_and_b32 v61, 0xffff0000, v57
    v_lshlrev_b32 v49, 16, v49
    v_lshlrev_b32 v57, 16, v57
    v_mul_f32 v49, v49, v57
    v_mul_f32 v53, v53, v61
    v_cvt_pk_bf16_f32 v81, v49, v53
    v_cvt_pk_bf16_f32 v50, v50, v54
    v_cvt_pk_bf16_f32 v58, v58, v62
    v_and_b32 v54, 0xffff0000, v50
    v_and_b32 v62, 0xffff0000, v58
    v_lshlrev_b32 v50, 16, v50
    v_lshlrev_b32 v58, 16, v58
    v_mul_f32 v50, v50, v58
    v_mul_f32 v54, v54, v62
    v_cvt_pk_bf16_f32 v82, v50, v54
    v_cvt_pk_bf16_f32 v51, v51, v55
    v_cvt_pk_bf16_f32 v59, v59, v63
    v_and_b32 v55, 0xffff0000, v51
    v_and_b32 v63, 0xffff0000, v59
    v_lshlrev_b32 v51, 16, v51
    v_lshlrev_b32 v59, 16, v59
    v_mul_f32 v51, v51, v59
    v_mul_f32 v55, v55, v63
    v_cvt_pk_bf16_f32 v83, v51, v55
    buffer_store_dwordx4 v[80:83], v4, s[8:11], s84 offen sc1
    v_cvt_pk_bf16_f32 v64, v64, v68
    v_cvt_pk_bf16_f32 v72, v72, v76
    v_and_b32 v68, 0xffff0000, v64
    v_and_b32 v76, 0xffff0000, v72
    v_lshlrev_b32 v64, 16, v64
    v_lshlrev_b32 v72, 16, v72
    v_mul_f32 v64, v64, v72
    v_mul_f32 v68, v68, v76
    v_cvt_pk_bf16_f32 v84, v64, v68
    v_cvt_pk_bf16_f32 v65, v65, v69
    v_cvt_pk_bf16_f32 v73, v73, v77
    v_and_b32 v69, 0xffff0000, v65
    v_and_b32 v77, 0xffff0000, v73
    v_lshlrev_b32 v65, 16, v65
    v_lshlrev_b32 v73, 16, v73
    v_mul_f32 v65, v65, v73
    v_mul_f32 v69, v69, v77
    v_cvt_pk_bf16_f32 v85, v65, v69
    v_cvt_pk_bf16_f32 v66, v66, v70
    v_cvt_pk_bf16_f32 v74, v74, v78
    v_and_b32 v70, 0xffff0000, v66
    v_and_b32 v78, 0xffff0000, v74
    v_lshlrev_b32 v66, 16, v66
    v_lshlrev_b32 v74, 16, v74
    v_mul_f32 v66, v66, v74
    v_mul_f32 v70, v70, v78
    v_cvt_pk_bf16_f32 v86, v66, v70
    v_cvt_pk_bf16_f32 v67, v67, v71
    v_cvt_pk_bf16_f32 v75, v75, v79
    v_and_b32 v71, 0xffff0000, v67
    v_and_b32 v79, 0xffff0000, v75
    v_lshlrev_b32 v67, 16, v67
    v_lshlrev_b32 v75, 16, v75
    v_mul_f32 v67, v67, v75
    v_mul_f32 v71, v71, v79
    v_cvt_pk_bf16_f32 v87, v67, v71
    buffer_store_dwordx4 v[84:87], v4, s[8:11], s85 offen sc1
    s_lshl_b32 s84, s64, 6
    s_add_u32 s71, s84, s73
    s_mov_b32 s72, 0x100
    v_xor_b32 v7, 32768, v7
    s_add_u32 s64, s64, s65
    s_cmp_lt_u32 s64, 64
    s_cbranch_scc1 Ah_loop
    s_waitcnt vmcnt(0)
    s_barrier
    s_cmp_lg_u32 s61, 0
    s_cbranch_scc1 Ah_nf_20
    s_mov_b64 exec, 1
    v_mov_b32 v250, 0
    v_mov_b32 v251, 1
    buffer_store_dword v251, v250, s[8:11], s71 offen sc1
    s_mov_b64 exec, -1
Ah_nf_20:
    s_branch A_done
A_done:
    v_mov_b32 v250, 20
    s_mov_b32 s83, 0
WD_21:
    buffer_load_dword v251, v250, s[12:15], 0 offen sc1
    s_add_u32 s83, s83, 1
    s_cmp_gt_u32 s83, 0x400000
    s_cbranch_scc1 B_fail
    s_waitcnt vmcnt(0)
    v_readfirstlane_b32 s84, v251
    s_nop 0
    s_cmp_ge_u32 s84, 4
    s_cbranch_scc1 WDd_22
    s_sleep 2
    s_branch WD_21
WDd_22:
    s_mov_b32 s83, 0
    v_mov_b32 v250, 0
K_arr:
    buffer_load_dword v251, v250, s[12:15], 0 offen offset:0 sc1
    buffer_load_dword v252, v250, s[12:15], 0 offen offset:128 sc1
    s_add_u32 s83, s83, 1
    s_cmp_gt_u32 s83, 0x400000
    s_cbranch_scc1 B_fail
    s_waitcnt vmcnt(0)
    v_readfirstlane_b32 s84, v251
    v_readfirstlane_b32 s85, v252
    s_cmp_ge_u32 s84, 32
    s_cbranch_scc1 K_arr2
    s_add_u32 s84, s84, s85
    s_cmp_lt_u32 s84, 256
    s_cbranch_scc1 K_arr
K_arr2:
    v_mov_b32 v253, 14336
    s_cmp_lg_u32 s61, 0
    s_cbranch_scc1 TK_23
    s_mov_b64 exec, 1
    v_mov_b32 v251, 1
    v_mov_b32 v252, 0
    v_mov_b32 v251, 32
    s_cmp_lt_u32 s84, 256
    s_cbranch_scc1 TKs_24
    v_mov_b32 v251, 1
    buffer_atomic_add v251, v252, s[12:15], 0 offen sc0
    s_waitcnt vmcnt(0)
TKs_24:
    ds_write_b32 v253, v251
    s_waitcnt lgkmcnt(0)
    s_mov_b64 exec, -1
TK_23:
    s_barrier
    ds_read_b32 v251, v253
    s_waitcnt lgkmcnt(0)
    v_readfirstlane_b32 s62, v251
    s_barrier
    s_cmp_ge_u32 s62, 32
    s_cbranch_scc1 K_b
    s_cmp_lg_u32 s61, 0
    s_cbranch_scc1 DA_25
    s_mov_b64 exec, 1
    v_mov_b32 v251, 1
    v_mov_b32 v252, 8
    buffer_atomic_add v251, v252, s[12:15], 0 offen
    s_waitcnt vmcnt(0)
    s_mov_b64 exec, -1
DA_25:
    s_branch K_rec
K_b:
    v_mov_b32 v253, 14336
    s_cmp_lg_u32 s61, 0
    s_cbranch_scc1 TK_26
    s_mov_b64 exec, 1
    v_mov_b32 v251, 1
    v_mov_b32 v252, 132
    buffer_atomic_add v251, v252, s[12:15], 0 offen sc0
    s_waitcnt vmcnt(0)
    ds_write_b32 v253, v251
    s_waitcnt lgkmcnt(0)
    s_mov_b64 exec, -1
TK_26:
    s_barrier
    ds_read_b32 v251, v253
    s_waitcnt lgkmcnt(0)
    v_readfirstlane_b32 s62, v251
    s_barrier
    s_cmp_lt_u32 s62, 96
    s_cbranch_scc1 K_t1
    s_sub_u32 s62, s62, 96
    s_cmp_ge_u32 s62, 128
    s_cbranch_scc1 K_exit
    v_and_b32 v1, 63, v0
    v_and_b32 v2, 15, v1
    v_lshrrev_b32 v3, 4, v1
    v_lshlrev_b32 v4, 4, v1
    s_mov_b32 s95, 0x05040100
    s_mov_b32 s96, 0x07060302
    s_and_b32 s65, s62, 15
    s_lshr_b32 s64, s62, 4
    s_mov_b32 s70, 0xbfb8aa3b
    v_lshlrev_b32 v5, 14, v3
    v_lshl_add_u32 v5, v2, 2, v5
    v_lshlrev_b32 v6, 13, v3
    v_lshl_add_u32 v6, v2, 2, v6
    v_lshlrev_b32 v7, 2, v1
    v_lshrrev_b32 v11, 2, v1
    v_lshlrev_b32 v11, 7, v11
    v_and_b32 v12, 3, v1
    v_lshl_add_u32 v11, v12, 2, v11
    s_lshl_b32 s84, s61, 12
    v_add_u32 v8, s84, v4
    s_lshl_b32 s84, s61, 10
    v_add_u32 v9, s84, v4
    v_lshlrev_b32 v10, 10, v2
    v_lshl_add_u32 v10, v3, 4, v10
    s_lshl_b32 s84, s65, 6
    s_lshl_b32 s85, s61, 2
    s_add_u32 s84, s84, s85
    v_add_u32 v10, s84, v10
    s_mov_b32 s16, s42
    s_and_b32 s17, s43, 0xffff
    s_mov_b32 s18, 0x400000
    s_mov_b32 s19, 0x20000
    s_mov_b32 s20, s52
    s_and_b32 s21, s53, 0xffff
    s_mov_b32 s22, 0x1c0000
    s_mov_b32 s23, 0x20000
    s_lshl_b32 s84, s65, 6
    s_lshl_b32 s86, s61, 20
    s_add_u32 s86, s86, s84
    s_mul_i32 s87, s61, 458752
    s_add_u32 s87, s87, s84
    s_add_u32 s84, s87, 0
    buffer_load_dword v36, v6, s[20:23], s84 offen
    s_add_u32 s84, s87, 1024
    buffer_load_dword v37, v6, s[20:23], s84 offen
    s_add_u32 s84, s87, 2048
    buffer_load_dword v38, v6, s[20:23], s84 offen
    s_add_u32 s84, s87, 3072
    buffer_load_dword v39, v6, s[20:23], s84 offen
    s_add_u32 s84, s87, 4096
    buffer_load_dword v40, v6, s[20:23], s84 offen
    s_add_u32 s84, s87, 5120
    buffer_load_dword v41, v6, s[20:23], s84 offen
    s_add_u32 s84, s87, 6144
    buffer_load_dword v42, v6, s[20:23], s84 offen
    s_add_u32 s84, s87, 7168
    buffer_load_dword v43, v6, s[20:23], s84 offen
    s_add_u32 s84, s87, 32768
    buffer_load_dword v44, v6, s[20:23], s84 offen
    s_add_u32 s84, s87, 33792
    buffer_load_dword v45, v6, s[20:23], s84 offen
    s_add_u32 s84, s87, 34816
    buffer_load_dword v46, v6, s[20:23], s84 offen
    s_add_u32 s84, s87, 35840
    buffer_load_dword v47, v6, s[20:23], s84 offen
    s_add_u32 s84, s87, 36864
    buffer_load_dword v48, v6, s[20:23], s84 offen
    s_add_u32 s84, s87, 37888
    buffer_load_dword v49, v6, s[20:23], s84 offen
    s_add_u32 s84, s87, 38912
    buffer_load_dword v50, v6, s[20:23], s84 offen
    s_add_u32 s84, s87, 39936
    buffer_load_dword v51, v6, s[20:23], s84 offen
    s_add_u32 s84, s87, 65536
    buffer_load_dword v52, v6, s[20:23], s84 offen
    s_add_u32 s84, s87, 66560
    buffer_load_dword v53, v6, s[20:23], s84 offen
    s_add_u32 s84, s87, 67584
    buffer_load_dword v54, v6, s[20:23], s84 offen
    s_add_u32 s84, s87, 68608
    buffer_load_dword v55, v6, s[20:23], s84 offen
    s_add_u32 s84, s87, 69632
    buffer_load_dword v56, v6, s[20:23], s84 offen
    s_add_u32 s84, s87, 70656
    buffer_load_dword v57, v6, s[20:23], s84 offen
    s_add_u32 s84, s87, 71680
    buffer_load_dword v58, v6, s[20:23], s84 offen
    s_add_u32 s84, s87, 72704
    buffer_load_dword v59, v6, s[20:23], s84 offen
    s_add_u32 s84, s87, 98304
    buffer_load_dword v60, v6, s[20:23], s84 offen
    s_add_u32 s84, s87, 99328
    buffer_load_dword v61, v6, s[20:23], s84 offen
    s_add_u32 s84, s87, 100352
    buffer_load_dword v62, v6, s[20:23], s84 offen
    s_add_u32 s84, s87, 101376
    buffer_load_dword v63, v6, s[20:23], s84 offen
    s_add_u32 s84, s87, 102400
    buffer_load_dword v64, v6, s[20:23], s84 offen
    s_add_u32 s84, s87, 103424
    buffer_load_dword v65, v6, s[20:23], s84 offen
    s_add_u32 s84, s87, 104448
    buffer_load_dword v66, v6, s[20:23], s84 offen
    s_add_u32 s84, s87, 105472
    buffer_load_dword v67, v6, s[20:23], s84 offen
    s_add_u32 s84, s87, 131072
    buffer_load_dword v68, v6, s[20:23], s84 offen
    s_add_u32 s84, s87, 132096
    buffer_load_dword v69, v6, s[20:23], s84 offen
    s_add_u32 s84, s87, 133120
    buffer_load_dword v70, v6, s[20:23], s84 offen
    s_add_u32 s84, s87, 134144
    buffer_load_dword v71, v6, s[20:23], s84 offen
    s_add_u32 s84, s87, 135168
    buffer_load_dword v72, v6, s[20:23], s84 offen
    s_add_u32 s84, s87, 136192
    buffer_load_dword v73, v6, s[20:23], s84 offen
    s_add_u32 s84, s87, 137216
    buffer_load_dword v74, v6, s[20:23], s84 offen
    s_add_u32 s84, s87, 138240
    buffer_load_dword v75, v6, s[20:23], s84 offen
    s_add_u32 s84, s87, 163840
    buffer_load_dword v76, v6, s[20:23], s84 offen
    s_add_u32 s84, s87, 164864
    buffer_load_dword v77, v6, s[20:23], s84 offen
    s_add_u32 s84, s87, 165888
    buffer_load_dword v78, v6, s[20:23], s84 offen
    s_add_u32 s84, s87, 166912
    buffer_load_dword v79, v6, s[20:23], s84 offen
    s_add_u32 s84, s87, 167936
    buffer_load_dword v80, v6, s[20:23], s84 offen
    s_add_u32 s84, s87, 168960
    buffer_load_dword v81, v6, s[20:23], s84 offen
    s_add_u32 s84, s87, 169984
    buffer_load_dword v82, v6, s[20:23], s84 offen
    s_add_u32 s84, s87, 171008
    buffer_load_dword v83, v6, s[20:23], s84 offen
    s_add_u32 s84, s87, 196608
    buffer_load_dword v84, v6, s[20:23], s84 offen
    s_add_u32 s84, s87, 197632
    buffer_load_dword v85, v6, s[20:23], s84 offen
    s_add_u32 s84, s87, 198656
    buffer_load_dword v86, v6, s[20:23], s84 offen
    s_add_u32 s84, s87, 199680
    buffer_load_dword v87, v6, s[20:23], s84 offen
    s_add_u32 s84, s87, 200704
    buffer_load_dword v88, v6, s[20:23], s84 offen
    s_add_u32 s84, s87, 201728
    buffer_load_dword v89, v6, s[20:23], s84 offen
    s_add_u32 s84, s87, 202752
    buffer_load_dword v90, v6, s[20:23], s84 offen
    s_add_u32 s84, s87, 203776
    buffer_load_dword v91, v6, s[20:23], s84 offen
    s_add_u32 s84, s87, 229376
    buffer_load_dword v92, v6, s[20:23], s84 offen
    s_add_u32 s84, s87, 230400
    buffer_load_dword v93, v6, s[20:23], s84 offen
    s_add_u32 s84, s87, 231424
    buffer_load_dword v94, v6, s[20:23], s84 offen
    s_add_u32 s84, s87, 232448
    buffer_load_dword v95, v6, s[20:23], s84 offen
    s_add_u32 s84, s87, 233472
    buffer_load_dword v96, v6, s[20:23], s84 offen
    s_add_u32 s84, s87, 234496
    buffer_load_dword v97, v6, s[20:23], s84 offen
    s_add_u32 s84, s87, 235520
    buffer_load_dword v98, v6, s[20:23], s84 offen
    s_add_u32 s84, s87, 236544
    buffer_load_dword v99, v6, s[20:23], s84 offen
    s_waitcnt vmcnt(48)
    v_perm_b32 v144, v37, v36, s95
    v_perm_b32 v145, v39, v38, s95
    v_perm_b32 v146, v41, v40, s95
    v_perm_b32 v147, v43, v42, s95
    v_perm_b32 v148, v37, v36, s96
    v_perm_b32 v149, v39, v38, s96
    v_perm_b32 v150, v41, v40, s96
    v_perm_b32 v151, v43, v42, s96
    v_perm_b32 v152, v45, v44, s95
    v_perm_b32 v153, v47, v46, s95
    v_perm_b32 v154, v49, v48, s95
    v_perm_b32 v155, v51, v50, s95
    v_perm_b32 v156, v45, v44, s96
    v_perm_b32 v157, v47, v46, s96
    v_perm_b32 v158, v49, v48, s96
    v_perm_b32 v159, v51, v50, s96
    s_add_u32 s84, s87, 262144
    buffer_load_dword v36, v6, s[20:23], s84 offen
    s_add_u32 s84, s87, 263168
    buffer_load_dword v37, v6, s[20:23], s84 offen
    s_add_u32 s84, s87, 264192
    buffer_load_dword v38, v6, s[20:23], s84 offen
    s_add_u32 s84, s87, 265216
    buffer_load_dword v39, v6, s[20:23], s84 offen
    s_add_u32 s84, s87, 266240
    buffer_load_dword v40, v6, s[20:23], s84 offen
    s_add_u32 s84, s87, 267264
    buffer_load_dword v41, v6, s[20:23], s84 offen
    s_add_u32 s84, s87, 268288
    buffer_load_dword v42, v6, s[20:23], s84 offen
    s_add_u32 s84, s87, 269312
    buffer_load_dword v43, v6, s[20:23], s84 offen
    s_add_u32 s84, s87, 294912
    buffer_load_dword v44, v6, s[20:23], s84 offen
    s_add_u32 s84, s87, 295936
    buffer_load_dword v45, v6, s[20:23], s84 offen
    s_add_u32 s84, s87, 296960
    buffer_load_dword v46, v6, s[20:23], s84 offen
    s_add_u32 s84, s87, 297984
    buffer_load_dword v47, v6, s[20:23], s84 offen
    s_add_u32 s84, s87, 299008
    buffer_load_dword v48, v6, s[20:23], s84 offen
    s_add_u32 s84, s87, 300032
    buffer_load_dword v49, v6, s[20:23], s84 offen
    s_add_u32 s84, s87, 301056
    buffer_load_dword v50, v6, s[20:23], s84 offen
    s_add_u32 s84, s87, 302080
    buffer_load_dword v51, v6, s[20:23], s84 offen
    s_waitcnt vmcnt(48)
    v_perm_b32 v160, v53, v52, s95
    v_perm_b32 v161, v55, v54, s95
    v_perm_b32 v162, v57, v56, s95
    v_perm_b32 v163, v59, v58, s95
    v_perm_b32 v164, v53, v52, s96
    v_perm_b32 v165, v55, v54, s96
    v_perm_b32 v166, v57, v56, s96
    v_perm_b32 v167, v59, v58, s96
    v_perm_b32 v168, v61, v60, s95
    v_perm_b32 v169, v63, v62, s95
    v_perm_b32 v170, v65, v64, s95
    v_perm_b32 v171, v67, v66, s95
    v_perm_b32 v172, v61, v60, s96
    v_perm_b32 v173, v63, v62, s96
    v_perm_b32 v174, v65, v64, s96
    v_perm_b32 v175, v67, v66, s96
    s_add_u32 s84, s87, 327680
    buffer_load_dword v52, v6, s[20:23], s84 offen
    s_add_u32 s84, s87, 328704
    buffer_load_dword v53, v6, s[20:23], s84 offen
    s_add_u32 s84, s87, 329728
    buffer_load_dword v54, v6, s[20:23], s84 offen
    s_add_u32 s84, s87, 330752
    buffer_load_dword v55, v6, s[20:23], s84 offen
    s_add_u32 s84, s87, 331776
    buffer_load_dword v56, v6, s[20:23], s84 offen
    s_add_u32 s84, s87, 332800
    buffer_load_dword v57, v6, s[20:23], s84 offen
    s_add_u32 s84, s87, 333824
    buffer_load_dword v58, v6, s[20:23], s84 offen
    s_add_u32 s84, s87, 334848
    buffer_load_dword v59, v6, s[20:23], s84 offen
    s_add_u32 s84, s87, 360448
    buffer_load_dword v60, v6, s[20:23], s84 offen
    s_add_u32 s84, s87, 361472
    buffer_load_dword v61, v6, s[20:23], s84 offen
    s_add_u32 s84, s87, 362496
    buffer_load_dword v62, v6, s[20:23], s84 offen
    s_add_u32 s84, s87, 363520
    buffer_load_dword v63, v6, s[20:23], s84 offen
    s_add_u32 s84, s87, 364544
    buffer_load_dword v64, v6, s[20:23], s84 offen
    s_add_u32 s84, s87, 365568
    buffer_load_dword v65, v6, s[20:23], s84 offen
    s_add_u32 s84, s87, 366592
    buffer_load_dword v66, v6, s[20:23], s84 offen
    s_add_u32 s84, s87, 367616
    buffer_load_dword v67, v6, s[20:23], s84 offen
    s_waitcnt vmcnt(48)
    v_perm_b32 v176, v69, v68, s95
    v_perm_b32 v177, v71, v70, s95
    v_perm_b32 v178, v73, v72, s95
    v_perm_b32 v179, v75, v74, s95
    v_perm_b32 v180, v69, v68, s96
    v_perm_b32 v181, v71, v70, s96
    v_perm_b32 v182, v73, v72, s96
    v_perm_b32 v183, v75, v74, s96
    v_perm_b32 v184, v77, v76, s95
    v_perm_b32 v185, v79, v78, s95
    v_perm_b32 v186, v81, v80, s95
    v_perm_b32 v187, v83, v82, s95
    v_perm_b32 v188, v77, v76, s96
    v_perm_b32 v189, v79, v78, s96
    v_perm_b32 v190, v81, v80, s96
    v_perm_b32 v191, v83, v82, s96
    s_add_u32 s84, s87, 393216
    buffer_load_dword v68, v6, s[20:23], s84 offen
    s_add_u32 s84, s87, 394240
    buffer_load_dword v69, v6, s[20:23], s84 offen
    s_add_u32 s84, s87, 395264
    buffer_load_dword v70, v6, s[20:23], s84 offen
    s_add_u32 s84, s87, 396288
    buffer_load_dword v71, v6, s[20:23], s84 offen
    s_add_u32 s84, s87, 397312
    buffer_load_dword v72, v6, s[20:23], s84 offen
    s_add_u32 s84, s87, 398336
    buffer_load_dword v73, v6, s[20:23], s84 offen
    s_add_u32 s84, s87, 399360
    buffer_load_dword v74, v6, s[20:23], s84 offen
    s_add_u32 s84, s87, 400384
    buffer_load_dword v75, v6, s[20:23], s84 offen
    s_add_u32 s84, s87, 425984
    buffer_load_dword v76, v6, s[20:23], s84 offen
    s_add_u32 s84, s87, 427008
    buffer_load_dword v77, v6, s[20:23], s84 offen
    s_add_u32 s84, s87, 428032
    buffer_load_dword v78, v6, s[20:23], s84 offen
    s_add_u32 s84, s87, 429056
    buffer_load_dword v79, v6, s[20:23], s84 offen
    s_add_u32 s84, s87, 430080
    buffer_load_dword v80, v6, s[20:23], s84 offen
    s_add_u32 s84, s87, 431104
    buffer_load_dword v81, v6, s[20:23], s84 offen
    s_add_u32 s84, s87, 432128
    buffer_load_dword v82, v6, s[20:23], s84 offen
    s_add_u32 s84, s87, 433152
    buffer_load_dword v83, v6, s[20:23], s84 offen
    s_waitcnt vmcnt(48)
    v_perm_b32 v192, v85, v84, s95
    v_perm_b32 v193, v87, v86, s95
    v_perm_b32 v194, v89, v88, s95
    v_perm_b32 v195, v91, v90, s95
    v_perm_b32 v196, v85, v84, s96
    v_perm_b32 v197, v87, v86, s96
    v_perm_b32 v198, v89, v88, s96
    v_perm_b32 v199, v91, v90, s96
    v_perm_b32 v200, v93, v92, s95
    v_perm_b32 v201, v95, v94, s95
    v_perm_b32 v202, v97, v96, s95
    v_perm_b32 v203, v99, v98, s95
    v_perm_b32 v204, v93, v92, s96
    v_perm_b32 v205, v95, v94, s96
    v_perm_b32 v206, v97, v96, s96
    v_perm_b32 v207, v99, v98, s96
    s_add_u32 s84, s86, 0
    buffer_load_dword v84, v5, s[16:19], s84 offen
    s_add_u32 s84, s86, 1024
    buffer_load_dword v85, v5, s[16:19], s84 offen
    s_add_u32 s84, s86, 2048
    buffer_load_dword v86, v5, s[16:19], s84 offen
    s_add_u32 s84, s86, 3072
    buffer_load_dword v87, v5, s[16:19], s84 offen
    s_add_u32 s84, s86, 4096
    buffer_load_dword v88, v5, s[16:19], s84 offen
    s_add_u32 s84, s86, 5120
    buffer_load_dword v89, v5, s[16:19], s84 offen
    s_add_u32 s84, s86, 6144
    buffer_load_dword v90, v5, s[16:19], s84 offen
    s_add_u32 s84, s86, 7168
    buffer_load_dword v91, v5, s[16:19], s84 offen
    s_add_u32 s84, s86, 8192
    buffer_load_dword v92, v5, s[16:19], s84 offen
    s_add_u32 s84, s86, 9216
    buffer_load_dword v93, v5, s[16:19], s84 offen
    s_add_u32 s84, s86, 10240
    buffer_load_dword v94, v5, s[16:19], s84 offen
    s_add_u32 s84, s86, 11264
    buffer_load_dword v95, v5, s[16:19], s84 offen
    s_add_u32 s84, s86, 12288
    buffer_load_dword v96, v5, s[16:19], s84 offen
    s_add_u32 s84, s86, 13312
    buffer_load_dword v97, v5, s[16:19], s84 offen
    s_add_u32 s84, s86, 14336
    buffer_load_dword v98, v5, s[16:19], s84 offen
    s_add_u32 s84, s86, 15360
    buffer_load_dword v99, v5, s[16:19], s84 offen
    s_waitcnt vmcnt(48)
    v_perm_b32 v208, v37, v36, s95
    v_perm_b32 v209, v39, v38, s95
    v_perm_b32 v210, v41, v40, s95
    v_perm_b32 v211, v43, v42, s95
    v_perm_b32 v212, v37, v36, s96
    v_perm_b32 v213, v39, v38, s96
    v_perm_b32 v214, v41, v40, s96
    v_perm_b32 v215, v43, v42, s96
    v_perm_b32 v216, v45, v44, s95
    v_perm_b32 v217, v47, v46, s95
    v_perm_b32 v218, v49, v48, s95
    v_perm_b32 v219, v51, v50, s95
    v_perm_b32 v220, v45, v44, s96
    v_perm_b32 v221, v47, v46, s96
    v_perm_b32 v222, v49, v48, s96
    v_perm_b32 v223, v51, v50, s96
    s_add_u32 s84, s86, 65536
    buffer_load_dword v36, v5, s[16:19], s84 offen
    s_add_u32 s84, s86, 66560
    buffer_load_dword v37, v5, s[16:19], s84 offen
    s_add_u32 s84, s86, 67584
    buffer_load_dword v38, v5, s[16:19], s84 offen
    s_add_u32 s84, s86, 68608
    buffer_load_dword v39, v5, s[16:19], s84 offen
    s_add_u32 s84, s86, 69632
    buffer_load_dword v40, v5, s[16:19], s84 offen
    s_add_u32 s84, s86, 70656
    buffer_load_dword v41, v5, s[16:19], s84 offen
    s_add_u32 s84, s86, 71680
    buffer_load_dword v42, v5, s[16:19], s84 offen
    s_add_u32 s84, s86, 72704
    buffer_load_dword v43, v5, s[16:19], s84 offen
    s_add_u32 s84, s86, 73728
    buffer_load_dword v44, v5, s[16:19], s84 offen
    s_add_u32 s84, s86, 74752
    buffer_load_dword v45, v5, s[16:19], s84 offen
    s_add_u32 s84, s86, 75776
    buffer_load_dword v46, v5, s[16:19], s84 offen
    s_add_u32 s84, s86, 76800
    buffer_load_dword v47, v5, s[16:19], s84 offen
    s_add_u32 s84, s86, 77824
    buffer_load_dword v48, v5, s[16:19], s84 offen
    s_add_u32 s84, s86, 78848
    buffer_load_dword v49, v5, s[16:19], s84 offen
    s_add_u32 s84, s86, 79872
    buffer_load_dword v50, v5, s[16:19], s84 offen
    s_add_u32 s84, s86, 80896
    buffer_load_dword v51, v5, s[16:19], s84 offen
    s_waitcnt vmcnt(48)
    v_perm_b32 v224, v53, v52, s95
    v_perm_b32 v225, v55, v54, s95
    v_perm_b32 v226, v57, v56, s95
    v_perm_b32 v227, v59, v58, s95
    v_perm_b32 v228, v53, v52, s96
    v_perm_b32 v229, v55, v54, s96
    v_perm_b32 v230, v57, v56, s96
    v_perm_b32 v231, v59, v58, s96
    v_perm_b32 v232, v61, v60, s95
    v_perm_b32 v233, v63, v62, s95
    v_perm_b32 v234, v65, v64, s95
    v_perm_b32 v235, v67, v66, s95
    v_perm_b32 v236, v61, v60, s96
    v_perm_b32 v237, v63, v62, s96
    v_perm_b32 v238, v65, v64, s96
    v_perm_b32 v239, v67, v66, s96
    s_add_u32 s84, s86, 131072
    buffer_load_dword v52, v5, s[16:19], s84 offen
    s_add_u32 s84, s86, 132096
    buffer_load_dword v53, v5, s[16:19], s84 offen
    s_add_u32 s84, s86, 133120
    buffer_load_dword v54, v5, s[16:19], s84 offen
    s_add_u32 s84, s86, 134144
    buffer_load_dword v55, v5, s[16:19], s84 offen
    s_add_u32 s84, s86, 135168
    buffer_load_dword v56, v5, s[16:19], s84 offen
    s_add_u32 s84, s86, 136192
    buffer_load_dword v57, v5, s[16:19], s84 offen
    s_add_u32 s84, s86, 137216
    buffer_load_dword v58, v5, s[16:19], s84 offen
    s_add_u32 s84, s86, 138240
    buffer_load_dword v59, v5, s[16:19], s84 offen
    s_add_u32 s84, s86, 139264
    buffer_load_dword v60, v5, s[16:19], s84 offen
    s_add_u32 s84, s86, 140288
    buffer_load_dword v61, v5, s[16:19], s84 offen
    s_add_u32 s84, s86, 141312
    buffer_load_dword v62, v5, s[16:19], s84 offen
    s_add_u32 s84, s86, 142336
    buffer_load_dword v63, v5, s[16:19], s84 offen
    s_add_u32 s84, s86, 143360
    buffer_load_dword v64, v5, s[16:19], s84 offen
    s_add_u32 s84, s86, 144384
    buffer_load_dword v65, v5, s[16:19], s84 offen
    s_add_u32 s84, s86, 145408
    buffer_load_dword v66, v5, s[16:19], s84 offen
    s_add_u32 s84, s86, 146432
    buffer_load_dword v67, v5, s[16:19], s84 offen
    s_waitcnt vmcnt(48)
    v_perm_b32 v240, v69, v68, s95
    v_perm_b32 v241, v71, v70, s95
    v_perm_b32 v242, v73, v72, s95
    v_perm_b32 v243, v75, v74, s95
    v_perm_b32 v244, v69, v68, s96
    v_perm_b32 v245, v71, v70, s96
    v_perm_b32 v246, v73, v72, s96
    v_perm_b32 v247, v75, v74, s96
    v_perm_b32 v248, v77, v76, s95
    v_perm_b32 v249, v79, v78, s95
    v_perm_b32 v250, v81, v80, s95
    v_perm_b32 v251, v83, v82, s95
    v_perm_b32 v252, v77, v76, s96
    v_perm_b32 v253, v79, v78, s96
    v_perm_b32 v254, v81, v80, s96
    v_perm_b32 v255, v83, v82, s96
    s_add_u32 s84, s86, 196608
    buffer_load_dword v68, v5, s[16:19], s84 offen
    s_add_u32 s84, s86, 197632
    buffer_load_dword v69, v5, s[16:19], s84 offen
    s_add_u32 s84, s86, 198656
    buffer_load_dword v70, v5, s[16:19], s84 offen
    s_add_u32 s84, s86, 199680
    buffer_load_dword v71, v5, s[16:19], s84 offen
    s_add_u32 s84, s86, 200704
    buffer_load_dword v72, v5, s[16:19], s84 offen
    s_add_u32 s84, s86, 201728
    buffer_load_dword v73, v5, s[16:19], s84 offen
    s_add_u32 s84, s86, 202752
    buffer_load_dword v74, v5, s[16:19], s84 offen
    s_add_u32 s84, s86, 203776
    buffer_load_dword v75, v5, s[16:19], s84 offen
    s_add_u32 s84, s86, 204800
    buffer_load_dword v76, v5, s[16:19], s84 offen
    s_add_u32 s84, s86, 205824
    buffer_load_dword v77, v5, s[16:19], s84 offen
    s_add_u32 s84, s86, 206848
    buffer_load_dword v78, v5, s[16:19], s84 offen
    s_add_u32 s84, s86, 207872
    buffer_load_dword v79, v5, s[16:19], s84 offen
    s_add_u32 s84, s86, 208896
    buffer_load_dword v80, v5, s[16:19], s84 offen
    s_add_u32 s84, s86, 209920
    buffer_load_dword v81, v5, s[16:19], s84 offen
    s_add_u32 s84, s86, 210944
    buffer_load_dword v82, v5, s[16:19], s84 offen
    s_add_u32 s84, s86, 211968
    buffer_load_dword v83, v5, s[16:19], s84 offen
    s_waitcnt vmcnt(48)
    v_perm_b32 v12, v85, v84, s95
    v_perm_b32 v13, v87, v86, s95
    v_perm_b32 v14, v89, v88, s95
    v_perm_b32 v15, v91, v90, s95
    v_perm_b32 v16, v85, v84, s96
    v_perm_b32 v17, v87, v86, s96
    v_perm_b32 v18, v89, v88, s96
    v_perm_b32 v19, v91, v90, s96
    v_accvgpr_write_b32 a0, v12
    v_accvgpr_write_b32 a1, v13
    v_accvgpr_write_b32 a2, v14
    v_accvgpr_write_b32 a3, v15
    v_accvgpr_write_b32 a4, v16
    v_accvgpr_write_b32 a5, v17
    v_accvgpr_write_b32 a6, v18
    v_accvgpr_write_b32 a7, v19
    v_perm_b32 v12, v93, v92, s95
    v_perm_b32 v13, v95, v94, s95
    v_perm_b32 v14, v97, v96, s95
    v_perm_b32 v15, v99, v98, s95
    v_perm_b32 v16, v93, v92, s96
    v_perm_b32 v17, v95, v94, s96
    v_perm_b32 v18, v97, v96, s96
    v_perm_b32 v19, v99, v98, s96
    v_accvgpr_write_b32 a8, v12
    v_accvgpr_write_b32 a9, v13
    v_accvgpr_write_b32 a10, v14
    v_accvgpr_write_b32 a11, v15
    v_accvgpr_write_b32 a12, v16
    v_accvgpr_write_b32 a13, v17
    v_accvgpr_write_b32 a14, v18
    v_accvgpr_write_b32 a15, v19
    s_add_u32 s84, s86, 262144
    buffer_load_dword v84, v5, s[16:19], s84 offen
    s_add_u32 s84, s86, 263168
    buffer_load_dword v85, v5, s[16:19], s84 offen
    s_add_u32 s84, s86, 264192
    buffer_load_dword v86, v5, s[16:19], s84 offen
    s_add_u32 s84, s86, 265216
    buffer_load_dword v87, v5, s[16:19], s84 offen
    s_add_u32 s84, s86, 266240
    buffer_load_dword v88, v5, s[16:19], s84 offen
    s_add_u32 s84, s86, 267264
    buffer_load_dword v89, v5, s[16:19], s84 offen
    s_add_u32 s84, s86, 268288
    buffer_load_dword v90, v5, s[16:19], s84 offen
    s_add_u32 s84, s86, 269312
    buffer_load_dword v91, v5, s[16:19], s84 offen
    s_add_u32 s84, s86, 270336
    buffer_load_dword v92, v5, s[16:19], s84 offen
    s_add_u32 s84, s86, 271360
    buffer_load_dword v93, v5, s[16:19], s84 offen
    s_add_u32 s84, s86, 272384
    buffer_load_dword v94, v5, s[16:19], s84 offen
    s_add_u32 s84, s86, 273408
    buffer_load_dword v95, v5, s[16:19], s84 offen
    s_add_u32 s84, s86, 274432
    buffer_load_dword v96, v5, s[16:19], s84 offen
    s_add_u32 s84, s86, 275456
    buffer_load_dword v97, v5, s[16:19], s84 offen
    s_add_u32 s84, s86, 276480
    buffer_load_dword v98, v5, s[16:19], s84 offen
    s_add_u32 s84, s86, 277504
    buffer_load_dword v99, v5, s[16:19], s84 offen
    s_waitcnt vmcnt(48)
    v_perm_b32 v12, v37, v36, s95
    v_perm_b32 v13, v39, v38, s95
    v_perm_b32 v14, v41, v40, s95
    v_perm_b32 v15, v43, v42, s95
    v_perm_b32 v16, v37, v36, s96
    v_perm_b32 v17, v39, v38, s96
    v_perm_b32 v18, v41, v40, s96
    v_perm_b32 v19, v43, v42, s96
    v_accvgpr_write_b32 a16, v12
    v_accvgpr_write_b32 a17, v13
    v_accvgpr_write_b32 a18, v14
    v_accvgpr_write_b32 a19, v15
    v_accvgpr_write_b32 a20, v16
    v_accvgpr_write_b32 a21, v17
    v_accvgpr_write_b32 a22, v18
    v_accvgpr_write_b32 a23, v19
    v_perm_b32 v12, v45, v44, s95
    v_perm_b32 v13, v47, v46, s95
    v_perm_b32 v14, v49, v48, s95
    v_perm_b32 v15, v51, v50, s95
    v_perm_b32 v16, v45, v44, s96
    v_perm_b32 v17, v47, v46, s96
    v_perm_b32 v18, v49, v48, s96
    v_perm_b32 v19, v51, v50, s96
    v_accvgpr_write_b32 a24, v12
    v_accvgpr_write_b32 a25, v13
    v_accvgpr_write_b32 a26, v14
    v_accvgpr_write_b32 a27, v15
    v_accvgpr_write_b32 a28, v16
    v_accvgpr_write_b32 a29, v17
    v_accvgpr_write_b32 a30, v18
    v_accvgpr_write_b32 a31, v19
    s_add_u32 s84, s86, 327680
    buffer_load_dword v36, v5, s[16:19], s84 offen
    s_add_u32 s84, s86, 328704
    buffer_load_dword v37, v5, s[16:19], s84 offen
    s_add_u32 s84, s86, 329728
    buffer_load_dword v38, v5, s[16:19], s84 offen
    s_add_u32 s84, s86, 330752
    buffer_load_dword v39, v5, s[16:19], s84 offen
    s_add_u32 s84, s86, 331776
    buffer_load_dword v40, v5, s[16:19], s84 offen
    s_add_u32 s84, s86, 332800
    buffer_load_dword v41, v5, s[16:19], s84 offen
    s_add_u32 s84, s86, 333824
    buffer_load_dword v42, v5, s[16:19], s84 offen
    s_add_u32 s84, s86, 334848
    buffer_load_dword v43, v5, s[16:19], s84 offen
    s_add_u32 s84, s86, 335872
    buffer_load_dword v44, v5, s[16:19], s84 offen
    s_add_u32 s84, s86, 336896
    buffer_load_dword v45, v5, s[16:19], s84 offen
    s_add_u32 s84, s86, 337920
    buffer_load_dword v46, v5, s[16:19], s84 offen
    s_add_u32 s84, s86, 338944
    buffer_load_dword v47, v5, s[16:19], s84 offen
    s_add_u32 s84, s86, 339968
    buffer_load_dword v48, v5, s[16:19], s84 offen
    s_add_u32 s84, s86, 340992
    buffer_load_dword v49, v5, s[16:19], s84 offen
    s_add_u32 s84, s86, 342016
    buffer_load_dword v50, v5, s[16:19], s84 offen
    s_add_u32 s84, s86, 343040
    buffer_load_dword v51, v5, s[16:19], s84 offen
    s_waitcnt vmcnt(48)
    v_perm_b32 v12, v53, v52, s95
    v_perm_b32 v13, v55, v54, s95
    v_perm_b32 v14, v57, v56, s95
    v_perm_b32 v15, v59, v58, s95
    v_perm_b32 v16, v53, v52, s96
    v_perm_b32 v17, v55, v54, s96
    v_perm_b32 v18, v57, v56, s96
    v_perm_b32 v19, v59, v58, s96
    v_accvgpr_write_b32 a32, v12
    v_accvgpr_write_b32 a33, v13
    v_accvgpr_write_b32 a34, v14
    v_accvgpr_write_b32 a35, v15
    v_accvgpr_write_b32 a36, v16
    v_accvgpr_write_b32 a37, v17
    v_accvgpr_write_b32 a38, v18
    v_accvgpr_write_b32 a39, v19
    v_perm_b32 v12, v61, v60, s95
    v_perm_b32 v13, v63, v62, s95
    v_perm_b32 v14, v65, v64, s95
    v_perm_b32 v15, v67, v66, s95
    v_perm_b32 v16, v61, v60, s96
    v_perm_b32 v17, v63, v62, s96
    v_perm_b32 v18, v65, v64, s96
    v_perm_b32 v19, v67, v66, s96
    v_accvgpr_write_b32 a40, v12
    v_accvgpr_write_b32 a41, v13
    v_accvgpr_write_b32 a42, v14
    v_accvgpr_write_b32 a43, v15
    v_accvgpr_write_b32 a44, v16
    v_accvgpr_write_b32 a45, v17
    v_accvgpr_write_b32 a46, v18
    v_accvgpr_write_b32 a47, v19
    s_add_u32 s84, s86, 393216
    buffer_load_dword v52, v5, s[16:19], s84 offen
    s_add_u32 s84, s86, 394240
    buffer_load_dword v53, v5, s[16:19], s84 offen
    s_add_u32 s84, s86, 395264
    buffer_load_dword v54, v5, s[16:19], s84 offen
    s_add_u32 s84, s86, 396288
    buffer_load_dword v55, v5, s[16:19], s84 offen
    s_add_u32 s84, s86, 397312
    buffer_load_dword v56, v5, s[16:19], s84 offen
    s_add_u32 s84, s86, 398336
    buffer_load_dword v57, v5, s[16:19], s84 offen
    s_add_u32 s84, s86, 399360
    buffer_load_dword v58, v5, s[16:19], s84 offen
    s_add_u32 s84, s86, 400384
    buffer_load_dword v59, v5, s[16:19], s84 offen
    s_add_u32 s84, s86, 401408
    buffer_load_dword v60, v5, s[16:19], s84 offen
    s_add_u32 s84, s86, 402432
    buffer_load_dword v61, v5, s[16:19], s84 offen
    s_add_u32 s84, s86, 403456
    buffer_load_dword v62, v5, s[16:19], s84 offen
    s_add_u32 s84, s86, 404480
    buffer_load_dword v63, v5, s[16:19], s84 offen
    s_add_u32 s84, s86, 405504
    buffer_load_dword v64, v5, s[16:19], s84 offen
    s_add_u32 s84, s86, 406528
    buffer_load_dword v65, v5, s[16:19], s84 offen
    s_add_u32 s84, s86, 407552
    buffer_load_dword v66, v5, s[16:19], s84 offen
    s_add_u32 s84, s86, 408576
    buffer_load_dword v67, v5, s[16:19], s84 offen
    s_waitcnt vmcnt(48)
    v_perm_b32 v12, v69, v68, s95
    v_perm_b32 v13, v71, v70, s95
    v_perm_b32 v14, v73, v72, s95
    v_perm_b32 v15, v75, v74, s95
    v_perm_b32 v16, v69, v68, s96
    v_perm_b32 v17, v71, v70, s96
    v_perm_b32 v18, v73, v72, s96
    v_perm_b32 v19, v75, v74, s96
    v_accvgpr_write_b32 a48, v12
    v_accvgpr_write_b32 a49, v13
    v_accvgpr_write_b32 a50, v14
    v_accvgpr_write_b32 a51, v15
    v_accvgpr_write_b32 a52, v16
    v_accvgpr_write_b32 a53, v17
    v_accvgpr_write_b32 a54, v18
    v_accvgpr_write_b32 a55, v19
    v_perm_b32 v12, v77, v76, s95
    v_perm_b32 v13, v79, v78, s95
    v_perm_b32 v14, v81, v80, s95
    v_perm_b32 v15, v83, v82, s95
    v_perm_b32 v16, v77, v76, s96
    v_perm_b32 v17, v79, v78, s96
    v_perm_b32 v18, v81, v80, s96
    v_perm_b32 v19, v83, v82, s96
    v_accvgpr_write_b32 a56, v12
    v_accvgpr_write_b32 a57, v13
    v_accvgpr_write_b32 a58, v14
    v_accvgpr_write_b32 a59, v15
    v_accvgpr_write_b32 a60, v16
    v_accvgpr_write_b32 a61, v17
    v_accvgpr_write_b32 a62, v18
    v_accvgpr_write_b32 a63, v19
    s_add_u32 s84, s86, 458752
    buffer_load_dword v68, v5, s[16:19], s84 offen
    s_add_u32 s84, s86, 459776
    buffer_load_dword v69, v5, s[16:19], s84 offen
    s_add_u32 s84, s86, 460800
    buffer_load_dword v70, v5, s[16:19], s84 offen
    s_add_u32 s84, s86, 461824
    buffer_load_dword v71, v5, s[16:19], s84 offen
    s_add_u32 s84, s86, 462848
    buffer_load_dword v72, v5, s[16:19], s84 offen
    s_add_u32 s84, s86, 463872
    buffer_load_dword v73, v5, s[16:19], s84 offen
    s_add_u32 s84, s86, 464896
    buffer_load_dword v74, v5, s[16:19], s84 offen
    s_add_u32 s84, s86, 465920
    buffer_load_dword v75, v5, s[16:19], s84 offen
    s_add_u32 s84, s86, 466944
    buffer_load_dword v76, v5, s[16:19], s84 offen
    s_add_u32 s84, s86, 467968
    buffer_load_dword v77, v5, s[16:19], s84 offen
    s_add_u32 s84, s86, 468992
    buffer_load_dword v78, v5, s[16:19], s84 offen
    s_add_u32 s84, s86, 470016
    buffer_load_dword v79, v5, s[16:19], s84 offen
    s_add_u32 s84, s86, 471040
    buffer_load_dword v80, v5, s[16:19], s84 offen
    s_add_u32 s84, s86, 472064
    buffer_load_dword v81, v5, s[16:19], s84 offen
    s_add_u32 s84, s86, 473088
    buffer_load_dword v82, v5, s[16:19], s84 offen
    s_add_u32 s84, s86, 474112
    buffer_load_dword v83, v5, s[16:19], s84 offen
    s_waitcnt vmcnt(48)
    v_perm_b32 v12, v85, v84, s95
    v_perm_b32 v13, v87, v86, s95
    v_perm_b32 v14, v89, v88, s95
    v_perm_b32 v15, v91, v90, s95
    v_perm_b32 v16, v85, v84, s96
    v_perm_b32 v17, v87, v86, s96
    v_perm_b32 v18, v89, v88, s96
    v_perm_b32 v19, v91, v90, s96
    v_accvgpr_write_b32 a64, v12
    v_accvgpr_write_b32 a65, v13
    v_accvgpr_write_b32 a66, v14
    v_accvgpr_write_b32 a67, v15
    v_accvgpr_write_b32 a68, v16
    v_accvgpr_write_b32 a69, v17
    v_accvgpr_write_b32 a70, v18
    v_accvgpr_write_b32 a71, v19
    v_perm_b32 v12, v93, v92, s95
    v_perm_b32 v13, v95, v94, s95
    v_perm_b32 v14, v97, v96, s95
    v_perm_b32 v15, v99, v98, s95
    v_perm_b32 v16, v93, v92, s96
    v_perm_b32 v17, v95, v94, s96
    v_perm_b32 v18, v97, v96, s96
    v_perm_b32 v19, v99, v98, s96
    v_accvgpr_write_b32 a72, v12
    v_accvgpr_write_b32 a73, v13
    v_accvgpr_write_b32 a74, v14
    v_accvgpr_write_b32 a75, v15
    v_accvgpr_write_b32 a76, v16
    v_accvgpr_write_b32 a77, v17
    v_accvgpr_write_b32 a78, v18
    v_accvgpr_write_b32 a79, v19
    s_add_u32 s84, s86, 524288
    buffer_load_dword v84, v5, s[16:19], s84 offen
    s_add_u32 s84, s86, 525312
    buffer_load_dword v85, v5, s[16:19], s84 offen
    s_add_u32 s84, s86, 526336
    buffer_load_dword v86, v5, s[16:19], s84 offen
    s_add_u32 s84, s86, 527360
    buffer_load_dword v87, v5, s[16:19], s84 offen
    s_add_u32 s84, s86, 528384
    buffer_load_dword v88, v5, s[16:19], s84 offen
    s_add_u32 s84, s86, 529408
    buffer_load_dword v89, v5, s[16:19], s84 offen
    s_add_u32 s84, s86, 530432
    buffer_load_dword v90, v5, s[16:19], s84 offen
    s_add_u32 s84, s86, 531456
    buffer_load_dword v91, v5, s[16:19], s84 offen
    s_add_u32 s84, s86, 532480
    buffer_load_dword v92, v5, s[16:19], s84 offen
    s_add_u32 s84, s86, 533504
    buffer_load_dword v93, v5, s[16:19], s84 offen
    s_add_u32 s84, s86, 534528
    buffer_load_dword v94, v5, s[16:19], s84 offen
    s_add_u32 s84, s86, 535552
    buffer_load_dword v95, v5, s[16:19], s84 offen
    s_add_u32 s84, s86, 536576
    buffer_load_dword v96, v5, s[16:19], s84 offen
    s_add_u32 s84, s86, 537600
    buffer_load_dword v97, v5, s[16:19], s84 offen
    s_add_u32 s84, s86, 538624
    buffer_load_dword v98, v5, s[16:19], s84 offen
    s_add_u32 s84, s86, 539648
    buffer_load_dword v99, v5, s[16:19], s84 offen
    s_waitcnt vmcnt(48)
    v_perm_b32 v12, v37, v36, s95
    v_perm_b32 v13, v39, v38, s95
    v_perm_b32 v14, v41, v40, s95
    v_perm_b32 v15, v43, v42, s95
    v_perm_b32 v16, v37, v36, s96
    v_perm_b32 v17, v39, v38, s96
    v_perm_b32 v18, v41, v40, s96
    v_perm_b32 v19, v43, v42, s96
    v_accvgpr_write_b32 a80, v12
    v_accvgpr_write_b32 a81, v13
    v_accvgpr_write_b32 a82, v14
    v_accvgpr_write_b32 a83, v15
    v_accvgpr_write_b32 a84, v16
    v_accvgpr_write_b32 a85, v17
    v_accvgpr_write_b32 a86, v18
    v_accvgpr_write_b32 a87, v19
    v_perm_b32 v12, v45, v44, s95
    v_perm_b32 v13, v47, v46, s95
    v_perm_b32 v14, v49, v48, s95
    v_perm_b32 v15, v51, v50, s95
    v_perm_b32 v16, v45, v44, s96
    v_perm_b32 v17, v47, v46, s96
    v_perm_b32 v18, v49, v48, s96
    v_perm_b32 v19, v51, v50, s96
    v_accvgpr_write_b32 a88, v12
    v_accvgpr_write_b32 a89, v13
    v_accvgpr_write_b32 a90, v14
    v_accvgpr_write_b32 a91, v15
    v_accvgpr_write_b32 a92, v16
    v_accvgpr_write_b32 a93, v17
    v_accvgpr_write_b32 a94, v18
    v_accvgpr_write_b32 a95, v19
    s_add_u32 s84, s86, 589824
    buffer_load_dword v36, v5, s[16:19], s84 offen
    s_add_u32 s84, s86, 590848
    buffer_load_dword v37, v5, s[16:19], s84 offen
    s_add_u32 s84, s86, 591872
    buffer_load_dword v38, v5, s[16:19], s84 offen
    s_add_u32 s84, s86, 592896
    buffer_load_dword v39, v5, s[16:19], s84 offen
    s_add_u32 s84, s86, 593920
    buffer_load_dword v40, v5, s[16:19], s84 offen
    s_add_u32 s84, s86, 594944
    buffer_load_dword v41, v5, s[16:19], s84 offen
    s_add_u32 s84, s86, 595968
    buffer_load_dword v42, v5, s[16:19], s84 offen
    s_add_u32 s84, s86, 596992
    buffer_load_dword v43, v5, s[16:19], s84 offen
    s_add_u32 s84, s86, 598016
    buffer_load_dword v44, v5, s[16:19], s84 offen
    s_add_u32 s84, s86, 599040
    buffer_load_dword v45, v5, s[16:19], s84 offen
    s_add_u32 s84, s86, 600064
    buffer_load_dword v46, v5, s[16:19], s84 offen
    s_add_u32 s84, s86, 601088
    buffer_load_dword v47, v5, s[16:19], s84 offen
    s_add_u32 s84, s86, 602112
    buffer_load_dword v48, v5, s[16:19], s84 offen
    s_add_u32 s84, s86, 603136
    buffer_load_dword v49, v5, s[16:19], s84 offen
    s_add_u32 s84, s86, 604160
    buffer_load_dword v50, v5, s[16:19], s84 offen
    s_add_u32 s84, s86, 605184
    buffer_load_dword v51, v5, s[16:19], s84 offen
    s_waitcnt vmcnt(48)
    v_perm_b32 v12, v53, v52, s95
    v_perm_b32 v13, v55, v54, s95
    v_perm_b32 v14, v57, v56, s95
    v_perm_b32 v15, v59, v58, s95
    v_perm_b32 v16, v53, v52, s96
    v_perm_b32 v17, v55, v54, s96
    v_perm_b32 v18, v57, v56, s96
    v_perm_b32 v19, v59, v58, s96
    v_accvgpr_write_b32 a96, v12
    v_accvgpr_write_b32 a97, v13
    v_accvgpr_write_b32 a98, v14
    v_accvgpr_write_b32 a99, v15
    v_accvgpr_write_b32 a100, v16
    v_accvgpr_write_b32 a101, v17
    v_accvgpr_write_b32 a102, v18
    v_accvgpr_write_b32 a103, v19
    v_perm_b32 v12, v61, v60, s95
    v_perm_b32 v13, v63, v62, s95
    v_perm_b32 v14, v65, v64, s95
    v_perm_b32 v15, v67, v66, s95
    v_perm_b32 v16, v61, v60, s96
    v_perm_b32 v17, v63, v62, s96
    v_perm_b32 v18, v65, v64, s96
    v_perm_b32 v19, v67, v66, s96
    v_accvgpr_write_b32 a104, v12
    v_accvgpr_write_b32 a105, v13
    v_accvgpr_write_b32 a106, v14
    v_accvgpr_write_b32 a107, v15
    v_accvgpr_write_b32 a108, v16
    v_accvgpr_write_b32 a109, v17
    v_accvgpr_write_b32 a110, v18
    v_accvgpr_write_b32 a111, v19
    s_add_u32 s84, s86, 655360
    buffer_load_dword v52, v5, s[16:19], s84 offen
    s_add_u32 s84, s86, 656384
    buffer_load_dword v53, v5, s[16:19], s84 offen
    s_add_u32 s84, s86, 657408
    buffer_load_dword v54, v5, s[16:19], s84 offen
    s_add_u32 s84, s86, 658432
    buffer_load_dword v55, v5, s[16:19], s84 offen
    s_add_u32 s84, s86, 659456
    buffer_load_dword v56, v5, s[16:19], s84 offen
    s_add_u32 s84, s86, 660480
    buffer_load_dword v57, v5, s[16:19], s84 offen
    s_add_u32 s84, s86, 661504
    buffer_load_dword v58, v5, s[16:19], s84 offen
    s_add_u32 s84, s86, 662528
    buffer_load_dword v59, v5, s[16:19], s84 offen
    s_add_u32 s84, s86, 663552
    buffer_load_dword v60, v5, s[16:19], s84 offen
    s_add_u32 s84, s86, 664576
    buffer_load_dword v61, v5, s[16:19], s84 offen
    s_add_u32 s84, s86, 665600
    buffer_load_dword v62, v5, s[16:19], s84 offen
    s_add_u32 s84, s86, 666624
    buffer_load_dword v63, v5, s[16:19], s84 offen
    s_add_u32 s84, s86, 667648
    buffer_load_dword v64, v5, s[16:19], s84 offen
    s_add_u32 s84, s86, 668672
    buffer_load_dword v65, v5, s[16:19], s84 offen
    s_add_u32 s84, s86, 669696
    buffer_load_dword v66, v5, s[16:19], s84 offen
    s_add_u32 s84, s86, 670720
    buffer_load_dword v67, v5, s[16:19], s84 offen
    s_waitcnt vmcnt(48)
    v_perm_b32 v12, v69, v68, s95
    v_perm_b32 v13, v71, v70, s95
    v_perm_b32 v14, v73, v72, s95
    v_perm_b32 v15, v75, v74, s95
    v_perm_b32 v16, v69, v68, s96
    v_perm_b32 v17, v71, v70, s96
    v_perm_b32 v18, v73, v72, s96
    v_perm_b32 v19, v75, v74, s96
    v_accvgpr_write_b32 a112, v12
    v_accvgpr_write_b32 a113, v13
    v_accvgpr_write_b32 a114, v14
    v_accvgpr_write_b32 a115, v15
    v_accvgpr_write_b32 a116, v16
    v_accvgpr_write_b32 a117, v17
    v_accvgpr_write_b32 a118, v18
    v_accvgpr_write_b32 a119, v19
    v_perm_b32 v12, v77, v76, s95
    v_perm_b32 v13, v79, v78, s95
    v_perm_b32 v14, v81, v80, s95
    v_perm_b32 v15, v83, v82, s95
    v_perm_b32 v16, v77, v76, s96
    v_perm_b32 v17, v79, v78, s96
    v_perm_b32 v18, v81, v80, s96
    v_perm_b32 v19, v83, v82, s96
    v_accvgpr_write_b32 a120, v12
    v_accvgpr_write_b32 a121, v13
    v_accvgpr_write_b32 a122, v14
    v_accvgpr_write_b32 a123, v15
    v_accvgpr_write_b32 a124, v16
    v_accvgpr_write_b32 a125, v17
    v_accvgpr_write_b32 a126, v18
    v_accvgpr_write_b32 a127, v19
    s_add_u32 s84, s86, 720896
    buffer_load_dword v68, v5, s[16:19], s84 offen
    s_add_u32 s84, s86, 721920
    buffer_load_dword v69, v5, s[16:19], s84 offen
    s_add_u32 s84, s86, 722944
    buffer_load_dword v70, v5, s[16:19], s84 offen
    s_add_u32 s84, s86, 723968
    buffer_load_dword v71, v5, s[16:19], s84 offen
    s_add_u32 s84, s86, 724992
    buffer_load_dword v72, v5, s[16:19], s84 offen
    s_add_u32 s84, s86, 726016
    buffer_load_dword v73, v5, s[16:19], s84 offen
    s_add_u32 s84, s86, 727040
    buffer_load_dword v74, v5, s[16:19], s84 offen
    s_add_u32 s84, s86, 728064
    buffer_load_dword v75, v5, s[16:19], s84 offen
    s_add_u32 s84, s86, 729088
    buffer_load_dword v76, v5, s[16:19], s84 offen
    s_add_u32 s84, s86, 730112
    buffer_load_dword v77, v5, s[16:19], s84 offen
    s_add_u32 s84, s86, 731136
    buffer_load_dword v78, v5, s[16:19], s84 offen
    s_add_u32 s84, s86, 732160
    buffer_load_dword v79, v5, s[16:19], s84 offen
    s_add_u32 s84, s86, 733184
    buffer_load_dword v80, v5, s[16:19], s84 offen
    s_add_u32 s84, s86, 734208
    buffer_load_dword v81, v5, s[16:19], s84 offen
    s_add_u32 s84, s86, 735232
    buffer_load_dword v82, v5, s[16:19], s84 offen
    s_add_u32 s84, s86, 736256
    buffer_load_dword v83, v5, s[16:19], s84 offen
    s_waitcnt vmcnt(48)
    v_perm_b32 v12, v85, v84, s95
    v_perm_b32 v13, v87, v86, s95
    v_perm_b32 v14, v89, v88, s95
    v_perm_b32 v15, v91, v90, s95
    v_perm_b32 v16, v85, v84, s96
    v_perm_b32 v17, v87, v86, s96
    v_perm_b32 v18, v89, v88, s96
    v_perm_b32 v19, v91, v90, s96
    v_accvgpr_write_b32 a128, v12
    v_accvgpr_write_b32 a129, v13
    v_accvgpr_write_b32 a130, v14
    v_accvgpr_write_b32 a131, v15
    v_accvgpr_write_b32 a132, v16
    v_accvgpr_write_b32 a133, v17
    v_accvgpr_write_b32 a134, v18
    v_accvgpr_write_b32 a135, v19
    v_perm_b32 v12, v93, v92, s95
    v_perm_b32 v13, v95, v94, s95
    v_perm_b32 v14, v97, v96, s95
    v_perm_b32 v15, v99, v98, s95
    v_perm_b32 v16, v93, v92, s96
    v_perm_b32 v17, v95, v94, s96
    v_perm_b32 v18, v97, v96, s96
    v_perm_b32 v19, v99, v98, s96
    v_accvgpr_write_b32 a136, v12
    v_accvgpr_write_b32 a137, v13
    v_accvgpr_write_b32 a138, v14
    v_accvgpr_write_b32 a139, v15
    v_accvgpr_write_b32 a140, v16
    v_accvgpr_write_b32 a141, v17
    v_accvgpr_write_b32 a142, v18
    v_accvgpr_write_b32 a143, v19
    s_add_u32 s84, s86, 786432
    buffer_load_dword v84, v5, s[16:19], s84 offen
    s_add_u32 s84, s86, 787456
    buffer_load_dword v85, v5, s[16:19], s84 offen
    s_add_u32 s84, s86, 788480
    buffer_load_dword v86, v5, s[16:19], s84 offen
    s_add_u32 s84, s86, 789504
    buffer_load_dword v87, v5, s[16:19], s84 offen
    s_add_u32 s84, s86, 790528
    buffer_load_dword v88, v5, s[16:19], s84 offen
    s_add_u32 s84, s86, 791552
    buffer_load_dword v89, v5, s[16:19], s84 offen
    s_add_u32 s84, s86, 792576
    buffer_load_dword v90, v5, s[16:19], s84 offen
    s_add_u32 s84, s86, 793600
    buffer_load_dword v91, v5, s[16:19], s84 offen
    s_add_u32 s84, s86, 794624
    buffer_load_dword v92, v5, s[16:19], s84 offen
    s_add_u32 s84, s86, 795648
    buffer_load_dword v93, v5, s[16:19], s84 offen
    s_add_u32 s84, s86, 796672
    buffer_load_dword v94, v5, s[16:19], s84 offen
    s_add_u32 s84, s86, 797696
    buffer_load_dword v95, v5, s[16:19], s84 offen
    s_add_u32 s84, s86, 798720
    buffer_load_dword v96, v5, s[16:19], s84 offen
    s_add_u32 s84, s86, 799744
    buffer_load_dword v97, v5, s[16:19], s84 offen
    s_add_u32 s84, s86, 800768
    buffer_load_dword v98, v5, s[16:19], s84 offen
    s_add_u32 s84, s86, 801792
    buffer_load_dword v99, v5, s[16:19], s84 offen
    s_waitcnt vmcnt(48)
    v_perm_b32 v12, v37, v36, s95
    v_perm_b32 v13, v39, v38, s95
    v_perm_b32 v14, v41, v40, s95
    v_perm_b32 v15, v43, v42, s95
    v_perm_b32 v16, v37, v36, s96
    v_perm_b32 v17, v39, v38, s96
    v_perm_b32 v18, v41, v40, s96
    v_perm_b32 v19, v43, v42, s96
    v_accvgpr_write_b32 a144, v12
    v_accvgpr_write_b32 a145, v13
    v_accvgpr_write_b32 a146, v14
    v_accvgpr_write_b32 a147, v15
    v_accvgpr_write_b32 a148, v16
    v_accvgpr_write_b32 a149, v17
    v_accvgpr_write_b32 a150, v18
    v_accvgpr_write_b32 a151, v19
    v_perm_b32 v12, v45, v44, s95
    v_perm_b32 v13, v47, v46, s95
    v_perm_b32 v14, v49, v48, s95
    v_perm_b32 v15, v51, v50, s95
    v_perm_b32 v16, v45, v44, s96
    v_perm_b32 v17, v47, v46, s96
    v_perm_b32 v18, v49, v48, s96
    v_perm_b32 v19, v51, v50, s96
    v_accvgpr_write_b32 a152, v12
    v_accvgpr_write_b32 a153, v13
    v_accvgpr_write_b32 a154, v14
    v_accvgpr_write_b32 a155, v15
    v_accvgpr_write_b32 a156, v16
    v_accvgpr_write_b32 a157, v17
    v_accvgpr_write_b32 a158, v18
    v_accvgpr_write_b32 a159, v19
    s_add_u32 s84, s86, 851968
    buffer_load_dword v36, v5, s[16:19], s84 offen
    s_add_u32 s84, s86, 852992
    buffer_load_dword v37, v5, s[16:19], s84 offen
    s_add_u32 s84, s86, 854016
    buffer_load_dword v38, v5, s[16:19], s84 offen
    s_add_u32 s84, s86, 855040
    buffer_load_dword v39, v5, s[16:19], s84 offen
    s_add_u32 s84, s86, 856064
    buffer_load_dword v40, v5, s[16:19], s84 offen
    s_add_u32 s84, s86, 857088
    buffer_load_dword v41, v5, s[16:19], s84 offen
    s_add_u32 s84, s86, 858112
    buffer_load_dword v42, v5, s[16:19], s84 offen
    s_add_u32 s84, s86, 859136
    buffer_load_dword v43, v5, s[16:19], s84 offen
    s_add_u32 s84, s86, 860160
    buffer_load_dword v44, v5, s[16:19], s84 offen
    s_add_u32 s84, s86, 861184
    buffer_load_dword v45, v5, s[16:19], s84 offen
    s_add_u32 s84, s86, 862208
    buffer_load_dword v46, v5, s[16:19], s84 offen
    s_add_u32 s84, s86, 863232
    buffer_load_dword v47, v5, s[16:19], s84 offen
    s_add_u32 s84, s86, 864256
    buffer_load_dword v48, v5, s[16:19], s84 offen
    s_add_u32 s84, s86, 865280
    buffer_load_dword v49, v5, s[16:19], s84 offen
    s_add_u32 s84, s86, 866304
    buffer_load_dword v50, v5, s[16:19], s84 offen
    s_add_u32 s84, s86, 867328
    buffer_load_dword v51, v5, s[16:19], s84 offen
    s_waitcnt vmcnt(48)
    v_perm_b32 v12, v53, v52, s95
    v_perm_b32 v13, v55, v54, s95
    v_perm_b32 v14, v57, v56, s95
    v_perm_b32 v15, v59, v58, s95
    v_perm_b32 v16, v53, v52, s96
    v_perm_b32 v17, v55, v54, s96
    v_perm_b32 v18, v57, v56, s96
    v_perm_b32 v19, v59, v58, s96
    v_accvgpr_write_b32 a160, v12
    v_accvgpr_write_b32 a161, v13
    v_accvgpr_write_b32 a162, v14
    v_accvgpr_write_b32 a163, v15
    v_accvgpr_write_b32 a164, v16
    v_accvgpr_write_b32 a165, v17
    v_accvgpr_write_b32 a166, v18
    v_accvgpr_write_b32 a167, v19
    v_perm_b32 v12, v61, v60, s95
    v_perm_b32 v13, v63, v62, s95
    v_perm_b32 v14, v65, v64, s95
    v_perm_b32 v15, v67, v66, s95
    v_perm_b32 v16, v61, v60, s96
    v_perm_b32 v17, v63, v62, s96
    v_perm_b32 v18, v65, v64, s96
    v_perm_b32 v19, v67, v66, s96
    v_accvgpr_write_b32 a168, v12
    v_accvgpr_write_b32 a169, v13
    v_accvgpr_write_b32 a170, v14
    v_accvgpr_write_b32 a171, v15
    v_accvgpr_write_b32 a172, v16
    v_accvgpr_write_b32 a173, v17
    v_accvgpr_write_b32 a174, v18
    v_accvgpr_write_b32 a175, v19
    s_add_u32 s84, s86, 917504
    buffer_load_dword v52, v5, s[16:19], s84 offen
    s_add_u32 s84, s86, 918528
    buffer_load_dword v53, v5, s[16:19], s84 offen
    s_add_u32 s84, s86, 919552
    buffer_load_dword v54, v5, s[16:19], s84 offen
    s_add_u32 s84, s86, 920576
    buffer_load_dword v55, v5, s[16:19], s84 offen
    s_add_u32 s84, s86, 921600
    buffer_load_dword v56, v5, s[16:19], s84 offen
    s_add_u32 s84, s86, 922624
    buffer_load_dword v57, v5, s[16:19], s84 offen
    s_add_u32 s84, s86, 923648
    buffer_load_dword v58, v5, s[16:19], s84 offen
    s_add_u32 s84, s86, 924672
    buffer_load_dword v59, v5, s[16:19], s84 offen
    s_add_u32 s84, s86, 925696
    buffer_load_dword v60, v5, s[16:19], s84 offen
    s_add_u32 s84, s86, 926720
    buffer_load_dword v61, v5, s[16:19], s84 offen
    s_add_u32 s84, s86, 927744
    buffer_load_dword v62, v5, s[16:19], s84 offen
    s_add_u32 s84, s86, 928768
    buffer_load_dword v63, v5, s[16:19], s84 offen
    s_add_u32 s84, s86, 929792
    buffer_load_dword v64, v5, s[16:19], s84 offen
    s_add_u32 s84, s86, 930816
    buffer_load_dword v65, v5, s[16:19], s84 offen
    s_add_u32 s84, s86, 931840
    buffer_load_dword v66, v5, s[16:19], s84 offen
    s_add_u32 s84, s86, 932864
    buffer_load_dword v67, v5, s[16:19], s84 offen
    s_waitcnt vmcnt(48)
    v_perm_b32 v12, v69, v68, s95
    v_perm_b32 v13, v71, v70, s95
    v_perm_b32 v14, v73, v72, s95
    v_perm_b32 v15, v75, v74, s95
    v_perm_b32 v16, v69, v68, s96
    v_perm_b32 v17, v71, v70, s96
    v_perm_b32 v18, v73, v72, s96
    v_perm_b32 v19, v75, v74, s96
    v_accvgpr_write_b32 a176, v12
    v_accvgpr_write_b32 a177, v13
    v_accvgpr_write_b32 a178, v14
    v_accvgpr_write_b32 a179, v15
    v_accvgpr_write_b32 a180, v16
    v_accvgpr_write_b32 a181, v17
    v_accvgpr_write_b32 a182, v18
    v_accvgpr_write_b32 a183, v19
    v_perm_b32 v12, v77, v76, s95
    v_perm_b32 v13, v79, v78, s95
    v_perm_b32 v14, v81, v80, s95
    v_perm_b32 v15, v83, v82, s95
    v_perm_b32 v16, v77, v76, s96
    v_perm_b32 v17, v79, v78, s96
    v_perm_b32 v18, v81, v80, s96
    v_perm_b32 v19, v83, v82, s96
    v_accvgpr_write_b32 a184, v12
    v_accvgpr_write_b32 a185, v13
    v_accvgpr_write_b32 a186, v14
    v_accvgpr_write_b32 a187, v15
    v_accvgpr_write_b32 a188, v16
    v_accvgpr_write_b32 a189, v17
    v_accvgpr_write_b32 a190, v18
    v_accvgpr_write_b32 a191, v19
    s_add_u32 s84, s86, 983040
    buffer_load_dword v68, v5, s[16:19], s84 offen
    s_add_u32 s84, s86, 984064
    buffer_load_dword v69, v5, s[16:19], s84 offen
    s_add_u32 s84, s86, 985088
    buffer_load_dword v70, v5, s[16:19], s84 offen
    s_add_u32 s84, s86, 986112
    buffer_load_dword v71, v5, s[16:19], s84 offen
    s_add_u32 s84, s86, 987136
    buffer_load_dword v72, v5, s[16:19], s84 offen
    s_add_u32 s84, s86, 988160
    buffer_load_dword v73, v5, s[16:19], s84 offen
    s_add_u32 s84, s86, 989184
    buffer_load_dword v74, v5, s[16:19], s84 offen
    s_add_u32 s84, s86, 990208
    buffer_load_dword v75, v5, s[16:19], s84 offen
    s_add_u32 s84, s86, 991232
    buffer_load_dword v76, v5, s[16:19], s84 offen
    s_add_u32 s84, s86, 992256
    buffer_load_dword v77, v5, s[16:19], s84 offen
    s_add_u32 s84, s86, 993280
    buffer_load_dword v78, v5, s[16:19], s84 offen
    s_add_u32 s84, s86, 994304
    buffer_load_dword v79, v5, s[16:19], s84 offen
    s_add_u32 s84, s86, 995328
    buffer_load_dword v80, v5, s[16:19], s84 offen
    s_add_u32 s84, s86, 996352
    buffer_load_dword v81, v5, s[16:19], s84 offen
    s_add_u32 s84, s86, 997376
    buffer_load_dword v82, v5, s[16:19], s84 offen
    s_add_u32 s84, s86, 998400
    buffer_load_dword v83, v5, s[16:19], s84 offen
    s_waitcnt vmcnt(48)
    v_perm_b32 v12, v85, v84, s95
    v_perm_b32 v13, v87, v86, s95
    v_perm_b32 v14, v89, v88, s95
    v_perm_b32 v15, v91, v90, s95
    v_perm_b32 v16, v85, v84, s96
    v_perm_b32 v17, v87, v86, s96
    v_perm_b32 v18, v89, v88, s96
    v_perm_b32 v19, v91, v90, s96
    v_accvgpr_write_b32 a192, v12
    v_accvgpr_write_b32 a193, v13
    v_accvgpr_write_b32 a194, v14
    v_accvgpr_write_b32 a195, v15
    v_accvgpr_write_b32 a196, v16
    v_accvgpr_write_b32 a197, v17
    v_accvgpr_write_b32 a198, v18
    v_accvgpr_write_b32 a199, v19
    v_perm_b32 v12, v93, v92, s95
    v_perm_b32 v13, v95, v94, s95
    v_perm_b32 v14, v97, v96, s95
    v_perm_b32 v15, v99, v98, s95
    v_perm_b32 v16, v93, v92, s96
    v_perm_b32 v17, v95, v94, s96
    v_perm_b32 v18, v97, v96, s96
    v_perm_b32 v19, v99, v98, s96
    v_accvgpr_write_b32 a200, v12
    v_accvgpr_write_b32 a201, v13
    v_accvgpr_write_b32 a202, v14
    v_accvgpr_write_b32 a203, v15
    v_accvgpr_write_b32 a204, v16
    v_accvgpr_write_b32 a205, v17
    v_accvgpr_write_b32 a206, v18
    v_accvgpr_write_b32 a207, v19
    s_waitcnt vmcnt(32)
    v_perm_b32 v12, v37, v36, s95
    v_perm_b32 v13, v39, v38, s95
    v_perm_b32 v14, v41, v40, s95
    v_perm_b32 v15, v43, v42, s95
    v_perm_b32 v16, v37, v36, s96
    v_perm_b32 v17, v39, v38, s96
    v_perm_b32 v18, v41, v40, s96
    v_perm_b32 v19, v43, v42, s96
    v_accvgpr_write_b32 a208, v12
    v_accvgpr_write_b32 a209, v13
    v_accvgpr_write_b32 a210, v14
    v_accvgpr_write_b32 a211, v15
    v_accvgpr_write_b32 a212, v16
    v_accvgpr_write_b32 a213, v17
    v_accvgpr_write_b32 a214, v18
    v_accvgpr_write_b32 a215, v19
    v_perm_b32 v12, v45, v44, s95
    v_perm_b32 v13, v47, v46, s95
    v_perm_b32 v14, v49, v48, s95
    v_perm_b32 v15, v51, v50, s95
    v_perm_b32 v16, v45, v44, s96
    v_perm_b32 v17, v47, v46, s96
    v_perm_b32 v18, v49, v48, s96
    v_perm_b32 v19, v51, v50, s96
    v_accvgpr_write_b32 a216, v12
    v_accvgpr_write_b32 a217, v13
    v_accvgpr_write_b32 a218, v14
    v_accvgpr_write_b32 a219, v15
    v_accvgpr_write_b32 a220, v16
    v_accvgpr_write_b32 a221, v17
    v_accvgpr_write_b32 a222, v18
    v_accvgpr_write_b32 a223, v19
    s_waitcnt vmcnt(16)
    v_perm_b32 v12, v53, v52, s95
    v_perm_b32 v13, v55, v54, s95
    v_perm_b32 v14, v57, v56, s95
    v_perm_b32 v15, v59, v58, s95
    v_perm_b32 v16, v53, v52, s96
    v_perm_b32 v17, v55, v54, s96
    v_perm_b32 v18, v57, v56, s96
    v_perm_b32 v19, v59, v58, s96
    v_accvgpr_write_b32 a224, v12
    v_accvgpr_write_b32 a225, v13
    v_accvgpr_write_b32 a226, v14
    v_accvgpr_write_b32 a227, v15
    v_accvgpr_write_b32 a228, v16
    v_accvgpr_write_b32 a229, v17
    v_accvgpr_write_b32 a230, v18
    v_accvgpr_write_b32 a231, v19
    v_perm_b32 v12, v61, v60, s95
    v_perm_b32 v13, v63, v62, s95
    v_perm_b32 v14, v65, v64, s95
    v_perm_b32 v15, v67, v66, s95
    v_perm_b32 v16, v61, v60, s96
    v_perm_b32 v17, v63, v62, s96
    v_perm_b32 v18, v65, v64, s96
    v_perm_b32 v19, v67, v66, s96
    v_accvgpr_write_b32 a232, v12
    v_accvgpr_write_b32 a233, v13
    v_accvgpr_write_b32 a234, v14
    v_accvgpr_write_b32 a235, v15
    v_accvgpr_write_b32 a236, v16
    v_accvgpr_write_b32 a237, v17
    v_accvgpr_write_b32 a238, v18
    v_accvgpr_write_b32 a239, v19
    s_waitcnt vmcnt(0)
    v_perm_b32 v12, v69, v68, s95
    v_perm_b32 v13, v71, v70, s95
    v_perm_b32 v14, v73, v72, s95
    v_perm_b32 v15, v75, v74, s95
    v_perm_b32 v16, v69, v68, s96
    v_perm_b32 v17, v71, v70, s96
    v_perm_b32 v18, v73, v72, s96
    v_perm_b32 v19, v75, v74, s96
    v_accvgpr_write_b32 a240, v12
    v_accvgpr_write_b32 a241, v13
    v_accvgpr_write_b32 a242, v14
    v_accvgpr_write_b32 a243, v15
    v_accvgpr_write_b32 a244, v16
    v_accvgpr_write_b32 a245, v17
    v_accvgpr_write_b32 a246, v18
    v_accvgpr_write_b32 a247, v19
    v_perm_b32 v12, v77, v76, s95
    v_perm_b32 v13, v79, v78, s95
    v_perm_b32 v14, v81, v80, s95
    v_perm_b32 v15, v83, v82, s95
    v_perm_b32 v16, v77, v76, s96
    v_perm_b32 v17, v79, v78, s96
    v_perm_b32 v18, v81, v80, s96
    v_perm_b32 v19, v83, v82, s96
    v_accvgpr_write_b32 a248, v12
    v_accvgpr_write_b32 a249, v13
    v_accvgpr_write_b32 a250, v14
    v_accvgpr_write_b32 a251, v15
    v_accvgpr_write_b32 a252, v16
    v_accvgpr_write_b32 a253, v17
    v_accvgpr_write_b32 a254, v18
    v_accvgpr_write_b32 a255, v19
    s_mov_b32 s16, s32
    s_and_b32 s17, s33, 0xffff
    s_mov_b32 s18, 0x200000
    s_mov_b32 s19, 0x20000
    s_mov_b32 s20, s54
    s_and_b32 s21, s55, 0xffff
    s_mov_b32 s22, 0x200000
    s_mov_b32 s23, 0x20000
    s_mov_b32 s67, s64
T2_loop:
    s_lshr_b32 s66, s64, 1
    s_lshl_b32 s85, s66, 6
    s_add_u32 s85, s85, 0x720f000
    s_mov_b32 s83, 0
    s_mov_b64 exec, 0x3fff
PF_27:
    buffer_load_dword v12, v7, s[8:11], s85 offen sc1
    s_add_u32 s83, s83, 1
    s_cmp_gt_u32 s83, 0x400000
    s_cbranch_scc1 B_fail
    s_waitcnt vmcnt(0)
    v_cmp_eq_u32 vcc, 0, v12
    s_cbranch_vccz PFd_28
    s_sleep 8
    s_branch PF_27
PFd_28:
    s_mov_b64 exec, -1
    s_mul_i32 s85, s64, 57344
    s_mul_i32 s86, s61, 14336
    s_add_u32 s85, s85, s86
    s_add_u32 s85, s85, 0x5000000
    buffer_load_dwordx4 v[36:39], v4, s[8:11], s85 offen offset:0 sc1
    buffer_load_dwordx4 v[40:43], v4, s[8:11], s85 offen offset:1024 sc1
    buffer_load_dwordx4 v[44:47], v4, s[8:11], s85 offen offset:2048 sc1
    buffer_load_dwordx4 v[48:51], v4, s[8:11], s85 offen offset:3072 sc1
    s_add_u32 s85, s85, 4096
    buffer_load_dwordx4 v[52:55], v4, s[8:11], s85 offen offset:0 sc1
    buffer_load_dwordx4 v[56:59], v4, s[8:11], s85 offen offset:1024 sc1
    buffer_load_dwordx4 v[60:63], v4, s[8:11], s85 offen offset:2048 sc1
    buffer_load_dwordx4 v[64:67], v4, s[8:11], s85 offen offset:3072 sc1
    s_add_u32 s85, s85, 4096
    buffer_load_dwordx4 v[68:71], v4, s[8:11], s85 offen offset:0 sc1
    buffer_load_dwordx4 v[72:75], v4, s[8:11], s85 offen offset:1024 sc1
    buffer_load_dwordx4 v[76:79], v4, s[8:11], s85 offen offset:2048 sc1
    buffer_load_dwordx4 v[80:83], v4, s[8:11], s85 offen offset:3072 sc1
    s_add_u32 s85, s85, 4096
    buffer_load_dwordx4 v[84:87], v4, s[8:11], s85 offen offset:0 sc1
    buffer_load_dwordx4 v[88:91], v4, s[8:11], s85 offen offset:1024 sc1
    s_lshl_b32 s69, s64, 14
    buffer_load_dword v132, v10, s[16:19], s69 offen
    s_waitcnt vmcnt(14)
    v_mfma_f32_16x16x32_bf16 v[28:31], v[144:147], v[36:39], 0
    v_mfma_f32_16x16x32_bf16 v[32:35], v[148:151], v[36:39], 0
    s_waitcnt vmcnt(13)
    v_mfma_f32_16x16x32_bf16 v[28:31], v[152:155], v[40:43], v[28:31]
    v_mfma_f32_16x16x32_bf16 v[32:35], v[156:159], v[40:43], v[32:35]
    s_waitcnt vmcnt(12)
    v_mfma_f32_16x16x32_bf16 v[28:31], v[160:163], v[44:47], v[28:31]
    v_mfma_f32_16x16x32_bf16 v[32:35], v[164:167], v[44:47], v[32:35]
    s_waitcnt vmcnt(11)
    v_mfma_f32_16x16x32_bf16 v[28:31], v[168:171], v[48:51], v[28:31]
    v_mfma_f32_16x16x32_bf16 v[32:35], v[172:175], v[48:51], v[32:35]
    s_waitcnt vmcnt(10)
    v_mfma_f32_16x16x32_bf16 v[28:31], v[176:179], v[52:55], v[28:31]
    v_mfma_f32_16x16x32_bf16 v[32:35], v[180:183], v[52:55], v[32:35]
    s_waitcnt vmcnt(9)
    v_mfma_f32_16x16x32_bf16 v[28:31], v[184:187], v[56:59], v[28:31]
    v_mfma_f32_16x16x32_bf16 v[32:35], v[188:191], v[56:59], v[32:35]
    s_waitcnt vmcnt(8)
    v_mfma_f32_16x16x32_bf16 v[28:31], v[192:195], v[60:63], v[28:31]
    v_mfma_f32_16x16x32_bf16 v[32:35], v[196:199], v[60:63], v[32:35]
    s_waitcnt vmcnt(7)
    v_mfma_f32_16x16x32_bf16 v[28:31], v[200:203], v[64:67], v[28:31]
    v_mfma_f32_16x16x32_bf16 v[32:35], v[204:207], v[64:67], v[32:35]
    s_waitcnt vmcnt(6)
    v_mfma_f32_16x16x32_bf16 v[28:31], v[208:211], v[68:71], v[28:31]
    v_mfma_f32_16x16x32_bf16 v[32:35], v[212:215], v[68:71], v[32:35]
    s_waitcnt vmcnt(5)
    v_mfma_f32_16x16x32_bf16 v[28:31], v[216:219], v[72:75], v[28:31]
    v_mfma_f32_16x16x32_bf16 v[32:35], v[220:223], v[72:75], v[32:35]
    s_waitcnt vmcnt(4)
    v_mfma_f32_16x16x32_bf16 v[28:31], v[224:227], v[76:79], v[28:31]
    v_mfma_f32_16x16x32_bf16 v[32:35], v[228:231], v[76:79], v[32:35]
    s_waitcnt vmcnt(3)
    v_mfma_f32_16x16x32_bf16 v[28:31], v[232:235], v[80:83], v[28:31]
    v_mfma_f32_16x16x32_bf16 v[32:35], v[236:239], v[80:83], v[32:35]
    s_waitcnt vmcnt(2)
    v_mfma_f32_16x16x32_bf16 v[28:31], v[240:243], v[84:87], v[28:31]
    v_mfma_f32_16x16x32_bf16 v[32:35], v[244:247], v[84:87], v[32:35]
    s_waitcnt vmcnt(1)
    v_mfma_f32_16x16x32_bf16 v[28:31], v[248:251], v[88:91], v[28:31]
    v_mfma_f32_16x16x32_bf16 v[32:35], v[252:255], v[88:91], v[32:35]
    s_mul_i32 s71, s66, 43
    s_lshr_b32 s71, s71, 9
    s_mul_i32 s85, s71, 12
    s_sub_u32 s85, s66, s85
    s_lshl_b32 s85, s85, 10
    s_lshl_b32 s86, s61, 8
    s_add_u32 s85, s85, s86
    s_add_u32 s85, s85, 0x720c000
    s_add_u32 s71, s71, 1
    s_lshl_b32 s68, s66, 18
    s_lshl_b32 s86, s61, 16
    s_add_u32 s68, s68, s86
    s_and_b32 s86, s64, 1
    s_lshl_b32 s86, s86, 12
    s_add_u32 s68, s68, s86
    s_add_u32 s68, s68, 0x4000000
    ds_write_b32 v8, v28 offset:8
    ds_write_b32 v8, v29 offset:1032
    ds_write_b32 v8, v30 offset:2056
    ds_write_b32 v8, v31 offset:3080
    ds_write_b32 v8, v32 offset:12
    ds_write_b32 v8, v33 offset:1036
    ds_write_b32 v8, v34 offset:2060
    ds_write_b32 v8, v35 offset:3084
    s_mov_b32 s83, 0
    s_mov_b64 exec, 0xff
PF_29:
    buffer_load_dword v12, v11, s[8:11], s85 offen sc1
    s_add_u32 s83, s83, 1
    s_cmp_gt_u32 s83, 0x400000
    s_cbranch_scc1 B_fail
    s_waitcnt vmcnt(0)
    v_cmp_gt_u32 vcc, s71, v12
    s_cbranch_vccz PFd_30
    s_sleep 2
    s_branch PF_29
PFd_30:
    s_mov_b64 exec, -1
    s_add_u32 s85, s68, 0
    buffer_load_dwordx4 v[36:39], v4, s[8:11], s85 offen offset:0 sc1
    buffer_load_dwordx4 v[40:43], v4, s[8:11], s85 offen offset:1024 sc1
    buffer_load_dwordx4 v[44:47], v4, s[8:11], s85 offen offset:2048 sc1
    buffer_load_dwordx4 v[48:51], v4, s[8:11], s85 offen offset:3072 sc1
    s_add_u32 s85, s68, 8192
    buffer_load_dwordx4 v[52:55], v4, s[8:11], s85 offen offset:0 sc1
    buffer_load_dwordx4 v[56:59], v4, s[8:11], s85 offen offset:1024 sc1
    buffer_load_dwordx4 v[60:63], v4, s[8:11], s85 offen offset:2048 sc1
    buffer_load_dwordx4 v[64:67], v4, s[8:11], s85 offen offset:3072 sc1
    s_add_u32 s85, s68, 16384
    buffer_load_dwordx4 v[68:71], v4, s[8:11], s85 offen offset:0 sc1
    buffer_load_dwordx4 v[72:75], v4, s[8:11], s85 offen offset:1024 sc1
    buffer_load_dwordx4 v[76:79], v4, s[8:11], s85 offen offset:2048 sc1
    buffer_load_dwordx4 v[80:83], v4, s[8:11], s85 offen offset:3072 sc1
    s_add_u32 s85, s68, 24576
    buffer_load_dwordx4 v[84:87], v4, s[8:11], s85 offen offset:0 sc1
    buffer_load_dwordx4 v[88:91], v4, s[8:11], s85 offen offset:1024 sc1
    buffer_load_dwordx4 v[92:95], v4, s[8:11], s85 offen offset:2048 sc1
    buffer_load_dwordx4 v[96:99], v4, s[8:11], s85 offen offset:3072 sc1
    s_add_u32 s85, s68, 32768
    buffer_load_dwordx4 v[100:103], v4, s[8:11], s85 offen offset:0 sc1
    buffer_load_dwordx4 v[104:107], v4, s[8:11], s85 offen offset:1024 sc1
    buffer_load_dwordx4 v[108:111], v4, s[8:11], s85 offen offset:2048 sc1
    buffer_load_dwordx4 v[112:115], v4, s[8:11], s85 offen offset:3072 sc1
    s_add_u32 s85, s68, 40960
    buffer_load_dwordx4 v[116:119], v4, s[8:11], s85 offen offset:0 sc1
    buffer_load_dwordx4 v[120:123], v4, s[8:11], s85 offen offset:1024 sc1
    buffer_load_dwordx4 v[124:127], v4, s[8:11], s85 offen offset:2048 sc1
    buffer_load_dwordx4 v[128:131], v4, s[8:11], s85 offen offset:3072 sc1
    s_waitcnt vmcnt(23)
    v_mfma_f32_16x16x32_bf16 v[20:23], a[0:3], v[36:39], 0
    v_mfma_f32_16x16x32_bf16 v[24:27], a[4:7], v[36:39], 0
    s_add_u32 s85, s68, 49152
    buffer_load_dwordx4 v[36:39], v4, s[8:11], s85 offen offset:0 sc1
    s_waitcnt vmcnt(23)
    v_mfma_f32_16x16x32_bf16 v[20:23], a[8:11], v[40:43], v[20:23]
    v_mfma_f32_16x16x32_bf16 v[24:27], a[12:15], v[40:43], v[24:27]
    buffer_load_dwordx4 v[40:43], v4, s[8:11], s85 offen offset:1024 sc1
    s_waitcnt vmcnt(23)
    v_mfma_f32_16x16x32_bf16 v[20:23], a[16:19], v[44:47], v[20:23]
    v_mfma_f32_16x16x32_bf16 v[24:27], a[20:23], v[44:47], v[24:27]
    buffer_load_dwordx4 v[44:47], v4, s[8:11], s85 offen offset:2048 sc1
    s_waitcnt vmcnt(23)
    v_mfma_f32_16x16x32_bf16 v[20:23], a[24:27], v[48:51], v[20:23]
    v_mfma_f32_16x16x32_bf16 v[24:27], a[28:31], v[48:51], v[24:27]
    buffer_load_dwordx4 v[48:51], v4, s[8:11], s85 offen offset:3072 sc1
    s_waitcnt vmcnt(23)
    v_mfma_f32_16x16x32_bf16 v[20:23], a[32:35], v[52:55], v[20:23]
    v_mfma_f32_16x16x32_bf16 v[24:27], a[36:39], v[52:55], v[24:27]
    s_add_u32 s85, s68, 57344
    buffer_load_dwordx4 v[52:55], v4, s[8:11], s85 offen offset:0 sc1
    s_waitcnt vmcnt(23)
    v_mfma_f32_16x16x32_bf16 v[20:23], a[40:43], v[56:59], v[20:23]
    v_mfma_f32_16x16x32_bf16 v[24:27], a[44:47], v[56:59], v[24:27]
    buffer_load_dwordx4 v[56:59], v4, s[8:11], s85 offen offset:1024 sc1
    s_waitcnt vmcnt(23)
    v_mfma_f32_16x16x32_bf16 v[20:23], a[48:51], v[60:63], v[20:23]
    v_mfma_f32_16x16x32_bf16 v[24:27], a[52:55], v[60:63], v[24:27]
    buffer_load_dwordx4 v[60:63], v4, s[8:11], s85 offen offset:2048 sc1
    s_waitcnt vmcnt(23)
    v_mfma_f32_16x16x32_bf16 v[20:23], a[56:59], v[64:67], v[20:23]
    v_mfma_f32_16x16x32_bf16 v[24:27], a[60:63], v[64:67], v[24:27]
    buffer_load_dwordx4 v[64:67], v4, s[8:11], s85 offen offset:3072 sc1
    s_waitcnt vmcnt(23)
    v_mfma_f32_16x16x32_bf16 v[20:23], a[64:67], v[68:71], v[20:23]
    v_mfma_f32_16x16x32_bf16 v[24:27], a[68:71], v[68:71], v[24:27]
    s_waitcnt vmcnt(22)
    v_mfma_f32_16x16x32_bf16 v[20:23], a[72:75], v[72:75], v[20:23]
    v_mfma_f32_16x16x32_bf16 v[24:27], a[76:79], v[72:75], v[24:27]
    s_waitcnt vmcnt(21)
    v_mfma_f32_16x16x32_bf16 v[20:23], a[80:83], v[76:79], v[20:23]
    v_mfma_f32_16x16x32_bf16 v[24:27], a[84:87], v[76:79], v[24:27]
    s_waitcnt vmcnt(20)
    v_mfma_f32_16x16x32_bf16 v[20:23], a[88:91], v[80:83], v[20:23]
    v_mfma_f32_16x16x32_bf16 v[24:27], a[92:95], v[80:83], v[24:27]
    s_waitcnt vmcnt(19)
    v_mfma_f32_16x16x32_bf16 v[20:23], a[96:99], v[84:87], v[20:23]
    v_mfma_f32_16x16x32_bf16 v[24:27], a[100:103], v[84:87], v[24:27]
    s_waitcnt vmcnt(18)
    v_mfma_f32_16x16x32_bf16 v[20:23], a[104:107], v[88:91], v[20:23]
    v_mfma_f32_16x16x32_bf16 v[24:27], a[108:111], v[88:91], v[24:27]
    s_waitcnt vmcnt(17)
    v_mfma_f32_16x16x32_bf16 v[20:23], a[112:115], v[92:95], v[20:23]
    v_mfma_f32_16x16x32_bf16 v[24:27], a[116:119], v[92:95], v[24:27]
    s_waitcnt vmcnt(16)
    v_mfma_f32_16x16x32_bf16 v[20:23], a[120:123], v[96:99], v[20:23]
    v_mfma_f32_16x16x32_bf16 v[24:27], a[124:127], v[96:99], v[24:27]
    s_waitcnt vmcnt(15)
    v_mfma_f32_16x16x32_bf16 v[20:23], a[128:131], v[100:103], v[20:23]
    v_mfma_f32_16x16x32_bf16 v[24:27], a[132:135], v[100:103], v[24:27]
    s_waitcnt vmcnt(14)
    v_mfma_f32_16x16x32_bf16 v[20:23], a[136:139], v[104:107], v[20:23]
    v_mfma_f32_16x16x32_bf16 v[24:27], a[140:143], v[104:107], v[24:27]
    s_waitcnt vmcnt(13)
    v_mfma_f32_16x16x32_bf16 v[20:23], a[144:147], v[108:111], v[20:23]
    v_mfma_f32_16x16x32_bf16 v[24:27], a[148:151], v[108:111], v[24:27]
    s_waitcnt vmcnt(12)
    v_mfma_f32_16x16x32_bf16 v[20:23], a[152:155], v[112:115], v[20:23]
    v_mfma_f32_16x16x32_bf16 v[24:27], a[156:159], v[112:115], v[24:27]
    s_waitcnt vmcnt(11)
    v_mfma_f32_16x16x32_bf16 v[20:23], a[160:163], v[116:119], v[20:23]
    v_mfma_f32_16x16x32_bf16 v[24:27], a[164:167], v[116:119], v[24:27]
    s_waitcnt vmcnt(10)
    v_mfma_f32_16x16x32_bf16 v[20:23], a[168:171], v[120:123], v[20:23]
    v_mfma_f32_16x16x32_bf16 v[24:27], a[172:175], v[120:123], v[24:27]
    s_waitcnt vmcnt(9)
    v_mfma_f32_16x16x32_bf16 v[20:23], a[176:179], v[124:127], v[20:23]
    v_mfma_f32_16x16x32_bf16 v[24:27], a[180:183], v[124:127], v[24:27]
    s_waitcnt vmcnt(8)
    v_mfma_f32_16x16x32_bf16 v[20:23], a[184:187], v[128:131], v[20:23]
    v_mfma_f32_16x16x32_bf16 v[24:27], a[188:191], v[128:131], v[24:27]
    s_waitcnt vmcnt(7)
    v_mfma_f32_16x16x32_bf16 v[20:23], a[192:195], v[36:39], v[20:23]
    v_mfma_f32_16x16x32_bf16 v[24:27], a[196:199], v[36:39], v[24:27]
    s_waitcnt vmcnt(6)
    v_mfma_f32_16x16x32_bf16 v[20:23], a[200:203], v[40:43], v[20:23]
    v_mfma_f32_16x16x32_bf16 v[24:27], a[204:207], v[40:43], v[24:27]
    s_waitcnt vmcnt(5)
    v_mfma_f32_16x16x32_bf16 v[20:23], a[208:211], v[44:47], v[20:23]
    v_mfma_f32_16x16x32_bf16 v[24:27], a[212:215], v[44:47], v[24:27]
    s_waitcnt vmcnt(4)
    v_mfma_f32_16x16x32_bf16 v[20:23], a[216:219], v[48:51], v[20:23]
    v_mfma_f32_16x16x32_bf16 v[24:27], a[220:223], v[48:51], v[24:27]
    s_waitcnt vmcnt(3)
    v_mfma_f32_16x16x32_bf16 v[20:23], a[224:227], v[52:55], v[20:23]
    v_mfma_f32_16x16x32_bf16 v[24:27], a[228:231], v[52:55], v[24:27]
    s_waitcnt vmcnt(2)
    v_mfma_f32_16x16x32_bf16 v[20:23], a[232:235], v[56:59], v[20:23]
    v_mfma_f32_16x16x32_bf16 v[24:27], a[236:239], v[56:59], v[24:27]
    s_waitcnt vmcnt(1)
    v_mfma_f32_16x16x32_bf16 v[20:23], a[240:243], v[60:63], v[20:23]
    v_mfma_f32_16x16x32_bf16 v[24:27], a[244:247], v[60:63], v[24:27]
    s_waitcnt vmcnt(0)
    v_mfma_f32_16x16x32_bf16 v[20:23], a[248:251], v[64:67], v[20:23]
    v_mfma_f32_16x16x32_bf16 v[24:27], a[252:255], v[64:67], v[24:27]
    s_nop 6
    ds_write_b32 v8, v20 offset:0
    ds_write_b32 v8, v21 offset:1024
    ds_write_b32 v8, v22 offset:2048
    ds_write_b32 v8, v23 offset:3072
    ds_write_b32 v8, v24 offset:4
    ds_write_b32 v8, v25 offset:1028
    ds_write_b32 v8, v26 offset:2052
    ds_write_b32 v8, v27 offset:3076
    s_waitcnt lgkmcnt(0)
    s_barrier
    ds_read_b128 v[36:39], v9 offset:0
    ds_read_b128 v[40:43], v9 offset:4096
    ds_read_b128 v[44:47], v9 offset:8192
    ds_read_b128 v[48:51], v9 offset:12288
    v_xor_b32 v8, 16384, v8
    v_xor_b32 v9, 16384, v9
    s_waitcnt lgkmcnt(0)
    v_add_f32 v36, v36, v40
    v_add_f32 v44, v44, v48
    v_add_f32 v37, v37, v41
    v_add_f32 v45, v45, v49
    v_add_f32 v38, v38, v42
    v_add_f32 v46, v46, v50
    v_add_f32 v39, v39, v43
    v_add_f32 v47, v47, v51
    v_add_f32 v36, v36, v44
    v_add_f32 v37, v37, v45
    v_add_f32 v38, v38, v46
    v_add_f32 v39, v39, v47
    v_cvt_pk_bf16_f32 v36, v36, v37
    v_cvt_pk_bf16_f32 v38, v38, v39
    v_and_b32 v37, 0xffff0000, v36
    v_lshlrev_b32 v36, 16, v36
    v_and_b32 v39, 0xffff0000, v38
    v_lshlrev_b32 v38, 16, v38
    v_mul_f32 v40, s70, v38
    v_mul_f32 v41, s70, v39
    v_exp_f32 v40, v40
    v_exp_f32 v41, v41
    v_add_f32 v40, 1.0, v40
    v_add_f32 v41, 1.0, v41
    v_rcp_f32 v40, v40
    v_rcp_f32 v41, v41
    v_mul_f32 v38, v38, v40
    v_mul_f32 v39, v39, v41
    v_cvt_pk_bf16_f32 v38, v38, v39
    v_and_b32 v39, 0xffff0000, v38
    v_lshlrev_b32 v38, 16, v38
    v_mul_f32 v36, v36, v38
    v_mul_f32 v37, v37, v39
    v_cvt_pk_bf16_f32 v36, v36, v37
    v_and_b32 v37, 0xffff0000, v36
    v_lshlrev_b32 v36, 16, v36
    v_and_b32 v39, 0xffff0000, v132
    v_lshlrev_b32 v38, 16, v132
    v_add_f32 v36, v36, v38
    v_add_f32 v37, v37, v39
    v_cvt_pk_bf16_f32 v13, v36, v37
    buffer_store_dword v13, v10, s[20:23], s69 offen
    s_add_u32 s64, s64, 8
    s_cmp_lt_u32 s64, 128
    s_cbranch_scc1 T2_loop
    s_endpgm
K_t1:
    v_and_b32 v1, 63, v0
    v_and_b32 v2, 15, v1
    v_lshrrev_b32 v3, 4, v1
    v_lshlrev_b32 v4, 4, v1
    s_mov_b32 s95, 0x05040100
    s_mov_b32 s96, 0x07060302
    s_mov_b32 s92, 0x3e0293ee
    s_mov_b32 s93, 0x3e0293ee
    s_mov_b32 s70, 0xbe0293ee
    v_mov_b32 v9, 0xff61b1e6
    v_lshlrev_b32 v10, 2, v3
    v_add_u32 v11, 0, v10
    v_cmp_le_u32 s[72:73], v11, v2
    v_add_u32 v11, 1, v10
    v_cmp_le_u32 s[74:75], v11, v2
    v_add_u32 v11, 2, v10
    v_cmp_le_u32 s[76:77], v11, v2
    v_add_u32 v11, 3, v10
    v_cmp_le_u32 s[78:79], v11, v2
    s_mov_b32 s80, -1
    s_mov_b32 s81, 0
    v_lshlrev_b32 v7, 3, v1
    v_lshlrev_b32 v8, 7, v1
    v_lshrrev_b32 v10, 1, v3
    v_lshlrev_b32 v5, 10, v10
    v_and_b32 v10, 1, v3
    v_lshl_add_u32 v5, v10, 7, v5
    v_bfe_u32 v10, v2, 1, 2
    v_lshl_add_u32 v5, v10, 8, v5
    v_and_b32 v10, 1, v2
    v_lshl_add_u32 v5, v10, 2, v5
    v_add_u32 v5, 4, v5
    v_lshrrev_b32 v10, 3, v2
    v_lshlrev_b32 v6, 10, v10
    v_and_b32 v10, 1, v3
    v_lshl_add_u32 v6, v10, 9, v6
    v_and_b32 v10, 7, v2
    v_lshl_add_u32 v6, v10, 5, v6
    s_lshl_b32 s84, s61, 12
    v_add_u32 v5, s84, v5
    v_add_u32 v6, s84, v6
    s_lshl_b32 s64, s62, 2
    s_add_u32 s64, s64, s61
    s_mov_b32 s71, 0
    s_lshl_b32 s82, s62, 7
    s_lshl_b32 s84, s61, 2
    s_add_u32 s82, s82, s84
    s_add_u32 s82, s82, 0x720c000
T1_loop:
    s_lshr_b32 s65, s64, 5
    s_and_b32 s66, s64, 31
    s_lshl_b32 s85, s65, 5
    s_lshr_b32 s86, s66, 1
    s_lshl_b32 s86, s86, 11
    s_add_u32 s85, s85, s86
    s_add_u32 s85, s85, 0x7200000
    s_mov_b32 s83, 0
    s_mov_b64 exec, 0x7
PF_31:
    buffer_load_dword v10, v7, s[8:11], s85 offen sc1
    s_add_u32 s83, s83, 1
    s_cmp_gt_u32 s83, 0x400000
    s_cbranch_scc1 B_fail
    s_waitcnt vmcnt(0)
    v_cmp_eq_u32 vcc, 0, v10
    s_cbranch_vccz PFd_32
    s_sleep 8
    s_branch PF_31
PFd_32:
    s_mov_b64 exec, -1
    s_lshl_b32 s67, s64, 13
    s_add_u32 s85, s67, 0x1000000
    s_add_u32 s86, s67, 0x1001000
    buffer_load_dwordx4 v[48:51], v4, s[8:11], s85 offen offset:0 sc1
    buffer_load_dwordx4 v[52:55], v4, s[8:11], s85 offen offset:1024 sc1
    buffer_load_dwordx4 v[56:59], v4, s[8:11], s85 offen offset:2048 sc1
    buffer_load_dwordx4 v[60:63], v4, s[8:11], s85 offen offset:3072 sc1
    buffer_load_dwordx4 v[64:67], v4, s[8:11], s86 offen offset:0 sc1
    buffer_load_dwordx4 v[68:71], v4, s[8:11], s86 offen offset:1024 sc1
    buffer_load_dwordx4 v[72:75], v4, s[8:11], s86 offen offset:2048 sc1
    buffer_load_dwordx4 v[76:79], v4, s[8:11], s86 offen offset:3072 sc1
    s_add_u32 s85, s67, 0x2000000
    s_add_u32 s86, s67, 0x2001000
    buffer_load_dwordx4 v[16:19], v4, s[8:11], s85 offen offset:0 sc1
    buffer_load_dwordx4 v[20:23], v4, s[8:11], s85 offen offset:1024 sc1
    buffer_load_dwordx4 v[24:27], v4, s[8:11], s85 offen offset:2048 sc1
    buffer_load_dwordx4 v[28:31], v4, s[8:11], s85 offen offset:3072 sc1
    buffer_load_dwordx4 v[32:35], v4, s[8:11], s86 offen offset:0 sc1
    buffer_load_dwordx4 v[36:39], v4, s[8:11], s86 offen offset:1024 sc1
    buffer_load_dwordx4 v[40:43], v4, s[8:11], s86 offen offset:2048 sc1
    buffer_load_dwordx4 v[44:47], v4, s[8:11], s86 offen offset:3072 sc1
    s_add_u32 s85, s67, 0x3000000
    s_add_u32 s86, s67, 0x3001000
    buffer_load_dwordx4 v[80:83], v4, s[8:11], s85 offen offset:0 sc1
    buffer_load_dwordx4 v[84:87], v4, s[8:11], s85 offen offset:1024 sc1
    buffer_load_dwordx4 v[88:91], v4, s[8:11], s85 offen offset:2048 sc1
    buffer_load_dwordx4 v[92:95], v4, s[8:11], s85 offen offset:3072 sc1
    buffer_load_dwordx4 v[96:99], v4, s[8:11], s86 offen offset:0 sc1
    buffer_load_dwordx4 v[100:103], v4, s[8:11], s86 offen offset:1024 sc1
    buffer_load_dwordx4 v[104:107], v4, s[8:11], s86 offen offset:2048 sc1
    buffer_load_dwordx4 v[108:111], v4, s[8:11], s86 offen offset:3072 sc1
    s_waitcnt vmcnt(8)
    v_mfma_f32_16x16x32_bf16 v[144:147], v[48:51], v[16:19], 0
    v_mfma_f32_16x16x32_bf16 v[144:147], v[52:55], v[20:23], v[144:147]
    v_mfma_f32_16x16x32_bf16 v[144:147], v[56:59], v[24:27], v[144:147]
    v_mfma_f32_16x16x32_bf16 v[144:147], v[60:63], v[28:31], v[144:147]
    v_mfma_f32_16x16x32_bf16 v[152:155], v[48:51], v[32:35], 0
    v_mfma_f32_16x16x32_bf16 v[152:155], v[52:55], v[36:39], v[152:155]
    v_mfma_f32_16x16x32_bf16 v[152:155], v[56:59], v[40:43], v[152:155]
    v_mfma_f32_16x16x32_bf16 v[152:155], v[60:63], v[44:47], v[152:155]
    v_mfma_f32_16x16x32_bf16 v[156:159], v[64:67], v[32:35], 0
    v_mfma_f32_16x16x32_bf16 v[156:159], v[68:71], v[36:39], v[156:159]
    v_mfma_f32_16x16x32_bf16 v[156:159], v[72:75], v[40:43], v[156:159]
    v_mfma_f32_16x16x32_bf16 v[156:159], v[76:79], v[44:47], v[156:159]
    s_add_u32 s69, s65, 1
    s_lshl_b32 s85, s66, 9
    s_add_u32 s85, s85, 0x7208000
    v_cndmask_b32 v144, v9, v144, s[72:73]
    s_nop 3
    v_cndmask_b32 v156, v9, v156, s[72:73]
    v_cndmask_b32 v145, v9, v145, s[74:75]
    v_cndmask_b32 v157, v9, v157, s[74:75]
    v_cndmask_b32 v146, v9, v146, s[76:77]
    v_cndmask_b32 v158, v9, v158, s[76:77]
    v_cndmask_b32 v147, v9, v147, s[78:79]
    v_cndmask_b32 v159, v9, v159, s[78:79]
    v_max3_f32 v12, v144, v145, v146
    v_max_f32 v12, v12, v147
    v_max3_f32 v13, v152, v153, v154
    v_max3_f32 v13, v13, v155, v156
    v_max3_f32 v13, v13, v157, v158
    v_max_f32 v13, v13, v159
    v_pk_mul_f32 v[144:145], v[144:145], s[92:93]
    v_pk_mul_f32 v[146:147], v[146:147], s[92:93]
    v_pk_mul_f32 v[152:153], v[152:153], s[92:93]
    v_pk_mul_f32 v[154:155], v[154:155], s[92:93]
    v_pk_mul_f32 v[156:157], v[156:157], s[92:93]
    v_pk_mul_f32 v[158:159], v[158:159], s[92:93]
    s_mov_b32 s83, 0
    s_mov_b64 exec, 0xf
PF_33:
    buffer_load_dword v10, v8, s[8:11], s85 offen sc1
    s_add_u32 s83, s83, 1
    s_cmp_gt_u32 s83, 0x400000
    s_cbranch_scc1 B_fail
    s_waitcnt vmcnt(0)
    v_cmp_gt_u32 vcc, s69, v10
    s_cbranch_vccz PFd_34
    s_sleep 2
    v_readfirstlane_b32 s84, v10
    s_nop 0
    s_add_u32 s84, s84, 3
    s_cmp_ge_u32 s84, s69
    s_cbranch_scc1 PF_33
    s_sleep 60
    s_branch PF_33
PFd_34:
    s_mov_b64 exec, -1
    s_lshl_b32 s68, s64, 12
    s_add_u32 s68, s68, 0x6800000
    s_lshl_b32 m0, s61, 12
    s_nop 0
    buffer_load_dwordx4 v4, s[8:11], s68 offen offset:0 sc1 lds
    buffer_load_dwordx4 v4, s[8:11], s68 offen offset:1024 sc1 lds
    buffer_load_dwordx4 v4, s[8:11], s68 offen offset:2048 sc1 lds
    buffer_load_dwordx4 v4, s[8:11], s68 offen offset:3072 sc1 lds
    s_waitcnt vmcnt(0)
    ds_read2_b32 v[112:113], v5 offset0:0 offset1:4
    ds_read2_b32 v[114:115], v5 offset0:8 offset1:12
    ds_read2_b32 v[116:117], v5 offset0:16 offset1:20
    ds_read2_b32 v[118:119], v5 offset0:24 offset1:28
    v_add_u32 v10, 2048, v5
    ds_read2_b32 v[120:121], v10 offset0:0 offset1:4
    ds_read2_b32 v[122:123], v10 offset0:8 offset1:12
    ds_read2_b32 v[124:125], v10 offset0:16 offset1:20
    ds_read2_b32 v[126:127], v10 offset0:24 offset1:28
    v_add_u32 v11, 2048, v6
    s_waitcnt lgkmcnt(6)
    v_mfma_f32_16x16x32_bf16 v[148:151], v[112:115], v[16:19], 0
    v_mfma_f32_16x16x32_bf16 v[160:163], v[112:115], v[32:35], 0
    s_waitcnt lgkmcnt(4)
    v_mfma_f32_16x16x32_bf16 v[148:151], v[116:119], v[20:23], v[148:151]
    v_mfma_f32_16x16x32_bf16 v[160:163], v[116:119], v[36:39], v[160:163]
    s_waitcnt lgkmcnt(2)
    v_mfma_f32_16x16x32_bf16 v[148:151], v[120:123], v[24:27], v[148:151]
    v_mfma_f32_16x16x32_bf16 v[160:163], v[120:123], v[40:43], v[160:163]
    s_waitcnt lgkmcnt(0)
    v_mfma_f32_16x16x32_bf16 v[148:151], v[124:127], v[28:31], v[148:151]
    v_mfma_f32_16x16x32_bf16 v[160:163], v[124:127], v[44:47], v[160:163]
    ds_read2_b32 v[128:129], v6 offset0:0 offset1:64
    ds_read2_b32 v[130:131], v6 offset0:3 offset1:67
    ds_read2_b32 v[132:133], v6 offset0:4 offset1:68
    ds_read2_b32 v[134:135], v6 offset0:7 offset1:71
    ds_read2_b32 v[136:137], v11 offset0:0 offset1:64
    ds_read2_b32 v[138:139], v11 offset0:3 offset1:67
    ds_read2_b32 v[140:141], v11 offset0:4 offset1:68
    ds_read2_b32 v[142:143], v11 offset0:7 offset1:71
    v_max3_f32 v12, v12, v148, v149
    v_max3_f32 v12, v12, v150, v151
    v_max3_f32 v13, v13, v160, v161
    v_max3_f32 v13, v13, v162, v163
    v_mov_b32 v14, v12
    v_mov_b32 v15, v13
    s_nop 0
    v_permlane32_swap_b32 v12, v14
    v_permlane32_swap_b32 v13, v15
    v_max_f32 v12, v12, v14
    v_max_f32 v13, v13, v15
    v_mov_b32 v14, v12
    v_mov_b32 v15, v13
    s_nop 0
    v_permlane16_swap_b32 v12, v14
    v_permlane16_swap_b32 v13, v15
    v_max_f32 v12, v12, v14
    v_max_f32 v13, v13, v15
    v_mul_f32 v12, s70, v12
    v_cndmask_b32 v148, v9, v148, s[80:81]
    v_cndmask_b32 v149, v9, v149, s[80:81]
    v_cndmask_b32 v150, v9, v150, s[80:81]
    v_cndmask_b32 v151, v9, v151, s[80:81]
    v_mul_f32 v13, s70, v13
    v_cndmask_b32 v160, v9, v160, s[80:81]
    v_cndmask_b32 v161, v9, v161, s[80:81]
    v_cndmask_b32 v162, v9, v162, s[80:81]
    v_cndmask_b32 v163, v9, v163, s[80:81]
    v_pk_mul_f32 v[148:149], v[148:149], s[92:93]
    v_pk_mul_f32 v[150:151], v[150:151], s[92:93]
    v_pk_add_f32 v[144:145], v[144:145], v[12:13] op_sel:[0,0] op_sel_hi:[1,0]
    v_pk_add_f32 v[146:147], v[146:147], v[12:13] op_sel:[0,0] op_sel_hi:[1,0]
    v_pk_add_f32 v[148:149], v[148:149], v[12:13] op_sel:[0,0] op_sel_hi:[1,0]
    v_pk_add_f32 v[150:151], v[150:151], v[12:13] op_sel:[0,0] op_sel_hi:[1,0]
    v_exp_f32 v144, v144
    v_exp_f32 v145, v145
    v_exp_f32 v146, v146
    v_exp_f32 v147, v147
    v_exp_f32 v148, v148
    v_exp_f32 v149, v149
    v_exp_f32 v150, v150
    v_exp_f32 v151, v151
    v_pk_mul_f32 v[160:161], v[160:161], s[92:93]
    v_pk_mul_f32 v[162:163], v[162:163], s[92:93]
    v_pk_add_f32 v[152:153], v[152:153], v[12:13] op_sel:[0,1] op_sel_hi:[1,1]
    v_pk_add_f32 v[154:155], v[154:155], v[12:13] op_sel:[0,1] op_sel_hi:[1,1]
    v_pk_add_f32 v[156:157], v[156:157], v[12:13] op_sel:[0,1] op_sel_hi:[1,1]
    v_pk_add_f32 v[158:159], v[158:159], v[12:13] op_sel:[0,1] op_sel_hi:[1,1]
    v_pk_add_f32 v[160:161], v[160:161], v[12:13] op_sel:[0,1] op_sel_hi:[1,1]
    v_pk_add_f32 v[162:163], v[162:163], v[12:13] op_sel:[0,1] op_sel_hi:[1,1]
    v_exp_f32 v152, v152
    v_exp_f32 v153, v153
    v_exp_f32 v154, v154
    v_exp_f32 v155, v155
    v_exp_f32 v156, v156
    v_exp_f32 v157, v157
    v_exp_f32 v158, v158
    v_exp_f32 v159, v159
    v_exp_f32 v160, v160
    v_exp_f32 v161, v161
    v_exp_f32 v162, v162
    v_exp_f32 v163, v163
    v_cvt_pk_bf16_f32 v164, v144, v145
    v_cvt_pk_bf16_f32 v165, v146, v147
    v_mov_b32 v166, 0
    v_mov_b32 v167, 0
    v_cvt_pk_bf16_f32 v168, v152, v153
    v_cvt_pk_bf16_f32 v169, v154, v155
    v_cvt_pk_bf16_f32 v170, v156, v157
    v_cvt_pk_bf16_f32 v171, v158, v159
    v_cvt_pk_bf16_f32 v172, v148, v149
    v_cvt_pk_bf16_f32 v173, v150, v151
    v_cvt_pk_bf16_f32 v174, v160, v161
    v_cvt_pk_bf16_f32 v175, v162, v163
    v_mfma_f32_16x16x32_bf16 v[176:179], v[80:83], v[164:167], 0
    v_add_f32 v12, v144, v145
    v_add_f32 v13, v152, v153
    v_mfma_f32_16x16x32_bf16 v[180:183], v[84:87], v[164:167], 0
    v_add_f32 v12, v12, v146
    v_add_f32 v13, v13, v154
    v_mfma_f32_16x16x32_bf16 v[184:187], v[88:91], v[164:167], 0
    v_add_f32 v12, v12, v147
    v_add_f32 v13, v13, v155
    v_mfma_f32_16x16x32_bf16 v[188:191], v[92:95], v[164:167], 0
    v_add_f32 v12, v12, v148
    v_add_f32 v13, v13, v156
    v_mfma_f32_16x16x32_bf16 v[192:195], v[96:99], v[164:167], 0
    v_add_f32 v12, v12, v149
    v_add_f32 v13, v13, v157
    v_mfma_f32_16x16x32_bf16 v[196:199], v[100:103], v[164:167], 0
    v_add_f32 v12, v12, v150
    v_add_f32 v13, v13, v158
    v_mfma_f32_16x16x32_bf16 v[200:203], v[104:107], v[164:167], 0
    v_add_f32 v12, v12, v151
    v_add_f32 v13, v13, v159
    v_mfma_f32_16x16x32_bf16 v[204:207], v[108:111], v[164:167], 0
    v_add_f32 v13, v13, v160
    v_add_f32 v13, v13, v161
    v_mfma_f32_16x16x32_bf16 v[208:211], v[80:83], v[168:171], 0
    v_add_f32 v13, v13, v162
    v_add_f32 v13, v13, v163
    v_mfma_f32_16x16x32_bf16 v[212:215], v[84:87], v[168:171], 0
    v_mfma_f32_16x16x32_bf16 v[216:219], v[88:91], v[168:171], 0
    v_mfma_f32_16x16x32_bf16 v[220:223], v[92:95], v[168:171], 0
    v_mfma_f32_16x16x32_bf16 v[224:227], v[96:99], v[168:171], 0
    v_mfma_f32_16x16x32_bf16 v[228:231], v[100:103], v[168:171], 0
    v_mfma_f32_16x16x32_bf16 v[232:235], v[104:107], v[168:171], 0
    v_mfma_f32_16x16x32_bf16 v[236:239], v[108:111], v[168:171], 0
    s_waitcnt lgkmcnt(0)
    v_mfma_f32_16x16x16_bf16 v[176:179], v[128:129], v[172:173], v[176:179]
    v_mfma_f32_16x16x16_bf16 v[180:183], v[130:131], v[172:173], v[180:183]
    v_mfma_f32_16x16x16_bf16 v[184:187], v[132:133], v[172:173], v[184:187]
    v_mfma_f32_16x16x16_bf16 v[188:191], v[134:135], v[172:173], v[188:191]
    v_mfma_f32_16x16x16_bf16 v[192:195], v[136:137], v[172:173], v[192:195]
    v_mfma_f32_16x16x16_bf16 v[196:199], v[138:139], v[172:173], v[196:199]
    v_mfma_f32_16x16x16_bf16 v[200:203], v[140:141], v[172:173], v[200:203]
    v_mfma_f32_16x16x16_bf16 v[204:207], v[142:143], v[172:173], v[204:207]
    v_mfma_f32_16x16x16_bf16 v[208:211], v[128:129], v[174:175], v[208:211]
    v_mfma_f32_16x16x16_bf16 v[212:215], v[130:131], v[174:175], v[212:215]
    v_mfma_f32_16x16x16_bf16 v[216:219], v[132:133], v[174:175], v[216:219]
    v_mfma_f32_16x16x16_bf16 v[220:223], v[134:135], v[174:175], v[220:223]
    v_mfma_f32_16x16x16_bf16 v[224:227], v[136:137], v[174:175], v[224:227]
    v_mfma_f32_16x16x16_bf16 v[228:231], v[138:139], v[174:175], v[228:231]
    v_mfma_f32_16x16x16_bf16 v[232:235], v[140:141], v[174:175], v[232:235]
    v_mfma_f32_16x16x16_bf16 v[236:239], v[142:143], v[174:175], v[236:239]
    v_mov_b32 v14, v12
    v_mov_b32 v15, v13
    s_nop 0
    v_permlane32_swap_b32 v12, v14
    v_permlane32_swap_b32 v13, v15
    v_add_f32 v12, v12, v14
    v_add_f32 v13, v13, v15
    v_mov_b32 v14, v12
    v_mov_b32 v15, v13
    s_nop 0
    v_permlane16_swap_b32 v12, v14
    v_permlane16_swap_b32 v13, v15
    v_add_f32 v12, v12, v14
    v_add_f32 v13, v13, v15
    v_rcp_f32 v12, v12
    v_rcp_f32 v13, v13
    s_add_u32 s85, s67, 0x4000000
    s_add_u32 s86, s67, 0x4001000
    v_pk_mul_f32 v[176:177], v[176:177], v[12:13] op_sel:[0,0] op_sel_hi:[1,0]
    v_pk_mul_f32 v[178:179], v[178:179], v[12:13] op_sel:[0,0] op_sel_hi:[1,0]
    v_pk_mul_f32 v[180:181], v[180:181], v[12:13] op_sel:[0,0] op_sel_hi:[1,0]
    v_pk_mul_f32 v[182:183], v[182:183], v[12:13] op_sel:[0,0] op_sel_hi:[1,0]
    v_pk_mul_f32 v[184:185], v[184:185], v[12:13] op_sel:[0,0] op_sel_hi:[1,0]
    v_pk_mul_f32 v[186:187], v[186:187], v[12:13] op_sel:[0,0] op_sel_hi:[1,0]
    v_pk_mul_f32 v[188:189], v[188:189], v[12:13] op_sel:[0,0] op_sel_hi:[1,0]
    v_pk_mul_f32 v[190:191], v[190:191], v[12:13] op_sel:[0,0] op_sel_hi:[1,0]
    v_cvt_pk_bf16_f32 v48, v176, v180
    v_cvt_pk_bf16_f32 v49, v184, v188
    v_cvt_pk_bf16_f32 v50, v177, v181
    v_cvt_pk_bf16_f32 v51, v185, v189
    v_cvt_pk_bf16_f32 v52, v178, v182
    v_cvt_pk_bf16_f32 v53, v186, v190
    v_cvt_pk_bf16_f32 v54, v179, v183
    v_cvt_pk_bf16_f32 v55, v187, v191
    buffer_store_dwordx4 v[48:51], v4, s[8:11], s85 offen offset:0 sc1
    buffer_store_dwordx4 v[52:55], v4, s[8:11], s85 offen offset:1024 sc1
    v_pk_mul_f32 v[192:193], v[192:193], v[12:13] op_sel:[0,0] op_sel_hi:[1,0]
    v_pk_mul_f32 v[194:195], v[194:195], v[12:13] op_sel:[0,0] op_sel_hi:[1,0]
    v_pk_mul_f32 v[196:197], v[196:197], v[12:13] op_sel:[0,0] op_sel_hi:[1,0]
    v_pk_mul_f32 v[198:199], v[198:199], v[12:13] op_sel:[0,0] op_sel_hi:[1,0]
    v_pk_mul_f32 v[200:201], v[200:201], v[12:13] op_sel:[0,0] op_sel_hi:[1,0]
    v_pk_mul_f32 v[202:203], v[202:203], v[12:13] op_sel:[0,0] op_sel_hi:[1,0]
    v_pk_mul_f32 v[204:205], v[204:205], v[12:13] op_sel:[0,0] op_sel_hi:[1,0]
    v_pk_mul_f32 v[206:207], v[206:207], v[12:13] op_sel:[0,0] op_sel_hi:[1,0]
    v_cvt_pk_bf16_f32 v56, v192, v196
    v_cvt_pk_bf16_f32 v57, v200, v204
    v_cvt_pk_bf16_f32 v58, v193, v197
    v_cvt_pk_bf16_f32 v59, v201, v205
    v_cvt_pk_bf16_f32 v60, v194, v198
    v_cvt_pk_bf16_f32 v61, v202, v206
    v_cvt_pk_bf16_f32 v62, v195, v199
    v_cvt_pk_bf16_f32 v63, v203, v207
    buffer_store_dwordx4 v[56:59], v4, s[8:11], s85 offen offset:2048 sc1
    buffer_store_dwordx4 v[60:63], v4, s[8:11], s85 offen offset:3072 sc1
    v_pk_mul_f32 v[208:209], v[208:209], v[12:13] op_sel:[0,1] op_sel_hi:[1,1]
    v_pk_mul_f32 v[210:211], v[210:211], v[12:13] op_sel:[0,1] op_sel_hi:[1,1]
    v_pk_mul_f32 v[212:213], v[212:213], v[12:13] op_sel:[0,1] op_sel_hi:[1,1]
    v_pk_mul_f32 v[214:215], v[214:215], v[12:13] op_sel:[0,1] op_sel_hi:[1,1]
    v_pk_mul_f32 v[216:217], v[216:217], v[12:13] op_sel:[0,1] op_sel_hi:[1,1]
    v_pk_mul_f32 v[218:219], v[218:219], v[12:13] op_sel:[0,1] op_sel_hi:[1,1]
    v_pk_mul_f32 v[220:221], v[220:221], v[12:13] op_sel:[0,1] op_sel_hi:[1,1]
    v_pk_mul_f32 v[222:223], v[222:223], v[12:13] op_sel:[0,1] op_sel_hi:[1,1]
    v_cvt_pk_bf16_f32 v64, v208, v212
    v_cvt_pk_bf16_f32 v65, v216, v220
    v_cvt_pk_bf16_f32 v66, v209, v213
    v_cvt_pk_bf16_f32 v67, v217, v221
    v_cvt_pk_bf16_f32 v68, v210, v214
    v_cvt_pk_bf16_f32 v69, v218, v222
    v_cvt_pk_bf16_f32 v70, v211, v215
    v_cvt_pk_bf16_f32 v71, v219, v223
    buffer_store_dwordx4 v[64:67], v4, s[8:11], s86 offen offset:0 sc1
    buffer_store_dwordx4 v[68:71], v4, s[8:11], s86 offen offset:1024 sc1
    v_pk_mul_f32 v[224:225], v[224:225], v[12:13] op_sel:[0,1] op_sel_hi:[1,1]
    v_pk_mul_f32 v[226:227], v[226:227], v[12:13] op_sel:[0,1] op_sel_hi:[1,1]
    v_pk_mul_f32 v[228:229], v[228:229], v[12:13] op_sel:[0,1] op_sel_hi:[1,1]
    v_pk_mul_f32 v[230:231], v[230:231], v[12:13] op_sel:[0,1] op_sel_hi:[1,1]
    v_pk_mul_f32 v[232:233], v[232:233], v[12:13] op_sel:[0,1] op_sel_hi:[1,1]
    v_pk_mul_f32 v[234:235], v[234:235], v[12:13] op_sel:[0,1] op_sel_hi:[1,1]
    v_pk_mul_f32 v[236:237], v[236:237], v[12:13] op_sel:[0,1] op_sel_hi:[1,1]
    v_pk_mul_f32 v[238:239], v[238:239], v[12:13] op_sel:[0,1] op_sel_hi:[1,1]
    v_cvt_pk_bf16_f32 v72, v224, v228
    v_cvt_pk_bf16_f32 v73, v232, v236
    v_cvt_pk_bf16_f32 v74, v225, v229
    v_cvt_pk_bf16_f32 v75, v233, v237
    v_cvt_pk_bf16_f32 v76, v226, v230
    v_cvt_pk_bf16_f32 v77, v234, v238
    v_cvt_pk_bf16_f32 v78, v227, v231
    v_cvt_pk_bf16_f32 v79, v235, v239
    buffer_store_dwordx4 v[72:75], v4, s[8:11], s86 offen offset:2048 sc1
    buffer_store_dwordx4 v[76:79], v4, s[8:11], s86 offen offset:3072 sc1
    s_add_u32 s71, s71, 1
    s_waitcnt vmcnt(0)
    s_mov_b64 exec, 1
    v_mov_b32 v10, 0
    v_mov_b32 v11, s71
    buffer_store_dword v11, v10, s[8:11], s82 offen sc1
    s_mov_b64 exec, -1
    s_add_u32 s64, s64, 384
    s_cmp_lt_u32 s64, 2048
    s_cbranch_scc1 T1_loop
    s_endpgm
B_fail:
    s_mov_b64 exec, 1
    v_mov_b32 v252, 24
    v_mov_b32 v251, s62
    v_or_b32 v251, 0x20000000, v251
    buffer_store_dword v251, v252, s[12:15], 0 offen sc1
K_exit:
    s_endpgm
K_rec:
    v_and_b32 v95, 63, v0
    v_lshlrev_b32 v3, 4, v95
    v_and_b32 v20, 15, v95
    v_lshrrev_b32 v21, 4, v95
    s_mov_b32 s80, 0xcccccccc
    s_mov_b32 s81, 0xcccccccc
    v_mov_b32 v1, 0x4444
    v_mov_b32 v22, 0xeeee
    v_cndmask_b32 v1, v1, v22, s[80:81]
    s_mov_b32 s84, 0
    s_mov_b32 s85, 0x33333333
    v_mov_b32 v2, 0
    v_mov_b32 v22, 0x7f61b1e6
    v_cndmask_b32 v2, v2, v22, s[84:85]
    s_mov_b32 s30, 0x3e0293ee
    s_mov_b32 s31, 0x3e0293ee
    s_mov_b32 s82, 0xbe0293ee
    s_mov_b32 s95, 0x05040100
    s_mov_b32 s96, 0x07060302
    s_mov_b32 s24, 0xf000f
    s_mov_b32 s25, 0xf000f
    s_mov_b32 s26, 0xf000f0
    s_mov_b32 s27, 0xf000f0
    s_mov_b32 s28, 0xaaaaaaaa
    s_mov_b32 s29, 0xaaaaaaaa
    s_mul_i32 s84, s61, 36864
    s_add_u32 s84, s84, 16384
    v_add_u32 v4, s84, v3
    s_lshl_b32 s84, s61, 10
    s_add_u32 s74, s84, 0x7000000
    s_add_u32 s84, s84, 8192
    v_add_u32 v0, s84, v3
    v_xor_b32 v6, 1024, v0
    v_xor_b32 v14, 2048, v0
    v_xor_b32 v15, 3072, v0
    v_lshlrev_b32 v5, 13, v21
    v_lshrrev_b32 v22, 2, v20
    v_lshl_add_u32 v5, v22, 11, v5
    v_and_b32 v22, 3, v20
    v_lshl_add_u32 v5, v22, 4, v5
    s_lshl_b32 s84, s61, 15
    s_lshl_b32 s85, s62, 6
    s_add_u32 s84, s84, s85
    s_add_u32 s70, s84, 0x7100000
    s_add_u32 s71, s84, 0x7120000
    s_lshl_b32 s88, s62, 1
    s_and_b32 s84, s61, 1
    s_add_u32 s88, s88, s84
    s_lshr_b32 s84, s61, 1
    s_lshl_b32 s84, s84, 6
    s_add_u32 s88, s88, s84
    s_mov_b32 s99, s88
    s_lshl_b32 s84, s88, 11
    s_add_u32 s72, s84, 0x7100000
    s_lshr_b32 s84, s88, 4
    s_lshl_b32 s84, s84, 10
    s_bfe_u32 s85, s88, 0x20002
    s_lshl_b32 s85, s85, 6
    s_add_u32 s84, s84, s85
    s_and_b32 s85, s88, 3
    s_lshl_b32 s85, s85, 8
    s_add_u32 s84, s84, s85
    v_and_b32 v22, 1, v21
    v_lshlrev_b32 v7, 4, v22
    v_bfe_u32 v22, v20, 1, 1
    v_lshl_add_u32 v7, v22, 5, v7
    v_and_b32 v22, 1, v20
    v_lshl_add_u32 v7, v22, 3, v7
    v_add_u32 v7, s84, v7
    v_and_b32 v22, 1, v20
    v_lshlrev_b32 v8, 11, v22
    v_lshrrev_b32 v22, 1, v21
    v_lshl_add_u32 v8, v22, 8, v8
    v_lshrrev_b32 v22, 1, v20
    v_lshl_add_u32 v8, v22, 4, v8
    v_and_b32 v22, 1, v21
    v_lshlrev_b32 v22, 2, v22
    v_sub_u32 v8, v8, v22
    s_lshr_b32 s84, s61, 1
    s_lshl_b32 s84, s84, 12
    s_and_b32 s85, s61, 1
    s_lshl_b32 s85, s85, 7
    s_add_u32 s84, s84, s85
    s_add_u32 s84, s84, 4
    v_add_u32 v8, s84, v8
    v_and_b32 v22, 1, v21
    v_lshlrev_b32 v9, 10, v22
    v_lshrrev_b32 v22, 1, v21
    v_lshl_add_u32 v9, v22, 8, v9
    v_lshl_add_u32 v9, v20, 4, v9
    s_lshl_b32 s92, s61, 11
    v_add_u32 v9, s92, v9
    s_add_u32 s92, s92, 0
    s_add_u32 s93, s92, 512
    s_mov_b32 s85, 256
    v_lshrrev_b32 v22, 2, v20
    v_mul_lo_u32 v10, v22, s85
    v_lshl_add_u32 v10, v21, 5, v10
    v_and_b32 v22, 3, v20
    v_lshl_add_u32 v10, v22, 2, v10
    s_mul_i32 s84, s61, 1024
    s_add_u32 s84, s84, 8192
    v_add_u32 v10, s84, v10
    v_bfe_u32 v22, v20, 2, 1
    v_mul_u32_u24 v22, 192, v22
    v_xor_b32 v10, v22, v10
    v_mul_lo_u32 v12, v21, s85
    v_lshrrev_b32 v22, 2, v20
    v_lshlrev_b32 v22, 5, v22
    v_and_b32 v23, 1, v20
    v_lshl_add_u32 v22, v23, 4, v22
    v_add_u32 v11, v12, v22
    v_add_u32 v11, 8192, v11
    v_and_b32 v22, 7, v20
    v_lshl_add_u32 v12, v22, 4, v12
    v_add_u32 v12, 8320, v12
    v_and_b32 v22, 1, v21
    v_mul_u32_u24 v22, 192, v22
    v_xor_b32 v11, v22, v11
    v_xor_b32 v12, v22, v12
    v_lshrrev_b32 v22, 3, v20
    v_lshlrev_b32 v13, 8, v22
    v_lshl_add_u32 v13, v21, 6, v13
    v_bfe_u32 v22, v20, 2, 1
    v_lshl_add_u32 v13, v22, 5, v13
    v_and_b32 v22, 3, v20
    v_lshl_add_u32 v13, v22, 2, v13
    s_lshl_b32 s84, s61, 9
    s_add_u32 s84, s84, 13312
    v_add_u32 v13, s84, v13
    v_lshrrev_b32 v16, 1, v95
    v_lshlrev_b32 v16, 7, v16
    s_lshl_b32 s84, s62, 13
    s_and_b32 s85, s61, 1
    s_lshl_b32 s85, s85, 12
    s_add_u32 s84, s84, s85
    s_lshr_b32 s85, s61, 1
    s_mul_i32 s85, s85, 0x2000000
    s_add_u32 s84, s84, s85
    v_add_u32 v16, s84, v16
    s_lshl_b32 s84, s62, 13
    s_add_u32 s75, s84, 0x1000000
    s_add_u32 s76, s84, 0x2fffffc
    s_lshl_b32 s84, s62, 12
    s_lshl_b32 s85, s61, 10
    s_add_u32 s84, s84, s85
    s_add_u32 s69, s84, 0x6800000
    s_lshl_b32 s84, s62, 9
    s_lshl_b32 s85, s61, 7
    s_add_u32 s84, s84, s85
    s_add_u32 s94, s84, 0x7208000
    s_mov_b32 s97, 0x1080000
    v_mov_b32 v56, -1
    v_mov_b32 v57, -1
    v_mov_b32 v58, -1
    v_mov_b32 v59, -1
    buffer_store_dwordx4 v[56:59], v3, s[8:11], s72 offen offset:0 sc1
    buffer_store_dwordx4 v[56:59], v3, s[8:11], s72 offen offset:1024 sc1
    s_mov_b32 s84, 0x7002000
    buffer_store_dwordx2 v[56:57], v7, s[8:11], s84 offen sc1
    s_mov_b32 s84, 0x7004000
    buffer_store_dwordx2 v[56:57], v7, s[8:11], s84 offen sc1
    s_mov_b32 s84, 0x7006000
    buffer_store_dwordx2 v[56:57], v7, s[8:11], s84 offen sc1
    s_mov_b32 s16, s34
    s_and_b32 s17, s35, 0xffff
    s_mov_b32 s18, 0x2000
    s_mov_b32 s19, 0x20000
    v_and_b32 v22, 1, v21
    v_lshlrev_b32 v22, 10, v22
    v_and_b32 v23, 3, v20
    v_lshl_add_u32 v22, v23, 3, v22
    s_and_b32 s84, s99, 3
    s_lshl_b32 s84, s84, 5
    v_add_u32 v22, s84, v22
    s_bfe_u32 s84, s99, 0x20002
    s_lshl_b32 s84, s84, 11
    s_lshr_b32 s85, s99, 4
    s_lshl_b32 s85, s85, 7
    s_add_u32 s84, s84, s85
    buffer_load_dwordx2 v[18:19], v22, s[16:19], s84 offen
    v_lshrrev_b32 v93, 1, v21
    v_lshlrev_b32 v93, 4, v93
    v_and_b32 v94, 1, v21
    v_lshl_add_u32 v93, v94, 2, v93
    v_lshlrev_b32 v94, 10, v93
    v_lshl_add_u32 v94, v20, 3, v94
    v_lshlrev_b32 v93, 8, v93
    v_lshl_add_u32 v93, v20, 2, v93
    s_xor_b32 s84, s61, 0
    s_lshl_b32 s84, s84, 14
    s_lshl_b32 s85, s61, 6
    s_add_u32 s84, s84, s85
    s_add_u32 s84, s84, 16384
    v_add_u32 v88, s84, v93
    s_xor_b32 s84, s61, 1
    s_lshl_b32 s84, s84, 14
    s_lshl_b32 s85, s61, 6
    s_add_u32 s84, s84, s85
    s_add_u32 s84, s84, 16384
    v_add_u32 v89, s84, v93
    s_xor_b32 s84, s61, 2
    s_lshl_b32 s84, s84, 14
    s_lshl_b32 s85, s61, 6
    s_add_u32 s84, s84, s85
    s_add_u32 s84, s84, 16384
    v_add_u32 v90, s84, v93
    s_xor_b32 s84, s61, 3
    s_lshl_b32 s84, s84, 14
    s_lshl_b32 s85, s61, 6
    s_add_u32 s84, s84, s85
    s_add_u32 s84, s84, 16384
    v_add_u32 v91, s84, v93
    v_lshlrev_b32 v92, 13, v21
    v_lshl_add_u32 v92, v20, 4, v92
    s_lshl_b32 s86, s62, 8
    s_lshl_b32 s84, s61, 19
    s_add_u32 s86, s86, s84
    s_lshl_b32 s87, s61, 14
    s_add_u32 s87, s87, 16384
    s_lshl_b32 s90, s62, 17
    s_lshl_b32 s84, s61, 7
    s_add_u32 s90, s90, s84
    s_mov_b32 s16, s38
    s_and_b32 s17, s39, 0xffff
    s_mov_b32 s18, 0x400000
    s_mov_b32 s19, 0x20000
    s_add_u32 m0, s87, 0
    s_add_u32 s84, s86, 0
    buffer_load_dwordx4 v92, s[16:19], s84 offen lds
    s_add_u32 m0, s87, 1024
    s_add_u32 s84, s86, 32768
    buffer_load_dwordx4 v92, s[16:19], s84 offen lds
    s_add_u32 m0, s87, 2048
    s_add_u32 s84, s86, 65536
    buffer_load_dwordx4 v92, s[16:19], s84 offen lds
    s_add_u32 m0, s87, 3072
    s_add_u32 s84, s86, 98304
    buffer_load_dwordx4 v92, s[16:19], s84 offen lds
    s_add_u32 m0, s87, 4096
    s_add_u32 s84, s86, 131072
    buffer_load_dwordx4 v92, s[16:19], s84 offen lds
    s_add_u32 m0, s87, 5120
    s_add_u32 s84, s86, 163840
    buffer_load_dwordx4 v92, s[16:19], s84 offen lds
    s_add_u32 m0, s87, 6144
    s_add_u32 s84, s86, 196608
    buffer_load_dwordx4 v92, s[16:19], s84 offen lds
    s_add_u32 m0, s87, 7168
    s_add_u32 s84, s86, 229376
    buffer_load_dwordx4 v92, s[16:19], s84 offen lds
    s_add_u32 m0, s87, 8192
    s_add_u32 s84, s86, 262144
    buffer_load_dwordx4 v92, s[16:19], s84 offen lds
    s_add_u32 m0, s87, 9216
    s_add_u32 s84, s86, 294912
    buffer_load_dwordx4 v92, s[16:19], s84 offen lds
    s_add_u32 m0, s87, 10240
    s_add_u32 s84, s86, 327680
    buffer_load_dwordx4 v92, s[16:19], s84 offen lds
    s_add_u32 m0, s87, 11264
    s_add_u32 s84, s86, 360448
    buffer_load_dwordx4 v92, s[16:19], s84 offen lds
    s_add_u32 m0, s87, 12288
    s_add_u32 s84, s86, 393216
    buffer_load_dwordx4 v92, s[16:19], s84 offen lds
    s_add_u32 m0, s87, 13312
    s_add_u32 s84, s86, 425984
    buffer_load_dwordx4 v92, s[16:19], s84 offen lds
    s_add_u32 m0, s87, 14336
    s_add_u32 s84, s86, 458752
    buffer_load_dwordx4 v92, s[16:19], s84 offen lds
    s_add_u32 m0, s87, 15360
    s_add_u32 s84, s86, 491520
    buffer_load_dwordx4 v92, s[16:19], s84 offen lds
    s_add_u32 m0, s87, 65536
    s_add_u32 s84, s86, 2097152
    buffer_load_dwordx4 v92, s[16:19], s84 offen lds
    s_add_u32 m0, s87, 66560
    s_add_u32 s84, s86, 2129920
    buffer_load_dwordx4 v92, s[16:19], s84 offen lds
    s_add_u32 m0, s87, 67584
    s_add_u32 s84, s86, 2162688
    buffer_load_dwordx4 v92, s[16:19], s84 offen lds
    s_add_u32 m0, s87, 68608
    s_add_u32 s84, s86, 2195456
    buffer_load_dwordx4 v92, s[16:19], s84 offen lds
    s_add_u32 m0, s87, 69632
    s_add_u32 s84, s86, 2228224
    buffer_load_dwordx4 v92, s[16:19], s84 offen lds
    s_add_u32 m0, s87, 70656
    s_add_u32 s84, s86, 2260992
    buffer_load_dwordx4 v92, s[16:19], s84 offen lds
    s_add_u32 m0, s87, 71680
    s_add_u32 s84, s86, 2293760
    buffer_load_dwordx4 v92, s[16:19], s84 offen lds
    s_add_u32 m0, s87, 72704
    s_add_u32 s84, s86, 2326528
    buffer_load_dwordx4 v92, s[16:19], s84 offen lds
    s_add_u32 m0, s87, 73728
    s_add_u32 s84, s86, 2359296
    buffer_load_dwordx4 v92, s[16:19], s84 offen lds
    s_add_u32 m0, s87, 74752
    s_add_u32 s84, s86, 2392064
    buffer_load_dwordx4 v92, s[16:19], s84 offen lds
    s_add_u32 m0, s87, 75776
    s_add_u32 s84, s86, 2424832
    buffer_load_dwordx4 v92, s[16:19], s84 offen lds
    s_add_u32 m0, s87, 76800
    s_add_u32 s84, s86, 2457600
    buffer_load_dwordx4 v92, s[16:19], s84 offen lds
    s_add_u32 m0, s87, 77824
    s_add_u32 s84, s86, 2490368
    buffer_load_dwordx4 v92, s[16:19], s84 offen lds
    s_add_u32 m0, s87, 78848
    s_add_u32 s84, s86, 2523136
    buffer_load_dwordx4 v92, s[16:19], s84 offen lds
    s_add_u32 m0, s87, 79872
    s_add_u32 s84, s86, 2555904
    buffer_load_dwordx4 v92, s[16:19], s84 offen lds
    s_add_u32 m0, s87, 80896
    s_add_u32 s84, s86, 2588672
    buffer_load_dwordx4 v92, s[16:19], s84 offen lds
    s_waitcnt vmcnt(16)
    s_barrier
    v_min_u32 v18, -2, v18
    s_mov_b32 s84, 0x7000000
    buffer_store_dwordx2 v[18:19], v7, s[8:11], s84 offen sc1
    ds_read2st64_b32 v[40:41], v88 offset0:0 offset1:1
    ds_read2st64_b32 v[42:43], v88 offset0:8 offset1:9
    ds_read2st64_b32 v[44:45], v88 offset0:2 offset1:3
    ds_read2st64_b32 v[46:47], v88 offset0:10 offset1:11
    ds_read2st64_b32 v[48:49], v88 offset0:32 offset1:33
    ds_read2st64_b32 v[50:51], v88 offset0:40 offset1:41
    ds_read2st64_b32 v[52:53], v88 offset0:34 offset1:35
    ds_read2st64_b32 v[54:55], v88 offset0:42 offset1:43
    ds_read2st64_b32 v[56:57], v89 offset0:0 offset1:1
    ds_read2st64_b32 v[58:59], v89 offset0:8 offset1:9
    ds_read2st64_b32 v[60:61], v89 offset0:2 offset1:3
    ds_read2st64_b32 v[62:63], v89 offset0:10 offset1:11
    ds_read2st64_b32 v[64:65], v89 offset0:32 offset1:33
    ds_read2st64_b32 v[66:67], v89 offset0:40 offset1:41
    ds_read2st64_b32 v[68:69], v89 offset0:34 offset1:35
    ds_read2st64_b32 v[70:71], v89 offset0:42 offset1:43
    s_waitcnt lgkmcnt(8)
    v_perm_b32 v112, v41, v40, s95
    v_perm_b32 v113, v43, v42, s95
    v_perm_b32 v114, v45, v44, s95
    v_perm_b32 v115, v47, v46, s95
    v_perm_b32 v116, v49, v48, s95
    v_perm_b32 v117, v51, v50, s95
    v_perm_b32 v118, v53, v52, s95
    v_perm_b32 v119, v55, v54, s95
    v_perm_b32 v120, v41, v40, s96
    v_perm_b32 v121, v43, v42, s96
    v_perm_b32 v122, v45, v44, s96
    v_perm_b32 v123, v47, v46, s96
    v_perm_b32 v124, v49, v48, s96
    v_perm_b32 v125, v51, v50, s96
    v_perm_b32 v126, v53, v52, s96
    v_perm_b32 v127, v55, v54, s96
    ds_read2st64_b32 v[40:41], v90 offset0:0 offset1:1
    ds_read2st64_b32 v[42:43], v90 offset0:8 offset1:9
    ds_read2st64_b32 v[44:45], v90 offset0:2 offset1:3
    ds_read2st64_b32 v[46:47], v90 offset0:10 offset1:11
    ds_read2st64_b32 v[48:49], v90 offset0:32 offset1:33
    ds_read2st64_b32 v[50:51], v90 offset0:40 offset1:41
    ds_read2st64_b32 v[52:53], v90 offset0:34 offset1:35
    ds_read2st64_b32 v[54:55], v90 offset0:42 offset1:43
    s_waitcnt lgkmcnt(8)
    v_perm_b32 v24, v57, v56, s95
    v_perm_b32 v25, v59, v58, s95
    v_perm_b32 v26, v61, v60, s95
    v_perm_b32 v27, v63, v62, s95
    v_perm_b32 v28, v65, v64, s95
    v_perm_b32 v29, v67, v66, s95
    v_perm_b32 v30, v69, v68, s95
    v_perm_b32 v31, v71, v70, s95
    v_accvgpr_write_b32 a0, v24
    v_accvgpr_write_b32 a1, v25
    v_accvgpr_write_b32 a2, v26
    v_accvgpr_write_b32 a3, v27
    v_accvgpr_write_b32 a4, v28
    v_accvgpr_write_b32 a5, v29
    v_accvgpr_write_b32 a6, v30
    v_accvgpr_write_b32 a7, v31
    v_perm_b32 v32, v57, v56, s96
    v_perm_b32 v33, v59, v58, s96
    v_perm_b32 v34, v61, v60, s96
    v_perm_b32 v35, v63, v62, s96
    v_perm_b32 v36, v65, v64, s96
    v_perm_b32 v37, v67, v66, s96
    v_perm_b32 v38, v69, v68, s96
    v_perm_b32 v39, v71, v70, s96
    v_accvgpr_write_b32 a8, v32
    v_accvgpr_write_b32 a9, v33
    v_accvgpr_write_b32 a10, v34
    v_accvgpr_write_b32 a11, v35
    v_accvgpr_write_b32 a12, v36
    v_accvgpr_write_b32 a13, v37
    v_accvgpr_write_b32 a14, v38
    v_accvgpr_write_b32 a15, v39
    ds_read2st64_b32 v[56:57], v91 offset0:0 offset1:1
    ds_read2st64_b32 v[58:59], v91 offset0:8 offset1:9
    ds_read2st64_b32 v[60:61], v91 offset0:2 offset1:3
    ds_read2st64_b32 v[62:63], v91 offset0:10 offset1:11
    ds_read2st64_b32 v[64:65], v91 offset0:32 offset1:33
    ds_read2st64_b32 v[66:67], v91 offset0:40 offset1:41
    ds_read2st64_b32 v[68:69], v91 offset0:34 offset1:35
    ds_read2st64_b32 v[70:71], v91 offset0:42 offset1:43
    s_waitcnt lgkmcnt(8)
    v_perm_b32 v24, v41, v40, s95
    v_perm_b32 v25, v43, v42, s95
    v_perm_b32 v26, v45, v44, s95
    v_perm_b32 v27, v47, v46, s95
    v_perm_b32 v28, v49, v48, s95
    v_perm_b32 v29, v51, v50, s95
    v_perm_b32 v30, v53, v52, s95
    v_perm_b32 v31, v55, v54, s95
    v_accvgpr_write_b32 a16, v24
    v_accvgpr_write_b32 a17, v25
    v_accvgpr_write_b32 a18, v26
    v_accvgpr_write_b32 a19, v27
    v_accvgpr_write_b32 a20, v28
    v_accvgpr_write_b32 a21, v29
    v_accvgpr_write_b32 a22, v30
    v_accvgpr_write_b32 a23, v31
    v_perm_b32 v32, v41, v40, s96
    v_perm_b32 v33, v43, v42, s96
    v_perm_b32 v34, v45, v44, s96
    v_perm_b32 v35, v47, v46, s96
    v_perm_b32 v36, v49, v48, s96
    v_perm_b32 v37, v51, v50, s96
    v_perm_b32 v38, v53, v52, s96
    v_perm_b32 v39, v55, v54, s96
    v_accvgpr_write_b32 a24, v32
    v_accvgpr_write_b32 a25, v33
    v_accvgpr_write_b32 a26, v34
    v_accvgpr_write_b32 a27, v35
    v_accvgpr_write_b32 a28, v36
    v_accvgpr_write_b32 a29, v37
    v_accvgpr_write_b32 a30, v38
    v_accvgpr_write_b32 a31, v39
    s_waitcnt lgkmcnt(0)
    v_perm_b32 v24, v57, v56, s95
    v_perm_b32 v25, v59, v58, s95
    v_perm_b32 v26, v61, v60, s95
    v_perm_b32 v27, v63, v62, s95
    v_perm_b32 v28, v65, v64, s95
    v_perm_b32 v29, v67, v66, s95
    v_perm_b32 v30, v69, v68, s95
    v_perm_b32 v31, v71, v70, s95
    v_accvgpr_write_b32 a32, v24
    v_accvgpr_write_b32 a33, v25
    v_accvgpr_write_b32 a34, v26
    v_accvgpr_write_b32 a35, v27
    v_accvgpr_write_b32 a36, v28
    v_accvgpr_write_b32 a37, v29
    v_accvgpr_write_b32 a38, v30
    v_accvgpr_write_b32 a39, v31
    v_perm_b32 v32, v57, v56, s96
    v_perm_b32 v33, v59, v58, s96
    v_perm_b32 v34, v61, v60, s96
    v_perm_b32 v35, v63, v62, s96
    v_perm_b32 v36, v65, v64, s96
    v_perm_b32 v37, v67, v66, s96
    v_perm_b32 v38, v69, v68, s96
    v_perm_b32 v39, v71, v70, s96
    v_accvgpr_write_b32 a40, v32
    v_accvgpr_write_b32 a41, v33
    v_accvgpr_write_b32 a42, v34
    v_accvgpr_write_b32 a43, v35
    v_accvgpr_write_b32 a44, v36
    v_accvgpr_write_b32 a45, v37
    v_accvgpr_write_b32 a46, v38
    v_accvgpr_write_b32 a47, v39
    v_add_u32 v88, 65536, v88
    v_add_u32 v89, 65536, v89
    v_add_u32 v90, 65536, v90
    v_add_u32 v91, 65536, v91
    s_barrier
    s_mov_b32 s20, s40
    s_and_b32 s21, s41, 0xffff
    s_mov_b32 s22, 0x400000
    s_mov_b32 s23, 0x20000
    s_add_u32 m0, s87, 0
    s_add_u32 s84, s86, 0
    buffer_load_dwordx4 v92, s[20:23], s84 offen lds
    s_add_u32 m0, s87, 1024
    s_add_u32 s84, s86, 32768
    buffer_load_dwordx4 v92, s[20:23], s84 offen lds
    s_add_u32 m0, s87, 2048
    s_add_u32 s84, s86, 65536
    buffer_load_dwordx4 v92, s[20:23], s84 offen lds
    s_add_u32 m0, s87, 3072
    s_add_u32 s84, s86, 98304
    buffer_load_dwordx4 v92, s[20:23], s84 offen lds
    s_add_u32 m0, s87, 4096
    s_add_u32 s84, s86, 131072
    buffer_load_dwordx4 v92, s[20:23], s84 offen lds
    s_add_u32 m0, s87, 5120
    s_add_u32 s84, s86, 163840
    buffer_load_dwordx4 v92, s[20:23], s84 offen lds
    s_add_u32 m0, s87, 6144
    s_add_u32 s84, s86, 196608
    buffer_load_dwordx4 v92, s[20:23], s84 offen lds
    s_add_u32 m0, s87, 7168
    s_add_u32 s84, s86, 229376
    buffer_load_dwordx4 v92, s[20:23], s84 offen lds
    s_add_u32 m0, s87, 8192
    s_add_u32 s84, s86, 262144
    buffer_load_dwordx4 v92, s[20:23], s84 offen lds
    s_add_u32 m0, s87, 9216
    s_add_u32 s84, s86, 294912
    buffer_load_dwordx4 v92, s[20:23], s84 offen lds
    s_add_u32 m0, s87, 10240
    s_add_u32 s84, s86, 327680
    buffer_load_dwordx4 v92, s[20:23], s84 offen lds
    s_add_u32 m0, s87, 11264
    s_add_u32 s84, s86, 360448
    buffer_load_dwordx4 v92, s[20:23], s84 offen lds
    s_add_u32 m0, s87, 12288
    s_add_u32 s84, s86, 393216
    buffer_load_dwordx4 v92, s[20:23], s84 offen lds
    s_add_u32 m0, s87, 13312
    s_add_u32 s84, s86, 425984
    buffer_load_dwordx4 v92, s[20:23], s84 offen lds
    s_add_u32 m0, s87, 14336
    s_add_u32 s84, s86, 458752
    buffer_load_dwordx4 v92, s[20:23], s84 offen lds
    s_add_u32 m0, s87, 15360
    s_add_u32 s84, s86, 491520
    buffer_load_dwordx4 v92, s[20:23], s84 offen lds
    s_waitcnt vmcnt(17)
    s_barrier
    ds_read2st64_b32 v[40:41], v88 offset0:0 offset1:1
    ds_read2st64_b32 v[42:43], v88 offset0:8 offset1:9
    ds_read2st64_b32 v[44:45], v88 offset0:2 offset1:3
    ds_read2st64_b32 v[46:47], v88 offset0:10 offset1:11
    ds_read2st64_b32 v[48:49], v88 offset0:32 offset1:33
    ds_read2st64_b32 v[50:51], v88 offset0:40 offset1:41
    ds_read2st64_b32 v[52:53], v88 offset0:34 offset1:35
    ds_read2st64_b32 v[54:55], v88 offset0:42 offset1:43
    ds_read2st64_b32 v[56:57], v89 offset0:0 offset1:1
    ds_read2st64_b32 v[58:59], v89 offset0:8 offset1:9
    ds_read2st64_b32 v[60:61], v89 offset0:2 offset1:3
    ds_read2st64_b32 v[62:63], v89 offset0:10 offset1:11
    ds_read2st64_b32 v[64:65], v89 offset0:32 offset1:33
    ds_read2st64_b32 v[66:67], v89 offset0:40 offset1:41
    ds_read2st64_b32 v[68:69], v89 offset0:34 offset1:35
    ds_read2st64_b32 v[70:71], v89 offset0:42 offset1:43
    s_waitcnt lgkmcnt(8)
    v_perm_b32 v24, v41, v40, s95
    v_perm_b32 v25, v43, v42, s95
    v_perm_b32 v26, v45, v44, s95
    v_perm_b32 v27, v47, v46, s95
    v_perm_b32 v28, v49, v48, s95
    v_perm_b32 v29, v51, v50, s95
    v_perm_b32 v30, v53, v52, s95
    v_perm_b32 v31, v55, v54, s95
    v_accvgpr_write_b32 a48, v24
    v_accvgpr_write_b32 a49, v25
    v_accvgpr_write_b32 a50, v26
    v_accvgpr_write_b32 a51, v27
    v_accvgpr_write_b32 a52, v28
    v_accvgpr_write_b32 a53, v29
    v_accvgpr_write_b32 a54, v30
    v_accvgpr_write_b32 a55, v31
    v_perm_b32 v32, v41, v40, s96
    v_perm_b32 v33, v43, v42, s96
    v_perm_b32 v34, v45, v44, s96
    v_perm_b32 v35, v47, v46, s96
    v_perm_b32 v36, v49, v48, s96
    v_perm_b32 v37, v51, v50, s96
    v_perm_b32 v38, v53, v52, s96
    v_perm_b32 v39, v55, v54, s96
    v_accvgpr_write_b32 a56, v32
    v_accvgpr_write_b32 a57, v33
    v_accvgpr_write_b32 a58, v34
    v_accvgpr_write_b32 a59, v35
    v_accvgpr_write_b32 a60, v36
    v_accvgpr_write_b32 a61, v37
    v_accvgpr_write_b32 a62, v38
    v_accvgpr_write_b32 a63, v39
    ds_read2st64_b32 v[40:41], v90 offset0:0 offset1:1
    ds_read2st64_b32 v[42:43], v90 offset0:8 offset1:9
    ds_read2st64_b32 v[44:45], v90 offset0:2 offset1:3
    ds_read2st64_b32 v[46:47], v90 offset0:10 offset1:11
    ds_read2st64_b32 v[48:49], v90 offset0:32 offset1:33
    ds_read2st64_b32 v[50:51], v90 offset0:40 offset1:41
    ds_read2st64_b32 v[52:53], v90 offset0:34 offset1:35
    ds_read2st64_b32 v[54:55], v90 offset0:42 offset1:43
    s_waitcnt lgkmcnt(8)
    v_perm_b32 v24, v57, v56, s95
    v_perm_b32 v25, v59, v58, s95
    v_perm_b32 v26, v61, v60, s95
    v_perm_b32 v27, v63, v62, s95
    v_perm_b32 v28, v65, v64, s95
    v_perm_b32 v29, v67, v66, s95
    v_perm_b32 v30, v69, v68, s95
    v_perm_b32 v31, v71, v70, s95
    v_accvgpr_write_b32 a64, v24
    v_accvgpr_write_b32 a65, v25
    v_accvgpr_write_b32 a66, v26
    v_accvgpr_write_b32 a67, v27
    v_accvgpr_write_b32 a68, v28
    v_accvgpr_write_b32 a69, v29
    v_accvgpr_write_b32 a70, v30
    v_accvgpr_write_b32 a71, v31
    v_perm_b32 v32, v57, v56, s96
    v_perm_b32 v33, v59, v58, s96
    v_perm_b32 v34, v61, v60, s96
    v_perm_b32 v35, v63, v62, s96
    v_perm_b32 v36, v65, v64, s96
    v_perm_b32 v37, v67, v66, s96
    v_perm_b32 v38, v69, v68, s96
    v_perm_b32 v39, v71, v70, s96
    v_accvgpr_write_b32 a72, v32
    v_accvgpr_write_b32 a73, v33
    v_accvgpr_write_b32 a74, v34
    v_accvgpr_write_b32 a75, v35
    v_accvgpr_write_b32 a76, v36
    v_accvgpr_write_b32 a77, v37
    v_accvgpr_write_b32 a78, v38
    v_accvgpr_write_b32 a79, v39
    ds_read2st64_b32 v[56:57], v91 offset0:0 offset1:1
    ds_read2st64_b32 v[58:59], v91 offset0:8 offset1:9
    ds_read2st64_b32 v[60:61], v91 offset0:2 offset1:3
    ds_read2st64_b32 v[62:63], v91 offset0:10 offset1:11
    ds_read2st64_b32 v[64:65], v91 offset0:32 offset1:33
    ds_read2st64_b32 v[66:67], v91 offset0:40 offset1:41
    ds_read2st64_b32 v[68:69], v91 offset0:34 offset1:35
    ds_read2st64_b32 v[70:71], v91 offset0:42 offset1:43
    s_waitcnt lgkmcnt(8)
    v_perm_b32 v24, v41, v40, s95
    v_perm_b32 v25, v43, v42, s95
    v_perm_b32 v26, v45, v44, s95
    v_perm_b32 v27, v47, v46, s95
    v_perm_b32 v28, v49, v48, s95
    v_perm_b32 v29, v51, v50, s95
    v_perm_b32 v30, v53, v52, s95
    v_perm_b32 v31, v55, v54, s95
    v_accvgpr_write_b32 a80, v24
    v_accvgpr_write_b32 a81, v25
    v_accvgpr_write_b32 a82, v26
    v_accvgpr_write_b32 a83, v27
    v_accvgpr_write_b32 a84, v28
    v_accvgpr_write_b32 a85, v29
    v_accvgpr_write_b32 a86, v30
    v_accvgpr_write_b32 a87, v31
    v_perm_b32 v32, v41, v40, s96
    v_perm_b32 v33, v43, v42, s96
    v_perm_b32 v34, v45, v44, s96
    v_perm_b32 v35, v47, v46, s96
    v_perm_b32 v36, v49, v48, s96
    v_perm_b32 v37, v51, v50, s96
    v_perm_b32 v38, v53, v52, s96
    v_perm_b32 v39, v55, v54, s96
    v_accvgpr_write_b32 a88, v32
    v_accvgpr_write_b32 a89, v33
    v_accvgpr_write_b32 a90, v34
    v_accvgpr_write_b32 a91, v35
    v_accvgpr_write_b32 a92, v36
    v_accvgpr_write_b32 a93, v37
    v_accvgpr_write_b32 a94, v38
    v_accvgpr_write_b32 a95, v39
    s_waitcnt lgkmcnt(0)
    v_perm_b32 v24, v57, v56, s95
    v_perm_b32 v25, v59, v58, s95
    v_perm_b32 v26, v61, v60, s95
    v_perm_b32 v27, v63, v62, s95
    v_perm_b32 v28, v65, v64, s95
    v_perm_b32 v29, v67, v66, s95
    v_perm_b32 v30, v69, v68, s95
    v_perm_b32 v31, v71, v70, s95
    v_accvgpr_write_b32 a96, v24
    v_accvgpr_write_b32 a97, v25
    v_accvgpr_write_b32 a98, v26
    v_accvgpr_write_b32 a99, v27
    v_accvgpr_write_b32 a100, v28
    v_accvgpr_write_b32 a101, v29
    v_accvgpr_write_b32 a102, v30
    v_accvgpr_write_b32 a103, v31
    v_perm_b32 v32, v57, v56, s96
    v_perm_b32 v33, v59, v58, s96
    v_perm_b32 v34, v61, v60, s96
    v_perm_b32 v35, v63, v62, s96
    v_perm_b32 v36, v65, v64, s96
    v_perm_b32 v37, v67, v66, s96
    v_perm_b32 v38, v69, v68, s96
    v_perm_b32 v39, v71, v70, s96
    v_accvgpr_write_b32 a104, v32
    v_accvgpr_write_b32 a105, v33
    v_accvgpr_write_b32 a106, v34
    v_accvgpr_write_b32 a107, v35
    v_accvgpr_write_b32 a108, v36
    v_accvgpr_write_b32 a109, v37
    v_accvgpr_write_b32 a110, v38
    v_accvgpr_write_b32 a111, v39
    v_subrev_u32 v88, 65536, v88
    v_subrev_u32 v89, 65536, v89
    v_subrev_u32 v90, 65536, v90
    v_subrev_u32 v91, 65536, v91
    s_barrier
    s_add_u32 m0, s87, 65536
    s_add_u32 s84, s86, 2097152
    buffer_load_dwordx4 v92, s[20:23], s84 offen lds
    s_add_u32 m0, s87, 66560
    s_add_u32 s84, s86, 2129920
    buffer_load_dwordx4 v92, s[20:23], s84 offen lds
    s_add_u32 m0, s87, 67584
    s_add_u32 s84, s86, 2162688
    buffer_load_dwordx4 v92, s[20:23], s84 offen lds
    s_add_u32 m0, s87, 68608
    s_add_u32 s84, s86, 2195456
    buffer_load_dwordx4 v92, s[20:23], s84 offen lds
    s_add_u32 m0, s87, 69632
    s_add_u32 s84, s86, 2228224
    buffer_load_dwordx4 v92, s[20:23], s84 offen lds
    s_add_u32 m0, s87, 70656
    s_add_u32 s84, s86, 2260992
    buffer_load_dwordx4 v92, s[20:23], s84 offen lds
    s_add_u32 m0, s87, 71680
    s_add_u32 s84, s86, 2293760
    buffer_load_dwordx4 v92, s[20:23], s84 offen lds
    s_add_u32 m0, s87, 72704
    s_add_u32 s84, s86, 2326528
    buffer_load_dwordx4 v92, s[20:23], s84 offen lds
    s_add_u32 m0, s87, 73728
    s_add_u32 s84, s86, 2359296
    buffer_load_dwordx4 v92, s[20:23], s84 offen lds
    s_add_u32 m0, s87, 74752
    s_add_u32 s84, s86, 2392064
    buffer_load_dwordx4 v92, s[20:23], s84 offen lds
    s_add_u32 m0, s87, 75776
    s_add_u32 s84, s86, 2424832
    buffer_load_dwordx4 v92, s[20:23], s84 offen lds
    s_add_u32 m0, s87, 76800
    s_add_u32 s84, s86, 2457600
    buffer_load_dwordx4 v92, s[20:23], s84 offen lds
    s_add_u32 m0, s87, 77824
    s_add_u32 s84, s86, 2490368
    buffer_load_dwordx4 v92, s[20:23], s84 offen lds
    s_add_u32 m0, s87, 78848
    s_add_u32 s84, s86, 2523136
    buffer_load_dwordx4 v92, s[20:23], s84 offen lds
    s_add_u32 m0, s87, 79872
    s_add_u32 s84, s86, 2555904
    buffer_load_dwordx4 v92, s[20:23], s84 offen lds
    s_add_u32 m0, s87, 80896
    s_add_u32 s84, s86, 2588672
    buffer_load_dwordx4 v92, s[20:23], s84 offen lds
    s_waitcnt vmcnt(16)
    s_barrier
    s_cmp_lg_u32 s61, 0
    s_cbranch_scc1 R_sig_35
    s_mov_b64 exec, 1
    v_mov_b32 v80, 1
    v_mov_b32 v81, 12
    buffer_atomic_add v80, v81, s[12:15], 0 offen
    s_mov_b64 exec, -1
R_sig_35:
    ds_read2st64_b32 v[40:41], v88 offset0:0 offset1:1
    ds_read2st64_b32 v[42:43], v88 offset0:8 offset1:9
    ds_read2st64_b32 v[44:45], v88 offset0:2 offset1:3
    ds_read2st64_b32 v[46:47], v88 offset0:10 offset1:11
    ds_read2st64_b32 v[48:49], v88 offset0:32 offset1:33
    ds_read2st64_b32 v[50:51], v88 offset0:40 offset1:41
    ds_read2st64_b32 v[52:53], v88 offset0:34 offset1:35
    ds_read2st64_b32 v[54:55], v88 offset0:42 offset1:43
    ds_read2st64_b32 v[56:57], v89 offset0:0 offset1:1
    ds_read2st64_b32 v[58:59], v89 offset0:8 offset1:9
    ds_read2st64_b32 v[60:61], v89 offset0:2 offset1:3
    ds_read2st64_b32 v[62:63], v89 offset0:10 offset1:11
    ds_read2st64_b32 v[64:65], v89 offset0:32 offset1:33
    ds_read2st64_b32 v[66:67], v89 offset0:40 offset1:41
    ds_read2st64_b32 v[68:69], v89 offset0:34 offset1:35
    ds_read2st64_b32 v[70:71], v89 offset0:42 offset1:43
    s_waitcnt lgkmcnt(8)
    v_perm_b32 v128, v41, v40, s95
    v_perm_b32 v129, v43, v42, s95
    v_perm_b32 v130, v45, v44, s95
    v_perm_b32 v131, v47, v46, s95
    v_perm_b32 v132, v49, v48, s95
    v_perm_b32 v133, v51, v50, s95
    v_perm_b32 v134, v53, v52, s95
    v_perm_b32 v135, v55, v54, s95
    v_perm_b32 v136, v41, v40, s96
    v_perm_b32 v137, v43, v42, s96
    v_perm_b32 v138, v45, v44, s96
    v_perm_b32 v139, v47, v46, s96
    v_perm_b32 v140, v49, v48, s96
    v_perm_b32 v141, v51, v50, s96
    v_perm_b32 v142, v53, v52, s96
    v_perm_b32 v143, v55, v54, s96
    ds_read2st64_b32 v[40:41], v90 offset0:0 offset1:1
    ds_read2st64_b32 v[42:43], v90 offset0:8 offset1:9
    ds_read2st64_b32 v[44:45], v90 offset0:2 offset1:3
    ds_read2st64_b32 v[46:47], v90 offset0:10 offset1:11
    ds_read2st64_b32 v[48:49], v90 offset0:32 offset1:33
    ds_read2st64_b32 v[50:51], v90 offset0:40 offset1:41
    ds_read2st64_b32 v[52:53], v90 offset0:34 offset1:35
    ds_read2st64_b32 v[54:55], v90 offset0:42 offset1:43
    s_waitcnt lgkmcnt(8)
    v_perm_b32 v24, v57, v56, s95
    v_perm_b32 v25, v59, v58, s95
    v_perm_b32 v26, v61, v60, s95
    v_perm_b32 v27, v63, v62, s95
    v_perm_b32 v28, v65, v64, s95
    v_perm_b32 v29, v67, v66, s95
    v_perm_b32 v30, v69, v68, s95
    v_perm_b32 v31, v71, v70, s95
    v_accvgpr_write_b32 a112, v24
    v_accvgpr_write_b32 a113, v25
    v_accvgpr_write_b32 a114, v26
    v_accvgpr_write_b32 a115, v27
    v_accvgpr_write_b32 a116, v28
    v_accvgpr_write_b32 a117, v29
    v_accvgpr_write_b32 a118, v30
    v_accvgpr_write_b32 a119, v31
    v_perm_b32 v32, v57, v56, s96
    v_perm_b32 v33, v59, v58, s96
    v_perm_b32 v34, v61, v60, s96
    v_perm_b32 v35, v63, v62, s96
    v_perm_b32 v36, v65, v64, s96
    v_perm_b32 v37, v67, v66, s96
    v_perm_b32 v38, v69, v68, s96
    v_perm_b32 v39, v71, v70, s96
    v_accvgpr_write_b32 a120, v32
    v_accvgpr_write_b32 a121, v33
    v_accvgpr_write_b32 a122, v34
    v_accvgpr_write_b32 a123, v35
    v_accvgpr_write_b32 a124, v36
    v_accvgpr_write_b32 a125, v37
    v_accvgpr_write_b32 a126, v38
    v_accvgpr_write_b32 a127, v39
    ds_read2st64_b32 v[56:57], v91 offset0:0 offset1:1
    ds_read2st64_b32 v[58:59], v91 offset0:8 offset1:9
    ds_read2st64_b32 v[60:61], v91 offset0:2 offset1:3
    ds_read2st64_b32 v[62:63], v91 offset0:10 offset1:11
    ds_read2st64_b32 v[64:65], v91 offset0:32 offset1:33
    ds_read2st64_b32 v[66:67], v91 offset0:40 offset1:41
    ds_read2st64_b32 v[68:69], v91 offset0:34 offset1:35
    ds_read2st64_b32 v[70:71], v91 offset0:42 offset1:43
    s_waitcnt lgkmcnt(8)
    v_perm_b32 v24, v41, v40, s95
    v_perm_b32 v25, v43, v42, s95
    v_perm_b32 v26, v45, v44, s95
    v_perm_b32 v27, v47, v46, s95
    v_perm_b32 v28, v49, v48, s95
    v_perm_b32 v29, v51, v50, s95
    v_perm_b32 v30, v53, v52, s95
    v_perm_b32 v31, v55, v54, s95
    v_accvgpr_write_b32 a128, v24
    v_accvgpr_write_b32 a129, v25
    v_accvgpr_write_b32 a130, v26
    v_accvgpr_write_b32 a131, v27
    v_accvgpr_write_b32 a132, v28
    v_accvgpr_write_b32 a133, v29
    v_accvgpr_write_b32 a134, v30
    v_accvgpr_write_b32 a135, v31
    v_perm_b32 v32, v41, v40, s96
    v_perm_b32 v33, v43, v42, s96
    v_perm_b32 v34, v45, v44, s96
    v_perm_b32 v35, v47, v46, s96
    v_perm_b32 v36, v49, v48, s96
    v_perm_b32 v37, v51, v50, s96
    v_perm_b32 v38, v53, v52, s96
    v_perm_b32 v39, v55, v54, s96
    v_accvgpr_write_b32 a136, v32
    v_accvgpr_write_b32 a137, v33
    v_accvgpr_write_b32 a138, v34
    v_accvgpr_write_b32 a139, v35
    v_accvgpr_write_b32 a140, v36
    v_accvgpr_write_b32 a141, v37
    v_accvgpr_write_b32 a142, v38
    v_accvgpr_write_b32 a143, v39
    s_waitcnt lgkmcnt(0)
    v_perm_b32 v24, v57, v56, s95
    v_perm_b32 v25, v59, v58, s95
    v_perm_b32 v26, v61, v60, s95
    v_perm_b32 v27, v63, v62, s95
    v_perm_b32 v28, v65, v64, s95
    v_perm_b32 v29, v67, v66, s95
    v_perm_b32 v30, v69, v68, s95
    v_perm_b32 v31, v71, v70, s95
    v_accvgpr_write_b32 a144, v24
    v_accvgpr_write_b32 a145, v25
    v_accvgpr_write_b32 a146, v26
    v_accvgpr_write_b32 a147, v27
    v_accvgpr_write_b32 a148, v28
    v_accvgpr_write_b32 a149, v29
    v_accvgpr_write_b32 a150, v30
    v_accvgpr_write_b32 a151, v31
    v_perm_b32 v32, v57, v56, s96
    v_perm_b32 v33, v59, v58, s96
    v_perm_b32 v34, v61, v60, s96
    v_perm_b32 v35, v63, v62, s96
    v_perm_b32 v36, v65, v64, s96
    v_perm_b32 v37, v67, v66, s96
    v_perm_b32 v38, v69, v68, s96
    v_perm_b32 v39, v71, v70, s96
    v_accvgpr_write_b32 a152, v32
    v_accvgpr_write_b32 a153, v33
    v_accvgpr_write_b32 a154, v34
    v_accvgpr_write_b32 a155, v35
    v_accvgpr_write_b32 a156, v36
    v_accvgpr_write_b32 a157, v37
    v_accvgpr_write_b32 a158, v38
    v_accvgpr_write_b32 a159, v39
    v_add_u32 v88, 65536, v88
    v_add_u32 v89, 65536, v89
    v_add_u32 v90, 65536, v90
    v_add_u32 v91, 65536, v91
    s_barrier
    s_mov_b32 s16, s36
    s_and_b32 s17, s37, 0xffff
    s_mov_b32 s18, 0x400000
    s_mov_b32 s19, 0x20000
    s_add_u32 m0, s87, 0
    s_add_u32 s84, s86, 0
    buffer_load_dwordx4 v92, s[16:19], s84 offen lds
    s_add_u32 m0, s87, 1024
    s_add_u32 s84, s86, 32768
    buffer_load_dwordx4 v92, s[16:19], s84 offen lds
    s_add_u32 m0, s87, 2048
    s_add_u32 s84, s86, 65536
    buffer_load_dwordx4 v92, s[16:19], s84 offen lds
    s_add_u32 m0, s87, 3072
    s_add_u32 s84, s86, 98304
    buffer_load_dwordx4 v92, s[16:19], s84 offen lds
    s_add_u32 m0, s87, 4096
    s_add_u32 s84, s86, 131072
    buffer_load_dwordx4 v92, s[16:19], s84 offen lds
    s_add_u32 m0, s87, 5120
    s_add_u32 s84, s86, 163840
    buffer_load_dwordx4 v92, s[16:19], s84 offen lds
    s_add_u32 m0, s87, 6144
    s_add_u32 s84, s86, 196608
    buffer_load_dwordx4 v92, s[16:19], s84 offen lds
    s_add_u32 m0, s87, 7168
    s_add_u32 s84, s86, 229376
    buffer_load_dwordx4 v92, s[16:19], s84 offen lds
    s_add_u32 m0, s87, 8192
    s_add_u32 s84, s86, 262144
    buffer_load_dwordx4 v92, s[16:19], s84 offen lds
    s_add_u32 m0, s87, 9216
    s_add_u32 s84, s86, 294912
    buffer_load_dwordx4 v92, s[16:19], s84 offen lds
    s_add_u32 m0, s87, 10240
    s_add_u32 s84, s86, 327680
    buffer_load_dwordx4 v92, s[16:19], s84 offen lds
    s_add_u32 m0, s87, 11264
    s_add_u32 s84, s86, 360448
    buffer_load_dwordx4 v92, s[16:19], s84 offen lds
    s_add_u32 m0, s87, 12288
    s_add_u32 s84, s86, 393216
    buffer_load_dwordx4 v92, s[16:19], s84 offen lds
    s_add_u32 m0, s87, 13312
    s_add_u32 s84, s86, 425984
    buffer_load_dwordx4 v92, s[16:19], s84 offen lds
    s_add_u32 m0, s87, 14336
    s_add_u32 s84, s86, 458752
    buffer_load_dwordx4 v92, s[16:19], s84 offen lds
    s_add_u32 m0, s87, 15360
    s_add_u32 s84, s86, 491520
    buffer_load_dwordx4 v92, s[16:19], s84 offen lds
    s_waitcnt vmcnt(16)
    s_barrier
    ds_read2st64_b32 v[40:41], v88 offset0:0 offset1:1
    ds_read2st64_b32 v[42:43], v88 offset0:8 offset1:9
    ds_read2st64_b32 v[44:45], v88 offset0:2 offset1:3
    ds_read2st64_b32 v[46:47], v88 offset0:10 offset1:11
    ds_read2st64_b32 v[48:49], v88 offset0:32 offset1:33
    ds_read2st64_b32 v[50:51], v88 offset0:40 offset1:41
    ds_read2st64_b32 v[52:53], v88 offset0:34 offset1:35
    ds_read2st64_b32 v[54:55], v88 offset0:42 offset1:43
    ds_read2st64_b32 v[56:57], v89 offset0:0 offset1:1
    ds_read2st64_b32 v[58:59], v89 offset0:8 offset1:9
    ds_read2st64_b32 v[60:61], v89 offset0:2 offset1:3
    ds_read2st64_b32 v[62:63], v89 offset0:10 offset1:11
    ds_read2st64_b32 v[64:65], v89 offset0:32 offset1:33
    ds_read2st64_b32 v[66:67], v89 offset0:40 offset1:41
    ds_read2st64_b32 v[68:69], v89 offset0:34 offset1:35
    ds_read2st64_b32 v[70:71], v89 offset0:42 offset1:43
    s_waitcnt lgkmcnt(8)
    v_perm_b32 v24, v41, v40, s95
    v_perm_b32 v25, v43, v42, s95
    v_perm_b32 v26, v45, v44, s95
    v_perm_b32 v27, v47, v46, s95
    v_perm_b32 v28, v49, v48, s95
    v_perm_b32 v29, v51, v50, s95
    v_perm_b32 v30, v53, v52, s95
    v_perm_b32 v31, v55, v54, s95
    v_accvgpr_write_b32 a160, v24
    v_accvgpr_write_b32 a161, v25
    v_accvgpr_write_b32 a162, v26
    v_accvgpr_write_b32 a163, v27
    v_accvgpr_write_b32 a164, v28
    v_accvgpr_write_b32 a165, v29
    v_accvgpr_write_b32 a166, v30
    v_accvgpr_write_b32 a167, v31
    v_perm_b32 v32, v41, v40, s96
    v_perm_b32 v33, v43, v42, s96
    v_perm_b32 v34, v45, v44, s96
    v_perm_b32 v35, v47, v46, s96
    v_perm_b32 v36, v49, v48, s96
    v_perm_b32 v37, v51, v50, s96
    v_perm_b32 v38, v53, v52, s96
    v_perm_b32 v39, v55, v54, s96
    v_accvgpr_write_b32 a168, v32
    v_accvgpr_write_b32 a169, v33
    v_accvgpr_write_b32 a170, v34
    v_accvgpr_write_b32 a171, v35
    v_accvgpr_write_b32 a172, v36
    v_accvgpr_write_b32 a173, v37
    v_accvgpr_write_b32 a174, v38
    v_accvgpr_write_b32 a175, v39
    ds_read2st64_b32 v[40:41], v90 offset0:0 offset1:1
    ds_read2st64_b32 v[42:43], v90 offset0:8 offset1:9
    ds_read2st64_b32 v[44:45], v90 offset0:2 offset1:3
    ds_read2st64_b32 v[46:47], v90 offset0:10 offset1:11
    ds_read2st64_b32 v[48:49], v90 offset0:32 offset1:33
    ds_read2st64_b32 v[50:51], v90 offset0:40 offset1:41
    ds_read2st64_b32 v[52:53], v90 offset0:34 offset1:35
    ds_read2st64_b32 v[54:55], v90 offset0:42 offset1:43
    s_waitcnt lgkmcnt(8)
    v_perm_b32 v24, v57, v56, s95
    v_perm_b32 v25, v59, v58, s95
    v_perm_b32 v26, v61, v60, s95
    v_perm_b32 v27, v63, v62, s95
    v_perm_b32 v28, v65, v64, s95
    v_perm_b32 v29, v67, v66, s95
    v_perm_b32 v30, v69, v68, s95
    v_perm_b32 v31, v71, v70, s95
    v_accvgpr_write_b32 a176, v24
    v_accvgpr_write_b32 a177, v25
    v_accvgpr_write_b32 a178, v26
    v_accvgpr_write_b32 a179, v27
    v_accvgpr_write_b32 a180, v28
    v_accvgpr_write_b32 a181, v29
    v_accvgpr_write_b32 a182, v30
    v_accvgpr_write_b32 a183, v31
    v_perm_b32 v32, v57, v56, s96
    v_perm_b32 v33, v59, v58, s96
    v_perm_b32 v34, v61, v60, s96
    v_perm_b32 v35, v63, v62, s96
    v_perm_b32 v36, v65, v64, s96
    v_perm_b32 v37, v67, v66, s96
    v_perm_b32 v38, v69, v68, s96
    v_perm_b32 v39, v71, v70, s96
    v_accvgpr_write_b32 a184, v32
    v_accvgpr_write_b32 a185, v33
    v_accvgpr_write_b32 a186, v34
    v_accvgpr_write_b32 a187, v35
    v_accvgpr_write_b32 a188, v36
    v_accvgpr_write_b32 a189, v37
    v_accvgpr_write_b32 a190, v38
    v_accvgpr_write_b32 a191, v39
    ds_read2st64_b32 v[56:57], v91 offset0:0 offset1:1
    ds_read2st64_b32 v[58:59], v91 offset0:8 offset1:9
    ds_read2st64_b32 v[60:61], v91 offset0:2 offset1:3
    ds_read2st64_b32 v[62:63], v91 offset0:10 offset1:11
    ds_read2st64_b32 v[64:65], v91 offset0:32 offset1:33
    ds_read2st64_b32 v[66:67], v91 offset0:40 offset1:41
    ds_read2st64_b32 v[68:69], v91 offset0:34 offset1:35
    ds_read2st64_b32 v[70:71], v91 offset0:42 offset1:43
    s_waitcnt lgkmcnt(8)
    v_perm_b32 v24, v41, v40, s95
    v_perm_b32 v25, v43, v42, s95
    v_perm_b32 v26, v45, v44, s95
    v_perm_b32 v27, v47, v46, s95
    v_perm_b32 v28, v49, v48, s95
    v_perm_b32 v29, v51, v50, s95
    v_perm_b32 v30, v53, v52, s95
    v_perm_b32 v31, v55, v54, s95
    v_accvgpr_write_b32 a192, v24
    v_accvgpr_write_b32 a193, v25
    v_accvgpr_write_b32 a194, v26
    v_accvgpr_write_b32 a195, v27
    v_accvgpr_write_b32 a196, v28
    v_accvgpr_write_b32 a197, v29
    v_accvgpr_write_b32 a198, v30
    v_accvgpr_write_b32 a199, v31
    v_perm_b32 v32, v41, v40, s96
    v_perm_b32 v33, v43, v42, s96
    v_perm_b32 v34, v45, v44, s96
    v_perm_b32 v35, v47, v46, s96
    v_perm_b32 v36, v49, v48, s96
    v_perm_b32 v37, v51, v50, s96
    v_perm_b32 v38, v53, v52, s96
    v_perm_b32 v39, v55, v54, s96
    v_accvgpr_write_b32 a200, v32
    v_accvgpr_write_b32 a201, v33
    v_accvgpr_write_b32 a202, v34
    v_accvgpr_write_b32 a203, v35
    v_accvgpr_write_b32 a204, v36
    v_accvgpr_write_b32 a205, v37
    v_accvgpr_write_b32 a206, v38
    v_accvgpr_write_b32 a207, v39
    s_waitcnt lgkmcnt(0)
    v_perm_b32 v24, v57, v56, s95
    v_perm_b32 v25, v59, v58, s95
    v_perm_b32 v26, v61, v60, s95
    v_perm_b32 v27, v63, v62, s95
    v_perm_b32 v28, v65, v64, s95
    v_perm_b32 v29, v67, v66, s95
    v_perm_b32 v30, v69, v68, s95
    v_perm_b32 v31, v71, v70, s95
    v_accvgpr_write_b32 a208, v24
    v_accvgpr_write_b32 a209, v25
    v_accvgpr_write_b32 a210, v26
    v_accvgpr_write_b32 a211, v27
    v_accvgpr_write_b32 a212, v28
    v_accvgpr_write_b32 a213, v29
    v_accvgpr_write_b32 a214, v30
    v_accvgpr_write_b32 a215, v31
    v_perm_b32 v32, v57, v56, s96
    v_perm_b32 v33, v59, v58, s96
    v_perm_b32 v34, v61, v60, s96
    v_perm_b32 v35, v63, v62, s96
    v_perm_b32 v36, v65, v64, s96
    v_perm_b32 v37, v67, v66, s96
    v_perm_b32 v38, v69, v68, s96
    v_perm_b32 v39, v71, v70, s96
    v_accvgpr_write_b32 a216, v32
    v_accvgpr_write_b32 a217, v33
    v_accvgpr_write_b32 a218, v34
    v_accvgpr_write_b32 a219, v35
    v_accvgpr_write_b32 a220, v36
    v_accvgpr_write_b32 a221, v37
    v_accvgpr_write_b32 a222, v38
    v_accvgpr_write_b32 a223, v39
    v_subrev_u32 v88, 65536, v88
    v_subrev_u32 v89, 65536, v89
    v_subrev_u32 v90, 65536, v90
    v_subrev_u32 v91, 65536, v91
    s_barrier
    s_add_u32 m0, s87, 65536
    s_add_u32 s84, s86, 2097152
    buffer_load_dwordx4 v92, s[16:19], s84 offen lds
    s_add_u32 m0, s87, 66560
    s_add_u32 s84, s86, 2129920
    buffer_load_dwordx4 v92, s[16:19], s84 offen lds
    s_add_u32 m0, s87, 67584
    s_add_u32 s84, s86, 2162688
    buffer_load_dwordx4 v92, s[16:19], s84 offen lds
    s_add_u32 m0, s87, 68608
    s_add_u32 s84, s86, 2195456
    buffer_load_dwordx4 v92, s[16:19], s84 offen lds
    s_add_u32 m0, s87, 69632
    s_add_u32 s84, s86, 2228224
    buffer_load_dwordx4 v92, s[16:19], s84 offen lds
    s_add_u32 m0, s87, 70656
    s_add_u32 s84, s86, 2260992
    buffer_load_dwordx4 v92, s[16:19], s84 offen lds
    s_add_u32 m0, s87, 71680
    s_add_u32 s84, s86, 2293760
    buffer_load_dwordx4 v92, s[16:19], s84 offen lds
    s_add_u32 m0, s87, 72704
    s_add_u32 s84, s86, 2326528
    buffer_load_dwordx4 v92, s[16:19], s84 offen lds
    s_add_u32 m0, s87, 73728
    s_add_u32 s84, s86, 2359296
    buffer_load_dwordx4 v92, s[16:19], s84 offen lds
    s_add_u32 m0, s87, 74752
    s_add_u32 s84, s86, 2392064
    buffer_load_dwordx4 v92, s[16:19], s84 offen lds
    s_add_u32 m0, s87, 75776
    s_add_u32 s84, s86, 2424832
    buffer_load_dwordx4 v92, s[16:19], s84 offen lds
    s_add_u32 m0, s87, 76800
    s_add_u32 s84, s86, 2457600
    buffer_load_dwordx4 v92, s[16:19], s84 offen lds
    s_add_u32 m0, s87, 77824
    s_add_u32 s84, s86, 2490368
    buffer_load_dwordx4 v92, s[16:19], s84 offen lds
    s_add_u32 m0, s87, 78848
    s_add_u32 s84, s86, 2523136
    buffer_load_dwordx4 v92, s[16:19], s84 offen lds
    s_add_u32 m0, s87, 79872
    s_add_u32 s84, s86, 2555904
    buffer_load_dwordx4 v92, s[16:19], s84 offen lds
    s_add_u32 m0, s87, 80896
    s_add_u32 s84, s86, 2588672
    buffer_load_dwordx4 v92, s[16:19], s84 offen lds
    s_waitcnt vmcnt(16)
    s_barrier
    s_mov_b32 s20, s42
    s_and_b32 s21, s43, 0xffff
    s_mov_b32 s22, 0x400000
    s_mov_b32 s23, 0x20000
    v_lshlrev_b32 v82, 7, v95
    s_lshl_b32 s84, s62, 17
    s_lshl_b32 s85, s61, 15
    s_add_u32 s84, s84, s85
    buffer_load_dword v83, v82, s[20:23], s84 offen
    s_add_u32 s84, s84, 8192
    buffer_load_dword v83, v82, s[20:23], s84 offen
    s_add_u32 s84, s84, 8192
    buffer_load_dword v83, v82, s[20:23], s84 offen
    s_add_u32 s84, s84, 8192
    buffer_load_dword v83, v82, s[20:23], s84 offen
    s_add_u32 s84, s84, 8192
    ds_read2st64_b32 v[40:41], v88 offset0:0 offset1:1
    ds_read2st64_b32 v[42:43], v88 offset0:8 offset1:9
    ds_read2st64_b32 v[44:45], v88 offset0:2 offset1:3
    ds_read2st64_b32 v[46:47], v88 offset0:10 offset1:11
    ds_read2st64_b32 v[48:49], v88 offset0:32 offset1:33
    ds_read2st64_b32 v[50:51], v88 offset0:40 offset1:41
    ds_read2st64_b32 v[52:53], v88 offset0:34 offset1:35
    ds_read2st64_b32 v[54:55], v88 offset0:42 offset1:43
    ds_read2st64_b32 v[56:57], v89 offset0:0 offset1:1
    ds_read2st64_b32 v[58:59], v89 offset0:8 offset1:9
    ds_read2st64_b32 v[60:61], v89 offset0:2 offset1:3
    ds_read2st64_b32 v[62:63], v89 offset0:10 offset1:11
    ds_read2st64_b32 v[64:65], v89 offset0:32 offset1:33
    ds_read2st64_b32 v[66:67], v89 offset0:40 offset1:41
    ds_read2st64_b32 v[68:69], v89 offset0:34 offset1:35
    ds_read2st64_b32 v[70:71], v89 offset0:42 offset1:43
    s_waitcnt lgkmcnt(8)
    v_perm_b32 v96, v41, v40, s95
    v_perm_b32 v97, v43, v42, s95
    v_perm_b32 v98, v45, v44, s95
    v_perm_b32 v99, v47, v46, s95
    v_perm_b32 v100, v49, v48, s95
    v_perm_b32 v101, v51, v50, s95
    v_perm_b32 v102, v53, v52, s95
    v_perm_b32 v103, v55, v54, s95
    v_perm_b32 v104, v41, v40, s96
    v_perm_b32 v105, v43, v42, s96
    v_perm_b32 v106, v45, v44, s96
    v_perm_b32 v107, v47, v46, s96
    v_perm_b32 v108, v49, v48, s96
    v_perm_b32 v109, v51, v50, s96
    v_perm_b32 v110, v53, v52, s96
    v_perm_b32 v111, v55, v54, s96
    ds_read2st64_b32 v[40:41], v90 offset0:0 offset1:1
    ds_read2st64_b32 v[42:43], v90 offset0:8 offset1:9
    ds_read2st64_b32 v[44:45], v90 offset0:2 offset1:3
    ds_read2st64_b32 v[46:47], v90 offset0:10 offset1:11
    ds_read2st64_b32 v[48:49], v90 offset0:32 offset1:33
    ds_read2st64_b32 v[50:51], v90 offset0:40 offset1:41
    ds_read2st64_b32 v[52:53], v90 offset0:34 offset1:35
    ds_read2st64_b32 v[54:55], v90 offset0:42 offset1:43
    s_waitcnt lgkmcnt(8)
    v_perm_b32 v144, v57, v56, s95
    v_perm_b32 v145, v59, v58, s95
    v_perm_b32 v146, v61, v60, s95
    v_perm_b32 v147, v63, v62, s95
    v_perm_b32 v148, v65, v64, s95
    v_perm_b32 v149, v67, v66, s95
    v_perm_b32 v150, v69, v68, s95
    v_perm_b32 v151, v71, v70, s95
    v_perm_b32 v152, v57, v56, s96
    v_perm_b32 v153, v59, v58, s96
    v_perm_b32 v154, v61, v60, s96
    v_perm_b32 v155, v63, v62, s96
    v_perm_b32 v156, v65, v64, s96
    v_perm_b32 v157, v67, v66, s96
    v_perm_b32 v158, v69, v68, s96
    v_perm_b32 v159, v71, v70, s96
    ds_read2st64_b32 v[56:57], v91 offset0:0 offset1:1
    ds_read2st64_b32 v[58:59], v91 offset0:8 offset1:9
    ds_read2st64_b32 v[60:61], v91 offset0:2 offset1:3
    ds_read2st64_b32 v[62:63], v91 offset0:10 offset1:11
    ds_read2st64_b32 v[64:65], v91 offset0:32 offset1:33
    ds_read2st64_b32 v[66:67], v91 offset0:40 offset1:41
    ds_read2st64_b32 v[68:69], v91 offset0:34 offset1:35
    ds_read2st64_b32 v[70:71], v91 offset0:42 offset1:43
    s_waitcnt lgkmcnt(8)
    v_perm_b32 v160, v41, v40, s95
    v_perm_b32 v161, v43, v42, s95
    v_perm_b32 v162, v45, v44, s95
    v_perm_b32 v163, v47, v46, s95
    v_perm_b32 v164, v49, v48, s95
    v_perm_b32 v165, v51, v50, s95
    v_perm_b32 v166, v53, v52, s95
    v_perm_b32 v167, v55, v54, s95
    v_perm_b32 v168, v41, v40, s96
    v_perm_b32 v169, v43, v42, s96
    v_perm_b32 v170, v45, v44, s96
    v_perm_b32 v171, v47, v46, s96
    v_perm_b32 v172, v49, v48, s96
    v_perm_b32 v173, v51, v50, s96
    v_perm_b32 v174, v53, v52, s96
    v_perm_b32 v175, v55, v54, s96
    s_waitcnt lgkmcnt(0)
    v_perm_b32 v176, v57, v56, s95
    v_perm_b32 v177, v59, v58, s95
    v_perm_b32 v178, v61, v60, s95
    v_perm_b32 v179, v63, v62, s95
    v_perm_b32 v180, v65, v64, s95
    v_perm_b32 v181, v67, v66, s95
    v_perm_b32 v182, v69, v68, s95
    v_perm_b32 v183, v71, v70, s95
    v_perm_b32 v184, v57, v56, s96
    v_perm_b32 v185, v59, v58, s96
    v_perm_b32 v186, v61, v60, s96
    v_perm_b32 v187, v63, v62, s96
    v_perm_b32 v188, v65, v64, s96
    v_perm_b32 v189, v67, v66, s96
    v_perm_b32 v190, v69, v68, s96
    v_perm_b32 v191, v71, v70, s96
    v_add_u32 v88, 65536, v88
    v_add_u32 v89, 65536, v89
    v_add_u32 v90, 65536, v90
    v_add_u32 v91, 65536, v91
    s_barrier
    s_waitcnt vmcnt(4)
    s_barrier
    ds_read2st64_b32 v[40:41], v88 offset0:0 offset1:1
    ds_read2st64_b32 v[42:43], v88 offset0:8 offset1:9
    ds_read2st64_b32 v[44:45], v88 offset0:2 offset1:3
    ds_read2st64_b32 v[46:47], v88 offset0:10 offset1:11
    ds_read2st64_b32 v[48:49], v88 offset0:32 offset1:33
    ds_read2st64_b32 v[50:51], v88 offset0:40 offset1:41
    ds_read2st64_b32 v[52:53], v88 offset0:34 offset1:35
    ds_read2st64_b32 v[54:55], v88 offset0:42 offset1:43
    ds_read2st64_b32 v[56:57], v89 offset0:0 offset1:1
    ds_read2st64_b32 v[58:59], v89 offset0:8 offset1:9
    ds_read2st64_b32 v[60:61], v89 offset0:2 offset1:3
    ds_read2st64_b32 v[62:63], v89 offset0:10 offset1:11
    ds_read2st64_b32 v[64:65], v89 offset0:32 offset1:33
    ds_read2st64_b32 v[66:67], v89 offset0:40 offset1:41
    ds_read2st64_b32 v[68:69], v89 offset0:34 offset1:35
    ds_read2st64_b32 v[70:71], v89 offset0:42 offset1:43
    s_waitcnt lgkmcnt(8)
    v_perm_b32 v192, v41, v40, s95
    v_perm_b32 v193, v43, v42, s95
    v_perm_b32 v194, v45, v44, s95
    v_perm_b32 v195, v47, v46, s95
    v_perm_b32 v196, v49, v48, s95
    v_perm_b32 v197, v51, v50, s95
    v_perm_b32 v198, v53, v52, s95
    v_perm_b32 v199, v55, v54, s95
    v_perm_b32 v200, v41, v40, s96
    v_perm_b32 v201, v43, v42, s96
    v_perm_b32 v202, v45, v44, s96
    v_perm_b32 v203, v47, v46, s96
    v_perm_b32 v204, v49, v48, s96
    v_perm_b32 v205, v51, v50, s96
    v_perm_b32 v206, v53, v52, s96
    v_perm_b32 v207, v55, v54, s96
    ds_read2st64_b32 v[40:41], v90 offset0:0 offset1:1
    ds_read2st64_b32 v[42:43], v90 offset0:8 offset1:9
    ds_read2st64_b32 v[44:45], v90 offset0:2 offset1:3
    ds_read2st64_b32 v[46:47], v90 offset0:10 offset1:11
    ds_read2st64_b32 v[48:49], v90 offset0:32 offset1:33
    ds_read2st64_b32 v[50:51], v90 offset0:40 offset1:41
    ds_read2st64_b32 v[52:53], v90 offset0:34 offset1:35
    ds_read2st64_b32 v[54:55], v90 offset0:42 offset1:43
    s_waitcnt lgkmcnt(8)
    v_perm_b32 v208, v57, v56, s95
    v_perm_b32 v209, v59, v58, s95
    v_perm_b32 v210, v61, v60, s95
    v_perm_b32 v211, v63, v62, s95
    v_perm_b32 v212, v65, v64, s95
    v_perm_b32 v213, v67, v66, s95
    v_perm_b32 v214, v69, v68, s95
    v_perm_b32 v215, v71, v70, s95
    v_perm_b32 v216, v57, v56, s96
    v_perm_b32 v217, v59, v58, s96
    v_perm_b32 v218, v61, v60, s96
    v_perm_b32 v219, v63, v62, s96
    v_perm_b32 v220, v65, v64, s96
    v_perm_b32 v221, v67, v66, s96
    v_perm_b32 v222, v69, v68, s96
    v_perm_b32 v223, v71, v70, s96
    ds_read2st64_b32 v[56:57], v91 offset0:0 offset1:1
    ds_read2st64_b32 v[58:59], v91 offset0:8 offset1:9
    ds_read2st64_b32 v[60:61], v91 offset0:2 offset1:3
    ds_read2st64_b32 v[62:63], v91 offset0:10 offset1:11
    ds_read2st64_b32 v[64:65], v91 offset0:32 offset1:33
    ds_read2st64_b32 v[66:67], v91 offset0:40 offset1:41
    ds_read2st64_b32 v[68:69], v91 offset0:34 offset1:35
    ds_read2st64_b32 v[70:71], v91 offset0:42 offset1:43
    s_waitcnt lgkmcnt(8)
    v_perm_b32 v224, v41, v40, s95
    v_perm_b32 v225, v43, v42, s95
    v_perm_b32 v226, v45, v44, s95
    v_perm_b32 v227, v47, v46, s95
    v_perm_b32 v228, v49, v48, s95
    v_perm_b32 v229, v51, v50, s95
    v_perm_b32 v230, v53, v52, s95
    v_perm_b32 v231, v55, v54, s95
    v_perm_b32 v232, v41, v40, s96
    v_perm_b32 v233, v43, v42, s96
    v_perm_b32 v234, v45, v44, s96
    v_perm_b32 v235, v47, v46, s96
    v_perm_b32 v236, v49, v48, s96
    v_perm_b32 v237, v51, v50, s96
    v_perm_b32 v238, v53, v52, s96
    v_perm_b32 v239, v55, v54, s96
    s_waitcnt lgkmcnt(0)
    v_perm_b32 v240, v57, v56, s95
    v_perm_b32 v241, v59, v58, s95
    v_perm_b32 v242, v61, v60, s95
    v_perm_b32 v243, v63, v62, s95
    v_perm_b32 v244, v65, v64, s95
    v_perm_b32 v245, v67, v66, s95
    v_perm_b32 v246, v69, v68, s95
    v_perm_b32 v247, v71, v70, s95
    v_perm_b32 v248, v57, v56, s96
    v_perm_b32 v249, v59, v58, s96
    v_perm_b32 v250, v61, v60, s96
    v_perm_b32 v251, v63, v62, s96
    v_perm_b32 v252, v65, v64, s96
    v_perm_b32 v253, v67, v66, s96
    v_perm_b32 v254, v69, v68, s96
    v_perm_b32 v255, v71, v70, s96
    v_subrev_u32 v88, 65536, v88
    v_subrev_u32 v89, 65536, v89
    v_subrev_u32 v90, 65536, v90
    v_subrev_u32 v91, 65536, v91
    s_barrier
    v_mov_b32 v18, 0
    s_mov_b32 s83, 0
    s_mov_b32 s64, 0
    buffer_load_dwordx4 v[20:23], v18, s[12:15], 0 offen offset:8 sc1
    s_add_u32 s84, s90, 0
    buffer_load_dwordx2 v[40:41], v94, s[20:23], s84 offen
    s_add_u32 s84, s90, 1024
    buffer_load_dwordx2 v[42:43], v94, s[20:23], s84 offen
    s_add_u32 s84, s90, 8192
    buffer_load_dwordx2 v[44:45], v94, s[20:23], s84 offen
    s_add_u32 s84, s90, 9216
    buffer_load_dwordx2 v[46:47], v94, s[20:23], s84 offen
    s_add_u32 s84, s90, 2048
    buffer_load_dwordx2 v[48:49], v94, s[20:23], s84 offen
    s_add_u32 s84, s90, 3072
    buffer_load_dwordx2 v[50:51], v94, s[20:23], s84 offen
    s_add_u32 s84, s90, 10240
    buffer_load_dwordx2 v[52:53], v94, s[20:23], s84 offen
    s_add_u32 s84, s90, 11264
    buffer_load_dwordx2 v[54:55], v94, s[20:23], s84 offen
    s_add_u32 s84, s90, 32768
    buffer_load_dwordx2 v[56:57], v94, s[20:23], s84 offen
    s_add_u32 s84, s90, 33792
    buffer_load_dwordx2 v[58:59], v94, s[20:23], s84 offen
    s_add_u32 s84, s90, 40960
    buffer_load_dwordx2 v[60:61], v94, s[20:23], s84 offen
    s_add_u32 s84, s90, 41984
    buffer_load_dwordx2 v[62:63], v94, s[20:23], s84 offen
    s_add_u32 s84, s90, 34816
    buffer_load_dwordx2 v[64:65], v94, s[20:23], s84 offen
    s_add_u32 s84, s90, 35840
    buffer_load_dwordx2 v[66:67], v94, s[20:23], s84 offen
    s_add_u32 s84, s90, 43008
    buffer_load_dwordx2 v[68:69], v94, s[20:23], s84 offen
    s_add_u32 s84, s90, 44032
    buffer_load_dwordx2 v[70:71], v94, s[20:23], s84 offen
    s_add_u32 s84, s90, 65536
    buffer_load_dwordx2 v[72:73], v94, s[20:23], s84 offen
    s_add_u32 s84, s90, 66560
    buffer_load_dwordx2 v[74:75], v94, s[20:23], s84 offen
    s_add_u32 s84, s90, 73728
    buffer_load_dwordx2 v[76:77], v94, s[20:23], s84 offen
    s_add_u32 s84, s90, 74752
    buffer_load_dwordx2 v[78:79], v94, s[20:23], s84 offen
    s_add_u32 s84, s90, 67584
    buffer_load_dwordx2 v[80:81], v94, s[20:23], s84 offen
    s_add_u32 s84, s90, 68608
    buffer_load_dwordx2 v[82:83], v94, s[20:23], s84 offen
    s_add_u32 s84, s90, 75776
    buffer_load_dwordx2 v[84:85], v94, s[20:23], s84 offen
    s_add_u32 s84, s90, 76800
    buffer_load_dwordx2 v[86:87], v94, s[20:23], s84 offen
    ds_write_b128 v4, v[112:115] offset:4096
    ds_write_b128 v4, v[116:119] offset:5120
    ds_write_b128 v4, v[120:123] offset:6144
    ds_write_b128 v4, v[124:127] offset:7168
    ds_write_b128 v4, v[128:131] offset:8192
    ds_write_b128 v4, v[132:135] offset:9216
    ds_write_b128 v4, v[136:139] offset:10240
    ds_write_b128 v4, v[140:143] offset:11264
    ds_write_b128 v4, v[96:99] offset:0
    ds_write_b128 v4, v[100:103] offset:1024
    ds_write_b128 v4, v[104:107] offset:2048
    ds_write_b128 v4, v[108:111] offset:3072
    s_lshr_b32 s73, s62, 1
    s_lshl_b32 s73, s73, 11
    s_add_u32 s73, s73, 0x7200000
    s_add_u32 s77, s73, 2016
    s_waitcnt vmcnt(16)
    s_waitcnt lgkmcnt(1)
    v_perm_b32 v24, v42, v40, s95
    v_perm_b32 v25, v46, v44, s95
    v_perm_b32 v26, v50, v48, s95
    v_perm_b32 v27, v54, v52, s95
    ds_write_b128 v4, v[24:27] offset:12288
    s_waitcnt lgkmcnt(1)
    v_perm_b32 v32, v42, v40, s96
    v_perm_b32 v33, v46, v44, s96
    v_perm_b32 v34, v50, v48, s96
    v_perm_b32 v35, v54, v52, s96
    ds_write_b128 v4, v[32:35] offset:14336
    s_waitcnt lgkmcnt(1)
    v_perm_b32 v24, v43, v41, s95
    v_perm_b32 v25, v47, v45, s95
    v_perm_b32 v26, v51, v49, s95
    v_perm_b32 v27, v55, v53, s95
    ds_write_b128 v4, v[24:27] offset:20480
    s_waitcnt lgkmcnt(1)
    v_perm_b32 v32, v43, v41, s96
    v_perm_b32 v33, v47, v45, s96
    v_perm_b32 v34, v51, v49, s96
    v_perm_b32 v35, v55, v53, s96
    v_accvgpr_write_b32 a224, v32
    v_accvgpr_write_b32 a225, v33
    v_accvgpr_write_b32 a226, v34
    v_accvgpr_write_b32 a227, v35
    s_add_u32 s84, s90, 98304
    buffer_load_dwordx2 v[40:41], v94, s[20:23], s84 offen
    s_add_u32 s84, s90, 99328
    buffer_load_dwordx2 v[42:43], v94, s[20:23], s84 offen
    s_add_u32 s84, s90, 106496
    buffer_load_dwordx2 v[44:45], v94, s[20:23], s84 offen
    s_add_u32 s84, s90, 107520
    buffer_load_dwordx2 v[46:47], v94, s[20:23], s84 offen
    s_add_u32 s84, s90, 100352
    buffer_load_dwordx2 v[48:49], v94, s[20:23], s84 offen
    s_add_u32 s84, s90, 101376
    buffer_load_dwordx2 v[50:51], v94, s[20:23], s84 offen
    s_add_u32 s84, s90, 108544
    buffer_load_dwordx2 v[52:53], v94, s[20:23], s84 offen
    s_add_u32 s84, s90, 109568
    buffer_load_dwordx2 v[54:55], v94, s[20:23], s84 offen
    s_waitcnt vmcnt(16)
    s_waitcnt lgkmcnt(1)
    v_perm_b32 v24, v58, v56, s95
    v_perm_b32 v25, v62, v60, s95
    v_perm_b32 v26, v66, v64, s95
    v_perm_b32 v27, v70, v68, s95
    ds_write_b128 v4, v[24:27] offset:13312
    s_waitcnt lgkmcnt(1)
    v_perm_b32 v32, v58, v56, s96
    v_perm_b32 v33, v62, v60, s96
    v_perm_b32 v34, v66, v64, s96
    v_perm_b32 v35, v70, v68, s96
    ds_write_b128 v4, v[32:35] offset:15360
    s_waitcnt lgkmcnt(1)
    v_perm_b32 v24, v59, v57, s95
    v_perm_b32 v25, v63, v61, s95
    v_perm_b32 v26, v67, v65, s95
    v_perm_b32 v27, v71, v69, s95
    ds_write_b128 v4, v[24:27] offset:21504
    s_waitcnt lgkmcnt(1)
    v_perm_b32 v32, v59, v57, s96
    v_perm_b32 v33, v63, v61, s96
    v_perm_b32 v34, v67, v65, s96
    v_perm_b32 v35, v71, v69, s96
    v_accvgpr_write_b32 a228, v32
    v_accvgpr_write_b32 a229, v33
    v_accvgpr_write_b32 a230, v34
    v_accvgpr_write_b32 a231, v35
    s_add_u32 s84, s90, 512
    buffer_load_dwordx2 v[56:57], v94, s[20:23], s84 offen
    s_add_u32 s84, s90, 1536
    buffer_load_dwordx2 v[58:59], v94, s[20:23], s84 offen
    s_add_u32 s84, s90, 8704
    buffer_load_dwordx2 v[60:61], v94, s[20:23], s84 offen
    s_add_u32 s84, s90, 9728
    buffer_load_dwordx2 v[62:63], v94, s[20:23], s84 offen
    s_add_u32 s84, s90, 2560
    buffer_load_dwordx2 v[64:65], v94, s[20:23], s84 offen
    s_add_u32 s84, s90, 3584
    buffer_load_dwordx2 v[66:67], v94, s[20:23], s84 offen
    s_add_u32 s84, s90, 10752
    buffer_load_dwordx2 v[68:69], v94, s[20:23], s84 offen
    s_add_u32 s84, s90, 11776
    buffer_load_dwordx2 v[70:71], v94, s[20:23], s84 offen
    s_waitcnt vmcnt(16)
    s_waitcnt lgkmcnt(1)
    v_perm_b32 v24, v74, v72, s95
    v_perm_b32 v25, v78, v76, s95
    v_perm_b32 v26, v82, v80, s95
    v_perm_b32 v27, v86, v84, s95
    ds_write_b128 v4, v[24:27] offset:16384
    s_waitcnt lgkmcnt(1)
    v_perm_b32 v32, v74, v72, s96
    v_perm_b32 v33, v78, v76, s96
    v_perm_b32 v34, v82, v80, s96
    v_perm_b32 v35, v86, v84, s96
    ds_write_b128 v4, v[32:35] offset:18432
    s_waitcnt lgkmcnt(1)
    v_perm_b32 v24, v75, v73, s95
    v_perm_b32 v25, v79, v77, s95
    v_perm_b32 v26, v83, v81, s95
    v_perm_b32 v27, v87, v85, s95
    ds_write_b128 v4, v[24:27] offset:22528
    s_waitcnt lgkmcnt(1)
    v_perm_b32 v32, v75, v73, s96
    v_perm_b32 v33, v79, v77, s96
    v_perm_b32 v34, v83, v81, s96
    v_perm_b32 v35, v87, v85, s96
    v_accvgpr_write_b32 a232, v32
    v_accvgpr_write_b32 a233, v33
    v_accvgpr_write_b32 a234, v34
    v_accvgpr_write_b32 a235, v35
    s_add_u32 s84, s90, 33280
    buffer_load_dwordx2 v[72:73], v94, s[20:23], s84 offen
    s_add_u32 s84, s90, 34304
    buffer_load_dwordx2 v[74:75], v94, s[20:23], s84 offen
    s_add_u32 s84, s90, 41472
    buffer_load_dwordx2 v[76:77], v94, s[20:23], s84 offen
    s_add_u32 s84, s90, 42496
    buffer_load_dwordx2 v[78:79], v94, s[20:23], s84 offen
    s_add_u32 s84, s90, 35328
    buffer_load_dwordx2 v[80:81], v94, s[20:23], s84 offen
    s_add_u32 s84, s90, 36352
    buffer_load_dwordx2 v[82:83], v94, s[20:23], s84 offen
    s_add_u32 s84, s90, 43520
    buffer_load_dwordx2 v[84:85], v94, s[20:23], s84 offen
    s_add_u32 s84, s90, 44544
    buffer_load_dwordx2 v[86:87], v94, s[20:23], s84 offen
    s_waitcnt vmcnt(16)
    s_waitcnt lgkmcnt(1)
    v_perm_b32 v24, v42, v40, s95
    v_perm_b32 v25, v46, v44, s95
    v_perm_b32 v26, v50, v48, s95
    v_perm_b32 v27, v54, v52, s95
    ds_write_b128 v4, v[24:27] offset:17408
    s_waitcnt lgkmcnt(1)
    v_perm_b32 v32, v42, v40, s96
    v_perm_b32 v33, v46, v44, s96
    v_perm_b32 v34, v50, v48, s96
    v_perm_b32 v35, v54, v52, s96
    ds_write_b128 v4, v[32:35] offset:19456
    s_waitcnt lgkmcnt(1)
    v_perm_b32 v24, v43, v41, s95
    v_perm_b32 v25, v47, v45, s95
    v_perm_b32 v26, v51, v49, s95
    v_perm_b32 v27, v55, v53, s95
    ds_write_b128 v4, v[24:27] offset:23552
    s_waitcnt lgkmcnt(1)
    v_perm_b32 v32, v43, v41, s96
    v_perm_b32 v33, v47, v45, s96
    v_perm_b32 v34, v51, v49, s96
    v_perm_b32 v35, v55, v53, s96
    v_accvgpr_write_b32 a236, v32
    v_accvgpr_write_b32 a237, v33
    v_accvgpr_write_b32 a238, v34
    v_accvgpr_write_b32 a239, v35
    s_add_u32 s84, s90, 66048
    buffer_load_dwordx2 v[40:41], v94, s[20:23], s84 offen
    s_add_u32 s84, s90, 67072
    buffer_load_dwordx2 v[42:43], v94, s[20:23], s84 offen
    s_add_u32 s84, s90, 74240
    buffer_load_dwordx2 v[44:45], v94, s[20:23], s84 offen
    s_add_u32 s84, s90, 75264
    buffer_load_dwordx2 v[46:47], v94, s[20:23], s84 offen
    s_add_u32 s84, s90, 68096
    buffer_load_dwordx2 v[48:49], v94, s[20:23], s84 offen
    s_add_u32 s84, s90, 69120
    buffer_load_dwordx2 v[50:51], v94, s[20:23], s84 offen
    s_add_u32 s84, s90, 76288
    buffer_load_dwordx2 v[52:53], v94, s[20:23], s84 offen
    s_add_u32 s84, s90, 77312
    buffer_load_dwordx2 v[54:55], v94, s[20:23], s84 offen
    s_waitcnt vmcnt(16)
    s_waitcnt lgkmcnt(1)
    v_perm_b32 v24, v58, v56, s95
    v_perm_b32 v25, v62, v60, s95
    v_perm_b32 v26, v66, v64, s95
    v_perm_b32 v27, v70, v68, s95
    v_accvgpr_write_b32 a240, v24
    v_accvgpr_write_b32 a241, v25
    v_accvgpr_write_b32 a242, v26
    v_accvgpr_write_b32 a243, v27
    s_waitcnt lgkmcnt(1)
    v_perm_b32 v32, v58, v56, s96
    v_perm_b32 v33, v62, v60, s96
    v_perm_b32 v34, v66, v64, s96
    v_perm_b32 v35, v70, v68, s96
    ds_write_b128 v4, v[32:35] offset:24576
    s_waitcnt lgkmcnt(1)
    v_perm_b32 v24, v59, v57, s95
    v_perm_b32 v25, v63, v61, s95
    v_perm_b32 v26, v67, v65, s95
    v_perm_b32 v27, v71, v69, s95
    ds_write_b128 v4, v[24:27] offset:28672
    s_waitcnt lgkmcnt(1)
    v_perm_b32 v32, v59, v57, s96
    v_perm_b32 v33, v63, v61, s96
    v_perm_b32 v34, v67, v65, s96
    v_perm_b32 v35, v71, v69, s96
    ds_write_b128 v4, v[32:35] offset:32768
    s_add_u32 s84, s90, 98816
    buffer_load_dwordx2 v[56:57], v94, s[20:23], s84 offen
    s_add_u32 s84, s90, 99840
    buffer_load_dwordx2 v[58:59], v94, s[20:23], s84 offen
    s_add_u32 s84, s90, 107008
    buffer_load_dwordx2 v[60:61], v94, s[20:23], s84 offen
    s_add_u32 s84, s90, 108032
    buffer_load_dwordx2 v[62:63], v94, s[20:23], s84 offen
    s_add_u32 s84, s90, 100864
    buffer_load_dwordx2 v[64:65], v94, s[20:23], s84 offen
    s_add_u32 s84, s90, 101888
    buffer_load_dwordx2 v[66:67], v94, s[20:23], s84 offen
    s_add_u32 s84, s90, 109056
    buffer_load_dwordx2 v[68:69], v94, s[20:23], s84 offen
    s_add_u32 s84, s90, 110080
    buffer_load_dwordx2 v[70:71], v94, s[20:23], s84 offen
R_dchk:
    v_readfirstlane_b32 s84, v21
    v_readfirstlane_b32 s85, v23
    v_readfirstlane_b32 s63, v20
    s_cmp_lt_u32 s84, 32
    s_cbranch_scc1 R_dwait
    s_cmp_lt_u32 s85, 4
    s_cbranch_scc1 R_dwait
    v_lshlrev_b32 v20, 1, v3
    buffer_load_dword v21, v20, s[8:11], s72 offen sc1
    v_lshlrev_b32 v20, 3, v3
    s_lshl_b32 s84, s61, 13
    s_add_u32 s84, s84, 0x7000000
    buffer_load_dword v21, v20, s[8:11], s84 offen sc1
    buffer_load_dword v17, v3, s[8:11], s73 offen sc1
    s_waitcnt vmcnt(19)
    s_waitcnt lgkmcnt(1)
    v_perm_b32 v24, v74, v72, s95
    v_perm_b32 v25, v78, v76, s95
    v_perm_b32 v26, v82, v80, s95
    v_perm_b32 v27, v86, v84, s95
    v_accvgpr_write_b32 a244, v24
    v_accvgpr_write_b32 a245, v25
    v_accvgpr_write_b32 a246, v26
    v_accvgpr_write_b32 a247, v27
    s_waitcnt lgkmcnt(1)
    v_perm_b32 v32, v74, v72, s96
    v_perm_b32 v33, v78, v76, s96
    v_perm_b32 v34, v82, v80, s96
    v_perm_b32 v35, v86, v84, s96
    ds_write_b128 v4, v[32:35] offset:25600
    s_waitcnt lgkmcnt(1)
    v_perm_b32 v24, v75, v73, s95
    v_perm_b32 v25, v79, v77, s95
    v_perm_b32 v26, v83, v81, s95
    v_perm_b32 v27, v87, v85, s95
    ds_write_b128 v4, v[24:27] offset:29696
    s_waitcnt lgkmcnt(1)
    v_perm_b32 v32, v75, v73, s96
    v_perm_b32 v33, v79, v77, s96
    v_perm_b32 v34, v83, v81, s96
    v_perm_b32 v35, v87, v85, s96
    ds_write_b128 v4, v[32:35] offset:33792
    s_waitcnt vmcnt(11)
    s_waitcnt lgkmcnt(1)
    v_perm_b32 v24, v42, v40, s95
    v_perm_b32 v25, v46, v44, s95
    v_perm_b32 v26, v50, v48, s95
    v_perm_b32 v27, v54, v52, s95
    v_accvgpr_write_b32 a248, v24
    v_accvgpr_write_b32 a249, v25
    v_accvgpr_write_b32 a250, v26
    v_accvgpr_write_b32 a251, v27
    s_waitcnt lgkmcnt(1)
    v_perm_b32 v32, v42, v40, s96
    v_perm_b32 v33, v46, v44, s96
    v_perm_b32 v34, v50, v48, s96
    v_perm_b32 v35, v54, v52, s96
    ds_write_b128 v4, v[32:35] offset:26624
    s_waitcnt lgkmcnt(1)
    v_perm_b32 v24, v43, v41, s95
    v_perm_b32 v25, v47, v45, s95
    v_perm_b32 v26, v51, v49, s95
    v_perm_b32 v27, v55, v53, s95
    ds_write_b128 v4, v[24:27] offset:30720
    s_waitcnt lgkmcnt(1)
    v_perm_b32 v32, v43, v41, s96
    v_perm_b32 v33, v47, v45, s96
    v_perm_b32 v34, v51, v49, s96
    v_perm_b32 v35, v55, v53, s96
    ds_write_b128 v4, v[32:35] offset:34816
    s_waitcnt vmcnt(3)
    s_waitcnt lgkmcnt(1)
    v_perm_b32 v24, v58, v56, s95
    v_perm_b32 v25, v62, v60, s95
    v_perm_b32 v26, v66, v64, s95
    v_perm_b32 v27, v70, v68, s95
    v_accvgpr_write_b32 a252, v24
    v_accvgpr_write_b32 a253, v25
    v_accvgpr_write_b32 a254, v26
    v_accvgpr_write_b32 a255, v27
    s_waitcnt lgkmcnt(1)
    v_perm_b32 v32, v58, v56, s96
    v_perm_b32 v33, v62, v60, s96
    v_perm_b32 v34, v66, v64, s96
    v_perm_b32 v35, v70, v68, s96
    ds_write_b128 v4, v[32:35] offset:27648
    s_waitcnt lgkmcnt(1)
    v_perm_b32 v24, v59, v57, s95
    v_perm_b32 v25, v63, v61, s95
    v_perm_b32 v26, v67, v65, s95
    v_perm_b32 v27, v71, v69, s95
    ds_write_b128 v4, v[24:27] offset:31744
    s_waitcnt lgkmcnt(1)
    v_perm_b32 v32, v59, v57, s96
    v_perm_b32 v33, v63, v61, s96
    v_perm_b32 v34, v67, v65, s96
    v_perm_b32 v35, v71, v69, s96
    ds_write_b128 v4, v[32:35] offset:35840
    s_mov_b32 s78, s69
    s_mov_b32 s79, s69
    s_mov_b32 s65, 0
    s_mov_b32 s67, 0
    s_mov_b32 s66, s74
    s_mov_b32 s88, 0x7000000
    s_mov_b32 s89, 0x7002000
    s_mov_b32 s90, 0x7004000
    s_mov_b32 s91, 0x7006000
    s_lshl_b32 s68, s61, 10
R_kvfirst:
    s_waitcnt vmcnt(0)
    v_cmp_eq_u32 vcc, 0, v17
    s_nop 1
    s_and_b32 s84, vcc_lo, 15
    s_cbranch_scc0 R_kvgo
    buffer_load_dword v17, v3, s[8:11], s73 offen sc1
    s_add_u32 s83, s83, 1
    s_cmp_gt_u32 s83, 0x100000
    s_cbranch_scc1 R_fail
    s_branch R_kvfirst
R_kvgo:
    v_xor_b32 v20, 8192, v16
    s_mov_b32 s84, 0x1000000
    buffer_load_dword v17, v20, s[8:11], s84 offen sc1
    buffer_load_dword v17, v16, s[8:11], s84 offen sc1
    s_mov_b32 s84, 0x1040000
    buffer_load_dword v17, v20, s[8:11], s84 offen sc1
    buffer_load_dword v17, v16, s[8:11], s84 offen sc1
    s_add_u32 s73, s73, 64
    s_cmp_lg_u32 s63, 0
    s_cbranch_scc1 R_safe
    s_waitcnt lgkmcnt(0)
    s_barrier
    s_mov_b32 m0, s92
    s_nop 0
    buffer_load_dwordx4 v9, s[8:11], s75 offen sc1 lds
    s_mov_b32 m0, s93
    s_nop 0
    buffer_load_dwordx4 v9, s[8:11], s75 offen offset:512 sc1 lds
    buffer_load_dword v17, v3, s[8:11], s73 offen sc1
    s_add_u32 s75, s75, 262144
    v_mov_b64 v[20:21], 0
    v_mov_b64 v[22:23], 0
    v_mov_b64 v[56:57], 0
    v_mov_b64 v[58:59], 0
    v_mov_b64 v[60:61], 0
    v_mov_b64 v[62:63], 0
    v_mov_b64 v[64:65], 0
    v_mov_b64 v[66:67], 0
    v_mov_b64 v[68:69], 0
    v_mov_b64 v[70:71], 0
    v_mov_b64 v[72:73], 0
    v_mov_b64 v[74:75], 0
    v_mov_b64 v[76:77], 0
    v_mov_b64 v[78:79], 0
    s_mov_b32 s83, 0
    s_add_u32 s98, s66, 4096
R_loop:
R_repoll:
    buffer_load_dwordx4 v[24:27], v3, s[8:11], s66 offen sc1
    buffer_load_dwordx4 v[40:43], v3, s[8:11], s98 offen sc1
    s_nop 15
    s_nop 15
    s_nop 3
    buffer_load_dwordx4 v[80:83], v3, s[8:11], s66 offen sc1
    buffer_load_dwordx4 v[84:87], v3, s[8:11], s98 offen sc1
    s_branch R_goA
R_badA:
    buffer_load_dwordx4 v[24:27], v3, s[8:11], s66 offen sc1
    buffer_load_dwordx4 v[40:43], v3, s[8:11], s98 offen sc1
    s_add_u32 s83, s83, 1
    s_cmp_gt_u32 s83, 0x100000
    s_cbranch_scc1 R_fail
    s_add_u32 s67, s67, 0x10000
    s_nop 1
    v_mov_b64 v[56:57], 0
    v_mov_b64 v[58:59], 0
    v_mov_b64 v[60:61], 0
    v_mov_b64 v[62:63], 0
    s_waitcnt vmcnt(3)
    ds_write_b128 v0, v[80:83]
    v_max_u32 v18, v80, v82
    v_smfmac_f32_16x16x64_bf16 v[56:59], v[80:83], v[96:103], v1
    s_waitcnt vmcnt(2)
    ds_write_b128 v0, v[84:87] offset:4096
    v_max3_u32 v18, v18, v84, v86
    v_cmp_eq_u32 vcc, -1, v18
    v_smfmac_f32_16x16x64_bf16 v[60:63], v[80:83], v[104:111], v1
    v_smfmac_f32_16x16x64_bf16 v[56:59], v[84:87], v[192:199], v1
    s_cbranch_vccnz R_badB
    v_smfmac_f32_16x16x64_bf16 v[60:63], v[84:87], v[200:207], v1
    v_smfmac_f32_16x16x64_bf16 v[64:67], v[80:83], v[112:119], v1
    v_smfmac_f32_16x16x64_bf16 v[68:71], v[80:83], v[120:127], v1
    s_waitcnt lgkmcnt(0)
    s_barrier
    ds_read_b128 v[28:31], v6 offset:0
    v_smfmac_f32_16x16x64_bf16 v[64:67], v[84:87], a[48:55], v1
    ds_read_b128 v[32:35], v14 offset:0
    v_smfmac_f32_16x16x64_bf16 v[68:71], v[84:87], a[56:63], v1
    ds_read_b128 v[36:39], v15 offset:0
    v_smfmac_f32_16x16x64_bf16 v[72:75], v[80:83], v[128:135], v1
    ds_read_b128 v[44:47], v6 offset:4096
    v_smfmac_f32_16x16x64_bf16 v[76:79], v[80:83], v[136:143], v1
    ds_read_b128 v[48:51], v14 offset:4096
    v_smfmac_f32_16x16x64_bf16 v[72:75], v[84:87], a[160:167], v1
    ds_read_b128 v[52:55], v15 offset:4096
    v_smfmac_f32_16x16x64_bf16 v[76:79], v[84:87], a[168:175], v1
    s_branch R_join
R_badB:
    buffer_load_dwordx4 v[80:83], v3, s[8:11], s66 offen sc1
    buffer_load_dwordx4 v[84:87], v3, s[8:11], s98 offen sc1
    s_add_u32 s67, s67, 0x10000
    s_nop 4
    v_mov_b64 v[56:57], 0
    v_mov_b64 v[58:59], 0
    v_mov_b64 v[60:61], 0
    v_mov_b64 v[62:63], 0
R_goA:
    s_waitcnt vmcnt(3)
    ds_write_b128 v0, v[24:27]
    v_max_u32 v18, v24, v26
    v_smfmac_f32_16x16x64_bf16 v[56:59], v[24:27], v[96:103], v1
    s_waitcnt vmcnt(2)
    ds_write_b128 v0, v[40:43] offset:4096
    v_max3_u32 v18, v18, v40, v42
    v_cmp_eq_u32 vcc, -1, v18
    v_smfmac_f32_16x16x64_bf16 v[60:63], v[24:27], v[104:111], v1
    v_smfmac_f32_16x16x64_bf16 v[56:59], v[40:43], v[192:199], v1
    s_cbranch_vccnz R_badA
    v_smfmac_f32_16x16x64_bf16 v[60:63], v[40:43], v[200:207], v1
    v_smfmac_f32_16x16x64_bf16 v[64:67], v[24:27], v[112:119], v1
    v_smfmac_f32_16x16x64_bf16 v[68:71], v[24:27], v[120:127], v1
    s_waitcnt lgkmcnt(0)
    s_barrier
    ds_read_b128 v[28:31], v6 offset:0
    v_smfmac_f32_16x16x64_bf16 v[64:67], v[40:43], a[48:55], v1
    ds_read_b128 v[32:35], v14 offset:0
    v_smfmac_f32_16x16x64_bf16 v[68:71], v[40:43], a[56:63], v1
    ds_read_b128 v[36:39], v15 offset:0
    v_smfmac_f32_16x16x64_bf16 v[72:75], v[24:27], v[128:135], v1
    ds_read_b128 v[44:47], v6 offset:4096
    v_smfmac_f32_16x16x64_bf16 v[76:79], v[24:27], v[136:143], v1
    ds_read_b128 v[48:51], v14 offset:4096
    v_smfmac_f32_16x16x64_bf16 v[72:75], v[40:43], a[160:167], v1
    ds_read_b128 v[52:55], v15 offset:4096
    v_smfmac_f32_16x16x64_bf16 v[76:79], v[40:43], a[168:175], v1
R_join:
    s_cmp_eq_u32 s64, 63
    s_cbranch_scc1 R_done
    ds_read_b128 v[96:99], v3 offset:0
    s_waitcnt lgkmcnt(5)
    v_smfmac_f32_16x16x64_bf16 v[56:59], v[28:31], v[144:151], v1
    buffer_load_dwordx4 v[80:83], v8, s[8:11], s76 offen offset:0 sc1
    s_sub_u32 s84, s64, 1
    v_smfmac_f32_16x16x64_bf16 v[60:63], v[28:31], v[152:159], v1
    ds_read_b128 v[100:103], v3 offset:1024
    s_max_i32 s84, s84, 0
    v_mov_b32 v19, s84
    v_smfmac_f32_16x16x64_bf16 v[56:59], v[32:35], v[160:167], v1
    buffer_load_dwordx4 v[84:87], v8, s[8:11], s76 offen offset:512 sc1
    v_cmp_eq_u32 vcc, 0, v17
    v_smfmac_f32_16x16x64_bf16 v[60:63], v[32:35], v[168:175], v1
    ds_read_b128 v[104:107], v3 offset:2048
    s_waitcnt lgkmcnt(5)
    v_smfmac_f32_16x16x64_bf16 v[56:59], v[36:39], v[176:183], v1
    buffer_load_dwordx4 v[88:91], v8, s[8:11], s76 offen offset:1024 sc1
    v_smfmac_f32_16x16x64_bf16 v[60:63], v[36:39], v[184:191], v1
    ds_read_b128 v[108:111], v3 offset:3072
    s_and_b32 s84, vcc_lo, 3
    s_cbranch_scc1 R_kvwait
R_kvok:
    v_smfmac_f32_16x16x64_bf16 v[56:59], v[44:47], v[208:215], v1
    buffer_load_dwordx4 v[92:95], v8, s[8:11], s76 offen offset:1536 sc1
    s_add_u32 s73, s73, 32
    v_smfmac_f32_16x16x64_bf16 v[60:63], v[44:47], v[216:223], v1
    ds_read_b128 v[112:115], v3 offset:4096
    s_waitcnt lgkmcnt(5)
    v_smfmac_f32_16x16x64_bf16 v[56:59], v[48:51], v[224:231], v1
    s_barrier
    s_mov_b64 exec, 3
    buffer_store_dword v19, v3, s[8:11], s94 offen sc1
    s_mov_b64 exec, -1
    v_smfmac_f32_16x16x64_bf16 v[60:63], v[48:51], v[232:239], v1
    buffer_store_dwordx4 v[20:23], v3, s[8:11], s79 offen sc1
    v_smfmac_f32_16x16x64_bf16 v[56:59], v[52:55], v[240:247], v1
    ds_read_b128 v[116:119], v3 offset:5120
    s_min_u32 s73, s73, s77
    v_smfmac_f32_16x16x64_bf16 v[60:63], v[52:55], v[248:255], v1
    ds_read_b128 v[120:123], v3 offset:6144
    s_add_u32 s76, s76, 262144
    v_smfmac_f32_16x16x64_bf16 v[64:67], v[28:31], a[0:7], v1
    ds_read_b128 v[124:127], v3 offset:7168
    s_waitcnt vmcnt(6)
    v_smfmac_f32_16x16x64_bf16 v[68:71], v[28:31], a[8:15], v1
    s_mov_b32 s84, s88
    s_mov_b32 s88, s89
    v_add_f32 v24, v56, v58
    v_smfmac_f32_16x16x64_bf16 v[64:67], v[32:35], a[16:23], v1
    v_add_f32 v25, v57, v59
    v_add_f32 v26, v60, v62
    v_add_f32 v27, v61, v63
    v_cvt_pk_bf16_f32 v24, v24, v26
    v_cvt_pk_bf16_f32 v25, v25, v27
    ds_write2_b32 v10, v24, v25 offset0:0 offset1:4
    v_smfmac_f32_16x16x64_bf16 v[68:71], v[32:35], a[24:31], v1
    buffer_load_dword v17, v16, s[8:11], s97 offen sc1
    s_mov_b32 s89, s90
    v_smfmac_f32_16x16x64_bf16 v[64:67], v[36:39], a[32:39], v1
    s_mov_b32 s90, s91
    s_mov_b32 s91, s84
    v_smfmac_f32_16x16x64_bf16 v[68:71], v[36:39], a[40:47], v1
    s_mov_b64 exec, 3
    buffer_load_dword v17, v3, s[8:11], s73 offen sc1
    s_mov_b64 exec, -1
    v_smfmac_f32_16x16x64_bf16 v[64:67], v[44:47], a[64:71], v1
    s_add_u32 s66, s88, s68
    s_and_b32 s65, s64, 1
    v_smfmac_f32_16x16x64_bf16 v[68:71], v[44:47], a[72:79], v1
    s_waitcnt lgkmcnt(0)
    s_barrier
    ds_read_b128 v[128:131], v11 offset:0
    v_smfmac_f32_16x16x64_bf16 v[64:67], v[48:51], a[80:87], v1
    ds_read_b128 v[132:135], v11 offset:1024
    v_smfmac_f32_16x16x64_bf16 v[68:71], v[48:51], a[88:95], v1
    ds_read_b128 v[136:139], v11 offset:2048
    v_smfmac_f32_16x16x64_bf16 v[64:67], v[52:55], a[96:103], v1
    ds_read_b128 v[140:143], v11 offset:3072
    s_mov_b32 m0, s92
    v_smfmac_f32_16x16x64_bf16 v[68:71], v[52:55], a[104:111], v1
    s_add_u32 s98, s66, 4096
    v_smfmac_f32_16x16x64_bf16 v[72:75], v[28:31], a[112:119], v1
    buffer_load_dwordx4 v9, s[8:11], s75 offen sc1 lds
    s_mov_b32 m0, s93
    v_xor_b32 v40, 128, v10
    v_smfmac_f32_16x16x64_bf16 v[76:79], v[28:31], a[120:127], v1
    s_waitcnt lgkmcnt(0)
    v_add_f32 v24, v64, v66
    v_mfma_f32_16x16x32_bf16 v[56:59], v[96:99], v[128:131], 0
    v_add_f32 v25, v65, v67
    v_add_f32 v26, v68, v70
    v_mfma_f32_16x16x32_bf16 v[56:59], v[100:103], v[132:135], v[56:59]
    v_add_f32 v27, v69, v71
    v_cvt_pk_bf16_f32 v18, v24, v26
    v_mfma_f32_16x16x32_bf16 v[56:59], v[104:107], v[136:139], v[56:59]
    v_cvt_pk_bf16_f32 v19, v25, v27
    ds_write2_b32 v40, v18, v19 offset0:0 offset1:4
    v_mfma_f32_16x16x32_bf16 v[56:59], v[108:111], v[140:143], v[56:59]
    buffer_load_dwordx4 v9, s[8:11], s75 offen offset:512 sc1 lds
    v_mov_b32 v71, 0
    v_mfma_f32_16x16x32_bf16 v[60:63], v[112:115], v[128:131], 0
    v_mov_b32 v22, 0x3f803f80
    v_mov_b32 v23, 0x3f803f80
    v_mfma_f32_16x16x32_bf16 v[60:63], v[116:119], v[132:135], v[60:63]
    v_mov_b64 v[40:41], 0
    v_mov_b64 v[42:43], 0
    v_mfma_f32_16x16x32_bf16 v[60:63], v[120:123], v[136:139], v[60:63]
    s_add_u32 s75, s75, 262144
    v_mov_b32 v20, 0x3f803f80
    v_mfma_f32_16x16x32_bf16 v[60:63], v[124:127], v[140:143], v[60:63]
    s_waitcnt lgkmcnt(0)
    s_barrier
    ds_read_b128 v[96:99], v12 offset:0
    v_smfmac_f32_16x16x64_bf16 v[72:75], v[32:35], a[128:135], v1
    ds_read_b128 v[100:103], v12 offset:1024
    v_max3_f32 v68, v56, v57, v58
    v_smfmac_f32_16x16x64_bf16 v[76:79], v[32:35], a[136:143], v1
    ds_read_b128 v[104:107], v12 offset:2048
    s_add_u32 s97, s97, 262144
    v_mov_b32 v21, 0x3f803f80
    v_smfmac_f32_16x16x64_bf16 v[72:75], v[36:39], a[144:151], v1
    ds_read_b128 v[108:111], v12 offset:3072
    v_max3_f32 v68, v68, v59, v60
    v_smfmac_f32_16x16x64_bf16 v[76:79], v[36:39], a[152:159], v1
    ds_read_b128 v[112:115], v4 offset:16384
    v_max3_f32 v69, v61, v62, v63
    v_smfmac_f32_16x16x64_bf16 v[72:75], v[44:47], a[176:183], v1
    ds_read_b128 v[116:119], v4 offset:17408
    s_waitcnt lgkmcnt(4)
    v_cndmask_b32 v60, v60, v62, s[80:81]
    v_mfma_f32_16x16x32_bf16 v[64:67], v[96:99], v[128:131], 0
    ds_read_b128 v[120:123], v4 offset:18432
    v_cndmask_b32 v61, v61, v63, s[80:81]
    v_max_f32 v62, v68, v69
    v_mfma_f32_16x16x32_bf16 v[64:67], v[100:103], v[132:135], v[64:67]
    s_waitcnt lgkmcnt(3)
    v_mov_b64 v[24:25], 0
    v_mov_b64 v[26:27], 0
    v_mfma_f32_16x16x32_bf16 v[64:67], v[104:107], v[136:139], v[64:67]
    ds_read_b128 v[124:127], v4 offset:19456
    v_mul_f32 v61, s30, v61
    v_mfma_f32_16x16x32_bf16 v[64:67], v[108:111], v[140:143], v[64:67]
    ds_read_b128 v[96:99], v4 offset:12288
    v_mov_b32 v63, v62
    v_mul_f32 v60, s30, v60
    v_smfmac_f32_16x16x64_bf16 v[76:79], v[44:47], a[184:191], v1
    ds_read_b128 v[100:103], v4 offset:13312
    v_permlane32_swap_b32 v62, v63
    v_smfmac_f32_16x16x64_bf16 v[72:75], v[48:51], a[192:199], v1
    ds_read_b128 v[104:107], v4 offset:14336
    v_max3_f32 v62, v62, v63, v64
    v_smfmac_f32_16x16x64_bf16 v[76:79], v[48:51], a[200:207], v1
    ds_read_b128 v[108:111], v4 offset:15360
    v_max3_f32 v63, v65, v66, v67
    v_max_f32 v62, v62, v63
    v_mov_b32 v63, v62
    v_smfmac_f32_16x16x64_bf16 v[72:75], v[52:55], a[208:215], v1
    ds_read_b128 v[128:131], v4 offset:20480
    v_permlane16_swap_b32 v62, v63
    v_cndmask_b32 v64, v64, v58, s[80:81]
    v_smfmac_f32_16x16x64_bf16 v[76:79], v[52:55], a[216:223], v1
    ds_read_b128 v[132:135], v4 offset:21504
    v_max_f32 v62, v62, v63
    v_cndmask_b32 v65, v65, v59, s[80:81]
    v_mul_f32 v62, s82, v62
    v_cndmask_b32 v66, v66, v56, s[80:81]
    v_cndmask_b32 v67, v67, v57, s[80:81]
    v_sub_f32 v63, v62, v2
    v_pk_add_f32 v[60:61], v[60:61], v[62:63] op_sel:[0,0] op_sel_hi:[1,0]
    v_pk_mul_f32 v[64:65], v[64:65], s[30:31]
    v_exp_f32 v60, v60
    v_pk_mul_f32 v[66:67], v[66:67], s[30:31]
    v_pk_add_f32 v[64:65], v[64:65], v[62:63] op_sel:[0,1] op_sel_hi:[1,1]
    v_pk_add_f32 v[66:67], v[66:67], v[62:63] op_sel:[0,1] op_sel_hi:[1,1]
    v_exp_f32 v61, v61
    v_pk_add_f32 v[56:57], v[72:73], v[74:75]
    v_exp_f32 v64, v64
    v_pk_add_f32 v[58:59], v[76:77], v[78:79]
    v_exp_f32 v65, v65
    v_cvt_pk_bf16_f32 v69, v60, v61
    v_exp_f32 v66, v66
    s_waitcnt vmcnt(6)
    v_cvt_pk_bf16_f32 v80, v56, v57
    v_exp_f32 v67, v67
    v_cvt_pk_bf16_f32 v68, v64, v65
    v_cvt_pk_bf16_f32 v88, v58, v59
    v_cvt_pk_bf16_f32 v70, v66, v67
    ds_read_b128 v[136:139], v4 offset:22528
    s_nop 0
    v_mfma_f32_16x16x32_bf16 v[28:31], v[68:71], v[20:23], 0
    ds_read_b128 v[140:143], v4 offset:23552
    v_smfmac_f32_16x16x64_bf16 v[40:43], v[68:71], v[80:87], v1
    v_mov_b32 v20, v80
    v_smfmac_f32_16x16x64_bf16 v[24:27], v[68:71], v[88:95], v1
    v_mov_b32 v21, v18
    v_mov_b32 v22, v19
    v_mov_b32 v23, v88
    s_nop 0
    v_pk_add_f32 v[62:63], v[28:29], v[30:31]
    v_rcp_f32 v62, v62
    v_rcp_f32 v63, v63
    v_pk_add_f32 v[40:41], v[40:41], v[42:43]
    v_pk_add_f32 v[24:25], v[24:25], v[26:27]
    v_pk_mul_f32 v[40:41], v[40:41], v[62:63]
    v_pk_mul_f32 v[24:25], v[24:25], v[62:63]
    v_cvt_pk_bf16_f32 v56, v40, v24
    v_cvt_pk_bf16_f32 v57, v41, v25
    ds_write2_b32 v13, v56, v57 offset0:0 offset1:4
    v_mov_b64 v[24:25], 0
    v_mov_b64 v[26:27], 0
    v_mov_b64 v[28:29], 0
    v_mov_b64 v[30:31], 0
    v_mov_b64 v[32:33], 0
    v_mov_b64 v[34:35], 0
    v_mov_b64 v[36:37], 0
    v_mov_b64 v[38:39], 0
    s_waitcnt lgkmcnt(0)
    s_barrier
    ds_read_b128 v[72:75], v3 offset:13312
    ds_read_b128 v[76:79], v3 offset:14336
    v_mov_b64 v[40:41], 0
    v_mov_b64 v[42:43], 0
    v_mov_b64 v[44:45], 0
    v_mov_b64 v[46:47], 0
    v_mov_b64 v[48:49], 0
    v_mov_b64 v[50:51], 0
    v_mov_b64 v[52:53], 0
    v_mov_b64 v[54:55], 0
    s_waitcnt lgkmcnt(1)
    v_smfmac_f32_16x16x64_bf16 v[24:27], v[72:75], v[96:103], v1
    ds_read_b128 v[96:99], v4 offset:24576
    v_smfmac_f32_16x16x64_bf16 v[28:31], v[72:75], v[104:111], v1
    s_waitcnt lgkmcnt(1)
    ds_read_b128 v[100:103], v4 offset:25600
    v_smfmac_f32_16x16x64_bf16 v[24:27], v[76:79], v[112:119], v1
    ds_read_b128 v[104:107], v4 offset:26624
    v_smfmac_f32_16x16x64_bf16 v[28:31], v[76:79], v[120:127], v1
    ds_read_b128 v[108:111], v4 offset:27648
    v_smfmac_f32_16x16x64_bf16 v[32:35], v[72:75], v[128:135], v1
    ds_read_b128 v[112:115], v4 offset:28672
    v_smfmac_f32_16x16x64_bf16 v[32:35], v[76:79], v[136:143], v1
    ds_read_b128 v[116:119], v4 offset:29696
    s_nop 0
    v_add_f32 v24, v24, v26
    v_smfmac_f32_16x16x64_bf16 v[36:39], v[72:75], a[224:231], v1
    ds_read_b128 v[120:123], v4 offset:30720
    v_add_f32 v25, v25, v27
    v_smfmac_f32_16x16x64_bf16 v[36:39], v[76:79], a[232:239], v1
    ds_read_b128 v[124:127], v4 offset:31744
    v_add_f32 v28, v28, v30
    v_add_f32 v29, v29, v31
    v_cvt_pk_bf16_f32 v56, v24, v28
    v_cvt_pk_bf16_f32 v58, v25, v29
    v_bfi_b32 v56, 1, s65, v56
    v_pk_add_f32 v[32:33], v[32:33], v[34:35]
    ds_read_b128 v[128:131], v4 offset:32768
    ds_read_b128 v[132:135], v4 offset:33792
    v_pk_add_f32 v[36:37], v[36:37], v[38:39]
    v_cvt_pk_bf16_f32 v57, v32, v36
    v_cvt_pk_bf16_f32 v59, v33, v37
    buffer_store_dwordx4 v[56:59], v5, s[8:11], s70 offen
    v_smfmac_f32_16x16x64_bf16 v[40:43], v[72:75], a[240:247], v1
    ds_read_b128 v[136:139], v4 offset:34816
    v_smfmac_f32_16x16x64_bf16 v[40:43], v[76:79], a[248:255], v1
    ds_read_b128 v[140:143], v4 offset:35840
    s_waitcnt lgkmcnt(8)
    v_smfmac_f32_16x16x64_bf16 v[44:47], v[72:75], v[96:103], v1
    s_mov_b32 s79, s78
    s_add_u32 s78, s78, 131072
    s_mov_b32 s83, 0
    v_smfmac_f32_16x16x64_bf16 v[44:47], v[76:79], v[104:111], v1
    s_waitcnt lgkmcnt(4)
    s_add_u32 s64, s64, 1
    v_smfmac_f32_16x16x64_bf16 v[48:51], v[72:75], v[112:119], v1
    ds_read_b128 v[96:99], v4 offset:0
    v_add_f32 v40, v40, v42
    v_smfmac_f32_16x16x64_bf16 v[48:51], v[76:79], v[120:127], v1
    s_waitcnt lgkmcnt(1)
    v_add_f32 v41, v41, v43
    v_smfmac_f32_16x16x64_bf16 v[52:55], v[72:75], v[128:135], v1
    ds_read_b128 v[100:103], v4 offset:1024
    v_add_f32 v44, v44, v46
    v_smfmac_f32_16x16x64_bf16 v[52:55], v[76:79], v[136:143], v1
    ds_read_b128 v[104:107], v4 offset:2048
    v_add_f32 v45, v45, v47
    v_cvt_pk_bf16_f32 v60, v40, v44
    v_cvt_pk_bf16_f32 v62, v41, v45
    v_bfi_b32 v60, 1, s65, v60
    v_pk_add_f32 v[48:49], v[48:49], v[50:51]
    ds_read_b128 v[108:111], v4 offset:3072
    s_cmp_ge_u32 s61, 2
    v_pk_add_f32 v[52:53], v[52:53], v[54:55]
    v_cvt_pk_bf16_f32 v61, v48, v52
    v_cvt_pk_bf16_f32 v63, v49, v53
    buffer_store_dwordx4 v[60:63], v5, s[8:11], s71 offen
    s_cbranch_scc1 R_late
    s_nop 15
    s_nop 15
    s_nop 7
    buffer_load_dwordx4 v[80:83], v3, s[8:11], s72 offen offset:0 sc1
    buffer_load_dwordx4 v[84:87], v3, s[8:11], s72 offen offset:1024 sc1
R_late:
    ds_read_b128 v[112:115], v4 offset:4096
    ds_read_b128 v[116:119], v4 offset:5120
    ds_read_b128 v[120:123], v4 offset:6144
    ds_read_b128 v[124:127], v4 offset:7168
    ds_read_b128 v[128:131], v4 offset:8192
    ds_read_b128 v[132:135], v4 offset:9216
    ds_read_b128 v[136:139], v4 offset:10240
    ds_read_b128 v[140:143], v4 offset:11264
    v_mov_b32 v68, 0x3f80
    v_cndmask_b32 v68, v68, 1.0, s[28:29]
    v_cndmask_b32 v64, 0, v68, s[24:25]
    v_cndmask_b32 v65, 0, v68, s[26:27]
    v_cndmask_b32 v66, 0, v68, s[24:25]
    v_cndmask_b32 v67, 0, v68, s[26:27]
    v_mov_b64 v[68:69], 0
    v_mov_b64 v[70:71], 0
    s_cbranch_scc0 R_early
    s_nop 15
    s_nop 15
    s_nop 15
    buffer_load_dwordx4 v[80:83], v3, s[8:11], s72 offen offset:0 sc1
    buffer_load_dwordx4 v[84:87], v3, s[8:11], s72 offen offset:1024 sc1
R_early:
    v_mov_b64 v[76:77], 0
    v_mov_b64 v[78:79], 0
    v_mov_b64 v[56:57], 0
    v_mov_b64 v[58:59], 0
    v_mov_b64 v[60:61], 0
    v_mov_b64 v[62:63], 0
    v_mov_b32 v74, -1
    v_mov_b32 v75, -1
    s_nop 15
    s_nop 7
    buffer_load_dwordx4 v[32:35], v3, s[8:11], s72 offen offset:0 sc1
    buffer_load_dwordx4 v[36:39], v3, s[8:11], s72 offen offset:1024 sc1
    s_waitcnt vmcnt(2) lgkmcnt(0)
R_chk1:
    v_smfmac_f32_16x16x64_bf16 v[68:71], v[64:67], v[80:87], v1
    v_bitop3_b32 v72, v80, v84, s65 bitop3:0x7e
    v_and_b32 v72, 1, v72
    v_cmp_ne_u32 vcc, 0, v72
    s_nop 4
    v_add_f32_dpp v88, v68, v68 row_ror:4 row_mask:0xf bank_mask:0xf
    v_add_f32_dpp v89, v69, v69 row_ror:4 row_mask:0xf bank_mask:0xf
    v_add_f32_dpp v90, v70, v70 row_ror:4 row_mask:0xf bank_mask:0xf
    v_add_f32_dpp v91, v71, v71 row_ror:4 row_mask:0xf bank_mask:0xf
    s_cbranch_vccnz R_slow1
R_ok1:
    v_add_f32_dpp v92, v88, v88 row_ror:8 row_mask:0xf bank_mask:0xf
    v_add_f32_dpp v93, v89, v89 row_ror:8 row_mask:0xf bank_mask:0xf
    v_add_f32_dpp v94, v90, v90 row_ror:8 row_mask:0xf bank_mask:0xf
    v_add_f32_dpp v95, v91, v91 row_ror:8 row_mask:0xf bank_mask:0xf
    s_mov_b64 exec, 0x000f000f
    v_cvt_pk_bf16_f32 v72, v92, v93
    v_cvt_pk_bf16_f32 v73, v94, v95
    v_min_u32 v72, -2, v72
    buffer_store_dwordx2 v[72:73], v7, s[8:11], s88 offen
    buffer_store_dwordx2 v[74:75], v7, s[8:11], s90 offen
    s_mov_b64 exec, -1
    s_add_u32 s67, s67, s83
    s_mov_b32 s83, 0
    v_mov_b64 v[64:65], 0
    v_mov_b64 v[66:67], 0
    v_mov_b64 v[68:69], 0
    v_mov_b64 v[70:71], 0
    v_mov_b64 v[72:73], 0
    v_mov_b64 v[74:75], 0
    s_nop 15
    s_barrier
    s_branch R_loop
R_slow1:
    buffer_load_dwordx4 v[80:83], v3, s[8:11], s72 offen offset:0 sc1
    buffer_load_dwordx4 v[84:87], v3, s[8:11], s72 offen offset:1024 sc1
    s_add_u32 s83, s83, 1
    s_cmp_gt_u32 s83, 0x100000
    s_cbranch_scc1 R_fail
    v_mov_b64 v[68:69], 0
    v_mov_b64 v[70:71], 0
    s_waitcnt vmcnt(2)
    s_nop 0
    v_smfmac_f32_16x16x64_bf16 v[68:71], v[64:67], v[32:39], v1
    v_bitop3_b32 v72, v32, v36, s65 bitop3:0x7e
    v_and_b32 v72, 1, v72
    v_cmp_ne_u32 vcc, 0, v72
    s_nop 4
    v_add_f32_dpp v88, v68, v68 row_ror:4 row_mask:0xf bank_mask:0xf
    v_add_f32_dpp v89, v69, v69 row_ror:4 row_mask:0xf bank_mask:0xf
    v_add_f32_dpp v90, v70, v70 row_ror:4 row_mask:0xf bank_mask:0xf
    v_add_f32_dpp v91, v71, v71 row_ror:4 row_mask:0xf bank_mask:0xf
    s_cbranch_vccnz R_slow2
    s_branch R_ok1
R_slow2:
    buffer_load_dwordx4 v[32:35], v3, s[8:11], s72 offen offset:0 sc1
    buffer_load_dwordx4 v[36:39], v3, s[8:11], s72 offen offset:1024 sc1
    s_add_u32 s83, s83, 1
    s_cmp_gt_u32 s83, 0x100000
    s_cbranch_scc1 R_fail
    v_mov_b64 v[68:69], 0
    v_mov_b64 v[70:71], 0
    s_waitcnt vmcnt(2)
    s_branch R_chk1
R_kvwait:
    buffer_load_dword v17, v3, s[8:11], s73 offen sc1
    s_add_u32 s83, s83, 1
    s_cmp_gt_u32 s83, 0x100000
    s_cbranch_scc1 R_fail
    s_waitcnt vmcnt(0)
    v_cmp_eq_u32 vcc, 0, v17
    s_nop 1
    s_and_b32 s84, vcc_lo, 3
    s_cbranch_scc1 R_kvwait
    s_branch R_kvok
R_done:
    buffer_store_dwordx4 v[20:23], v3, s[8:11], s79 offen sc1
    s_waitcnt lgkmcnt(0)
    v_smfmac_f32_16x16x64_bf16 v[64:67], v[28:31], a[0:7], v1
    v_smfmac_f32_16x16x64_bf16 v[68:71], v[28:31], a[8:15], v1
    v_smfmac_f32_16x16x64_bf16 v[72:75], v[28:31], a[112:119], v1
    v_smfmac_f32_16x16x64_bf16 v[76:79], v[28:31], a[120:127], v1
    v_smfmac_f32_16x16x64_bf16 v[64:67], v[32:35], a[16:23], v1
    v_smfmac_f32_16x16x64_bf16 v[68:71], v[32:35], a[24:31], v1
    v_smfmac_f32_16x16x64_bf16 v[72:75], v[32:35], a[128:135], v1
    v_smfmac_f32_16x16x64_bf16 v[76:79], v[32:35], a[136:143], v1
    v_smfmac_f32_16x16x64_bf16 v[64:67], v[36:39], a[32:39], v1
    v_smfmac_f32_16x16x64_bf16 v[68:71], v[36:39], a[40:47], v1
    v_smfmac_f32_16x16x64_bf16 v[72:75], v[36:39], a[144:151], v1
    v_smfmac_f32_16x16x64_bf16 v[76:79], v[36:39], a[152:159], v1
    v_smfmac_f32_16x16x64_bf16 v[64:67], v[44:47], a[64:71], v1
    v_smfmac_f32_16x16x64_bf16 v[68:71], v[44:47], a[72:79], v1
    v_smfmac_f32_16x16x64_bf16 v[72:75], v[44:47], a[176:183], v1
    v_smfmac_f32_16x16x64_bf16 v[76:79], v[44:47], a[184:191], v1
    v_smfmac_f32_16x16x64_bf16 v[64:67], v[48:51], a[80:87], v1
    v_smfmac_f32_16x16x64_bf16 v[68:71], v[48:51], a[88:95], v1
    v_smfmac_f32_16x16x64_bf16 v[72:75], v[48:51], a[192:199], v1
    v_smfmac_f32_16x16x64_bf16 v[76:79], v[48:51], a[200:207], v1
    v_smfmac_f32_16x16x64_bf16 v[64:67], v[52:55], a[96:103], v1
    v_smfmac_f32_16x16x64_bf16 v[68:71], v[52:55], a[104:111], v1
    v_smfmac_f32_16x16x64_bf16 v[72:75], v[52:55], a[208:215], v1
    v_smfmac_f32_16x16x64_bf16 v[76:79], v[52:55], a[216:223], v1
    s_nop 4
    v_pk_add_f32 v[96:97], v[64:65], v[66:67]
    v_pk_add_f32 v[98:99], v[68:69], v[70:71]
    v_pk_add_f32 v[100:101], v[72:73], v[74:75]
    v_pk_add_f32 v[102:103], v[76:77], v[78:79]
    v_cvt_pk_bf16_f32 v105, v96, v98
    v_cvt_pk_bf16_f32 v106, v97, v99
    v_cvt_pk_bf16_f32 v104, v100, v101
    v_cvt_pk_bf16_f32 v107, v102, v103
    buffer_store_dwordx4 v[104:107], v3, s[8:11], s78 offen sc1
    s_waitcnt vmcnt(0)
    v_mov_b32 v21, 64
    s_mov_b64 exec, 1
    buffer_store_dword v21, v3, s[8:11], s94 offen sc1
    s_endpgm
R_fail:
    s_mov_b64 exec, 1
    v_mov_b32 v22, 16
    v_mov_b32 v23, s64
    v_or_b32 v23, 0x40000000, v23
    buffer_store_dword v23, v22, s[12:15], 0 offen sc1
    s_endpgm
R_safe:
    s_waitcnt lgkmcnt(0)
    s_barrier
    s_mov_b32 m0, s92
    s_nop 0
    buffer_load_dwordx4 v9, s[8:11], s75 offen sc1 lds
    s_mov_b32 m0, s93
    s_nop 0
    buffer_load_dwordx4 v9, s[8:11], s75 offen offset:512 sc1 lds
    buffer_load_dword v17, v3, s[8:11], s73 offen sc1
    s_add_u32 s75, s75, 262144
    v_mov_b64 v[20:21], 0
    v_mov_b64 v[22:23], 0
    v_mov_b64 v[56:57], 0
    v_mov_b64 v[58:59], 0
    v_mov_b64 v[60:61], 0
    v_mov_b64 v[62:63], 0
    v_mov_b64 v[64:65], 0
    v_mov_b64 v[66:67], 0
    v_mov_b64 v[68:69], 0
    v_mov_b64 v[70:71], 0
    v_mov_b64 v[72:73], 0
    v_mov_b64 v[74:75], 0
    v_mov_b64 v[76:77], 0
    v_mov_b64 v[78:79], 0
    s_mov_b32 s83, 0
    s_add_u32 s98, s66, 4096
RS_loop:
RS_repoll:
    buffer_load_dwordx4 v[24:27], v3, s[8:11], s66 offen sc1
    buffer_load_dwordx4 v[40:43], v3, s[8:11], s98 offen sc1
    s_nop 15
    s_nop 15
    s_nop 3
    buffer_load_dwordx4 v[80:83], v3, s[8:11], s66 offen sc1
    buffer_load_dwordx4 v[84:87], v3, s[8:11], s98 offen sc1
    s_branch RS_goA
RS_badA:
    buffer_load_dwordx4 v[24:27], v3, s[8:11], s66 offen sc1
    buffer_load_dwordx4 v[40:43], v3, s[8:11], s98 offen sc1
    s_add_u32 s83, s83, 1
    s_cmp_gt_u32 s83, 0x100000
    s_cbranch_scc1 RS_fail
    s_add_u32 s67, s67, 0x10000
    s_nop 1
    v_mov_b64 v[56:57], 0
    v_mov_b64 v[58:59], 0
    v_mov_b64 v[60:61], 0
    v_mov_b64 v[62:63], 0
    s_waitcnt vmcnt(3)
    ds_write_b128 v0, v[80:83]
    v_max_u32 v18, v80, v82
    v_smfmac_f32_16x16x64_bf16 v[56:59], v[80:83], v[96:103], v1
    s_waitcnt vmcnt(2)
    ds_write_b128 v0, v[84:87] offset:4096
    v_max3_u32 v18, v18, v84, v86
    v_cmp_eq_u32 vcc, -1, v18
    v_smfmac_f32_16x16x64_bf16 v[60:63], v[80:83], v[104:111], v1
    v_smfmac_f32_16x16x64_bf16 v[56:59], v[84:87], v[192:199], v1
    s_cbranch_vccnz RS_badB
    v_smfmac_f32_16x16x64_bf16 v[60:63], v[84:87], v[200:207], v1
    v_smfmac_f32_16x16x64_bf16 v[64:67], v[80:83], v[112:119], v1
    v_smfmac_f32_16x16x64_bf16 v[68:71], v[80:83], v[120:127], v1
    s_waitcnt lgkmcnt(0)
    s_barrier
    ds_read_b128 v[28:31], v6 offset:0
    v_smfmac_f32_16x16x64_bf16 v[64:67], v[84:87], a[48:55], v1
    ds_read_b128 v[32:35], v14 offset:0
    v_smfmac_f32_16x16x64_bf16 v[68:71], v[84:87], a[56:63], v1
    ds_read_b128 v[36:39], v15 offset:0
    v_smfmac_f32_16x16x64_bf16 v[72:75], v[80:83], v[128:135], v1
    ds_read_b128 v[44:47], v6 offset:4096
    v_smfmac_f32_16x16x64_bf16 v[76:79], v[80:83], v[136:143], v1
    ds_read_b128 v[48:51], v14 offset:4096
    v_smfmac_f32_16x16x64_bf16 v[72:75], v[84:87], a[160:167], v1
    ds_read_b128 v[52:55], v15 offset:4096
    v_smfmac_f32_16x16x64_bf16 v[76:79], v[84:87], a[168:175], v1
    s_branch RS_join
RS_badB:
    buffer_load_dwordx4 v[80:83], v3, s[8:11], s66 offen sc1
    buffer_load_dwordx4 v[84:87], v3, s[8:11], s98 offen sc1
    s_add_u32 s67, s67, 0x10000
    s_nop 4
    v_mov_b64 v[56:57], 0
    v_mov_b64 v[58:59], 0
    v_mov_b64 v[60:61], 0
    v_mov_b64 v[62:63], 0
RS_goA:
    s_waitcnt vmcnt(3)
    ds_write_b128 v0, v[24:27]
    v_max_u32 v18, v24, v26
    v_smfmac_f32_16x16x64_bf16 v[56:59], v[24:27], v[96:103], v1
    s_waitcnt vmcnt(2)
    ds_write_b128 v0, v[40:43] offset:4096
    v_max3_u32 v18, v18, v40, v42
    v_cmp_eq_u32 vcc, -1, v18
    v_smfmac_f32_16x16x64_bf16 v[60:63], v[24:27], v[104:111], v1
    v_smfmac_f32_16x16x64_bf16 v[56:59], v[40:43], v[192:199], v1
    s_cbranch_vccnz RS_badA
    v_smfmac_f32_16x16x64_bf16 v[60:63], v[40:43], v[200:207], v1
    v_smfmac_f32_16x16x64_bf16 v[64:67], v[24:27], v[112:119], v1
    v_smfmac_f32_16x16x64_bf16 v[68:71], v[24:27], v[120:127], v1
    s_waitcnt lgkmcnt(0)
    s_barrier
    ds_read_b128 v[28:31], v6 offset:0
    v_smfmac_f32_16x16x64_bf16 v[64:67], v[40:43], a[48:55], v1
    ds_read_b128 v[32:35], v14 offset:0
    v_smfmac_f32_16x16x64_bf16 v[68:71], v[40:43], a[56:63], v1
    ds_read_b128 v[36:39], v15 offset:0
    v_smfmac_f32_16x16x64_bf16 v[72:75], v[24:27], v[128:135], v1
    ds_read_b128 v[44:47], v6 offset:4096
    v_smfmac_f32_16x16x64_bf16 v[76:79], v[24:27], v[136:143], v1
    ds_read_b128 v[48:51], v14 offset:4096
    v_smfmac_f32_16x16x64_bf16 v[72:75], v[40:43], a[160:167], v1
    ds_read_b128 v[52:55], v15 offset:4096
    v_smfmac_f32_16x16x64_bf16 v[76:79], v[40:43], a[168:175], v1
RS_join:
    s_cmp_eq_u32 s64, 63
    s_cbranch_scc1 RS_done
    ds_read_b128 v[96:99], v3 offset:0
    s_waitcnt lgkmcnt(5)
    v_smfmac_f32_16x16x64_bf16 v[56:59], v[28:31], v[144:151], v1
    buffer_load_dwordx4 v[80:83], v8, s[8:11], s76 offen offset:0 sc1
    s_sub_u32 s84, s64, 1
    v_smfmac_f32_16x16x64_bf16 v[60:63], v[28:31], v[152:159], v1
    ds_read_b128 v[100:103], v3 offset:1024
    s_max_i32 s84, s84, 0
    v_mov_b32 v19, s84
    v_smfmac_f32_16x16x64_bf16 v[56:59], v[32:35], v[160:167], v1
    buffer_load_dwordx4 v[84:87], v8, s[8:11], s76 offen offset:512 sc1
    v_cmp_eq_u32 vcc, 0, v17
    v_smfmac_f32_16x16x64_bf16 v[60:63], v[32:35], v[168:175], v1
    ds_read_b128 v[104:107], v3 offset:2048
    s_waitcnt lgkmcnt(5)
    v_smfmac_f32_16x16x64_bf16 v[56:59], v[36:39], v[176:183], v1
    buffer_load_dwordx4 v[88:91], v8, s[8:11], s76 offen offset:1024 sc1
    v_smfmac_f32_16x16x64_bf16 v[60:63], v[36:39], v[184:191], v1
    ds_read_b128 v[108:111], v3 offset:3072
    s_and_b32 s84, vcc_lo, 3
    s_cbranch_scc1 RS_kvwait
RS_kvok:
    v_smfmac_f32_16x16x64_bf16 v[56:59], v[44:47], v[208:215], v1
    buffer_load_dwordx4 v[92:95], v8, s[8:11], s76 offen offset:1536 sc1
    s_add_u32 s73, s73, 32
    v_smfmac_f32_16x16x64_bf16 v[60:63], v[44:47], v[216:223], v1
    ds_read_b128 v[112:115], v3 offset:4096
    s_waitcnt lgkmcnt(5)
    v_smfmac_f32_16x16x64_bf16 v[56:59], v[48:51], v[224:231], v1
    s_barrier
    s_mov_b64 exec, 3
    buffer_store_dword v19, v3, s[8:11], s94 offen sc1
    s_mov_b64 exec, -1
    v_smfmac_f32_16x16x64_bf16 v[60:63], v[48:51], v[232:239], v1
    buffer_store_dwordx4 v[20:23], v3, s[8:11], s79 offen sc1
    v_smfmac_f32_16x16x64_bf16 v[56:59], v[52:55], v[240:247], v1
    ds_read_b128 v[116:119], v3 offset:5120
    s_min_u32 s73, s73, s77
    v_smfmac_f32_16x16x64_bf16 v[60:63], v[52:55], v[248:255], v1
    ds_read_b128 v[120:123], v3 offset:6144
    s_add_u32 s76, s76, 262144
    v_smfmac_f32_16x16x64_bf16 v[64:67], v[28:31], a[0:7], v1
    ds_read_b128 v[124:127], v3 offset:7168
    s_waitcnt vmcnt(6)
    v_smfmac_f32_16x16x64_bf16 v[68:71], v[28:31], a[8:15], v1
    s_mov_b32 s84, s88
    s_mov_b32 s88, s89
    v_add_f32 v24, v56, v58
    v_smfmac_f32_16x16x64_bf16 v[64:67], v[32:35], a[16:23], v1
    v_add_f32 v25, v57, v59
    v_add_f32 v26, v60, v62
    v_add_f32 v27, v61, v63
    v_cvt_pk_bf16_f32 v24, v24, v26
    v_cvt_pk_bf16_f32 v25, v25, v27
    ds_write2_b32 v10, v24, v25 offset0:0 offset1:4
    v_smfmac_f32_16x16x64_bf16 v[68:71], v[32:35], a[24:31], v1
    buffer_load_dword v17, v16, s[8:11], s97 offen sc1
    s_mov_b32 s89, s90
    v_smfmac_f32_16x16x64_bf16 v[64:67], v[36:39], a[32:39], v1
    s_mov_b32 s90, s91
    s_mov_b32 s91, s84
    v_smfmac_f32_16x16x64_bf16 v[68:71], v[36:39], a[40:47], v1
    s_mov_b64 exec, 3
    buffer_load_dword v17, v3, s[8:11], s73 offen sc1
    s_mov_b64 exec, -1
    v_smfmac_f32_16x16x64_bf16 v[64:67], v[44:47], a[64:71], v1
    s_add_u32 s66, s88, s68
    s_and_b32 s65, s64, 1
    v_smfmac_f32_16x16x64_bf16 v[68:71], v[44:47], a[72:79], v1
    s_waitcnt lgkmcnt(0)
    s_barrier
    ds_read_b128 v[128:131], v11 offset:0
    v_smfmac_f32_16x16x64_bf16 v[64:67], v[48:51], a[80:87], v1
    ds_read_b128 v[132:135], v11 offset:1024
    v_smfmac_f32_16x16x64_bf16 v[68:71], v[48:51], a[88:95], v1
    ds_read_b128 v[136:139], v11 offset:2048
    v_smfmac_f32_16x16x64_bf16 v[64:67], v[52:55], a[96:103], v1
    ds_read_b128 v[140:143], v11 offset:3072
    s_mov_b32 m0, s92
    v_smfmac_f32_16x16x64_bf16 v[68:71], v[52:55], a[104:111], v1
    s_add_u32 s98, s66, 4096
    v_smfmac_f32_16x16x64_bf16 v[72:75], v[28:31], a[112:119], v1
    buffer_load_dwordx4 v9, s[8:11], s75 offen sc1 lds
    s_mov_b32 m0, s93
    v_xor_b32 v40, 128, v10
    v_smfmac_f32_16x16x64_bf16 v[76:79], v[28:31], a[120:127], v1
    s_waitcnt lgkmcnt(0)
    v_add_f32 v24, v64, v66
    v_mfma_f32_16x16x32_bf16 v[56:59], v[96:99], v[128:131], 0
    v_add_f32 v25, v65, v67
    v_add_f32 v26, v68, v70
    v_mfma_f32_16x16x32_bf16 v[56:59], v[100:103], v[132:135], v[56:59]
    v_add_f32 v27, v69, v71
    v_cvt_pk_bf16_f32 v18, v24, v26
    v_mfma_f32_16x16x32_bf16 v[56:59], v[104:107], v[136:139], v[56:59]
    v_cvt_pk_bf16_f32 v19, v25, v27
    ds_write2_b32 v40, v18, v19 offset0:0 offset1:4
    v_mfma_f32_16x16x32_bf16 v[56:59], v[108:111], v[140:143], v[56:59]
    buffer_load_dwordx4 v9, s[8:11], s75 offen offset:512 sc1 lds
    v_mov_b32 v71, 0
    v_mfma_f32_16x16x32_bf16 v[60:63], v[112:115], v[128:131], 0
    v_mov_b32 v22, 0x3f803f80
    v_mov_b32 v23, 0x3f803f80
    v_mfma_f32_16x16x32_bf16 v[60:63], v[116:119], v[132:135], v[60:63]
    v_mov_b64 v[40:41], 0
    v_mov_b64 v[42:43], 0
    v_mfma_f32_16x16x32_bf16 v[60:63], v[120:123], v[136:139], v[60:63]
    s_add_u32 s75, s75, 262144
    v_mov_b32 v20, 0x3f803f80
    v_mfma_f32_16x16x32_bf16 v[60:63], v[124:127], v[140:143], v[60:63]
    s_waitcnt lgkmcnt(0)
    s_barrier
    ds_read_b128 v[96:99], v12 offset:0
    v_smfmac_f32_16x16x64_bf16 v[72:75], v[32:35], a[128:135], v1
    ds_read_b128 v[100:103], v12 offset:1024
    v_max3_f32 v68, v56, v57, v58
    v_smfmac_f32_16x16x64_bf16 v[76:79], v[32:35], a[136:143], v1
    ds_read_b128 v[104:107], v12 offset:2048
    s_add_u32 s97, s97, 262144
    v_mov_b32 v21, 0x3f803f80
    v_smfmac_f32_16x16x64_bf16 v[72:75], v[36:39], a[144:151], v1
    ds_read_b128 v[108:111], v12 offset:3072
    v_max3_f32 v68, v68, v59, v60
    v_smfmac_f32_16x16x64_bf16 v[76:79], v[36:39], a[152:159], v1
    ds_read_b128 v[112:115], v4 offset:16384
    v_max3_f32 v69, v61, v62, v63
    v_smfmac_f32_16x16x64_bf16 v[72:75], v[44:47], a[176:183], v1
    ds_read_b128 v[116:119], v4 offset:17408
    s_waitcnt lgkmcnt(4)
    v_cndmask_b32 v60, v60, v62, s[80:81]
    v_mfma_f32_16x16x32_bf16 v[64:67], v[96:99], v[128:131], 0
    ds_read_b128 v[120:123], v4 offset:18432
    v_cndmask_b32 v61, v61, v63, s[80:81]
    v_max_f32 v62, v68, v69
    v_mfma_f32_16x16x32_bf16 v[64:67], v[100:103], v[132:135], v[64:67]
    s_waitcnt lgkmcnt(3)
    v_mov_b64 v[24:25], 0
    v_mov_b64 v[26:27], 0
    v_mfma_f32_16x16x32_bf16 v[64:67], v[104:107], v[136:139], v[64:67]
    ds_read_b128 v[124:127], v4 offset:19456
    v_mul_f32 v61, s30, v61
    v_mfma_f32_16x16x32_bf16 v[64:67], v[108:111], v[140:143], v[64:67]
    ds_read_b128 v[96:99], v4 offset:12288
    v_mov_b32 v63, v62
    v_mul_f32 v60, s30, v60
    v_smfmac_f32_16x16x64_bf16 v[76:79], v[44:47], a[184:191], v1
    ds_read_b128 v[100:103], v4 offset:13312
    v_permlane32_swap_b32 v62, v63
    v_smfmac_f32_16x16x64_bf16 v[72:75], v[48:51], a[192:199], v1
    ds_read_b128 v[104:107], v4 offset:14336
    v_max3_f32 v62, v62, v63, v64
    v_smfmac_f32_16x16x64_bf16 v[76:79], v[48:51], a[200:207], v1
    ds_read_b128 v[108:111], v4 offset:15360
    v_max3_f32 v63, v65, v66, v67
    v_max_f32 v62, v62, v63
    v_mov_b32 v63, v62
    v_smfmac_f32_16x16x64_bf16 v[72:75], v[52:55], a[208:215], v1
    ds_read_b128 v[128:131], v4 offset:20480
    v_permlane16_swap_b32 v62, v63
    v_cndmask_b32 v64, v64, v58, s[80:81]
    v_smfmac_f32_16x16x64_bf16 v[76:79], v[52:55], a[216:223], v1
    ds_read_b128 v[132:135], v4 offset:21504
    v_max_f32 v62, v62, v63
    v_cndmask_b32 v65, v65, v59, s[80:81]
    v_mul_f32 v62, s82, v62
    v_cndmask_b32 v66, v66, v56, s[80:81]
    v_cndmask_b32 v67, v67, v57, s[80:81]
    v_sub_f32 v63, v62, v2
    v_pk_add_f32 v[60:61], v[60:61], v[62:63] op_sel:[0,0] op_sel_hi:[1,0]
    v_pk_mul_f32 v[64:65], v[64:65], s[30:31]
    v_exp_f32 v60, v60
    v_pk_mul_f32 v[66:67], v[66:67], s[30:31]
    v_pk_add_f32 v[64:65], v[64:65], v[62:63] op_sel:[0,1] op_sel_hi:[1,1]
    v_pk_add_f32 v[66:67], v[66:67], v[62:63] op_sel:[0,1] op_sel_hi:[1,1]
    v_exp_f32 v61, v61
    v_pk_add_f32 v[56:57], v[72:73], v[74:75]
    v_exp_f32 v64, v64
    v_pk_add_f32 v[58:59], v[76:77], v[78:79]
    v_exp_f32 v65, v65
    v_cvt_pk_bf16_f32 v69, v60, v61
    v_exp_f32 v66, v66
    s_waitcnt vmcnt(6)
    v_cvt_pk_bf16_f32 v80, v56, v57
    v_exp_f32 v67, v67
    v_cvt_pk_bf16_f32 v68, v64, v65
    v_cvt_pk_bf16_f32 v88, v58, v59
    v_cvt_pk_bf16_f32 v70, v66, v67
    ds_read_b128 v[136:139], v4 offset:22528
    s_nop 0
    v_mfma_f32_16x16x32_bf16 v[28:31], v[68:71], v[20:23], 0
    ds_read_b128 v[140:143], v4 offset:23552
    v_smfmac_f32_16x16x64_bf16 v[40:43], v[68:71], v[80:87], v1
    v_mov_b32 v20, v80
    v_smfmac_f32_16x16x64_bf16 v[24:27], v[68:71], v[88:95], v1
    v_mov_b32 v21, v18
    v_mov_b32 v22, v19
    v_mov_b32 v23, v88
    s_nop 0
    v_pk_add_f32 v[62:63], v[28:29], v[30:31]
    v_rcp_f32 v62, v62
    v_rcp_f32 v63, v63
    v_pk_add_f32 v[40:41], v[40:41], v[42:43]
    v_pk_add_f32 v[24:25], v[24:25], v[26:27]
    v_pk_mul_f32 v[40:41], v[40:41], v[62:63]
    v_pk_mul_f32 v[24:25], v[24:25], v[62:63]
    v_cvt_pk_bf16_f32 v56, v40, v24
    v_cvt_pk_bf16_f32 v57, v41, v25
    ds_write2_b32 v13, v56, v57 offset0:0 offset1:4
    v_mov_b64 v[24:25], 0
    v_mov_b64 v[26:27], 0
    v_mov_b64 v[28:29], 0
    v_mov_b64 v[30:31], 0
    v_mov_b64 v[32:33], 0
    v_mov_b64 v[34:35], 0
    v_mov_b64 v[36:37], 0
    v_mov_b64 v[38:39], 0
    s_waitcnt lgkmcnt(0)
    s_barrier
    ds_read_b128 v[72:75], v3 offset:13312
    ds_read_b128 v[76:79], v3 offset:14336
    v_mov_b64 v[40:41], 0
    v_mov_b64 v[42:43], 0
    v_mov_b64 v[44:45], 0
    v_mov_b64 v[46:47], 0
    v_mov_b64 v[48:49], 0
    v_mov_b64 v[50:51], 0
    v_mov_b64 v[52:53], 0
    v_mov_b64 v[54:55], 0
    s_waitcnt lgkmcnt(1)
    v_smfmac_f32_16x16x64_bf16 v[24:27], v[72:75], v[96:103], v1
    ds_read_b128 v[96:99], v4 offset:24576
    v_smfmac_f32_16x16x64_bf16 v[28:31], v[72:75], v[104:111], v1
    s_waitcnt lgkmcnt(1)
    ds_read_b128 v[100:103], v4 offset:25600
    v_smfmac_f32_16x16x64_bf16 v[24:27], v[76:79], v[112:119], v1
    ds_read_b128 v[104:107], v4 offset:26624
    v_smfmac_f32_16x16x64_bf16 v[28:31], v[76:79], v[120:127], v1
    ds_read_b128 v[108:111], v4 offset:27648
    v_smfmac_f32_16x16x64_bf16 v[32:35], v[72:75], v[128:135], v1
    ds_read_b128 v[112:115], v4 offset:28672
    v_smfmac_f32_16x16x64_bf16 v[32:35], v[76:79], v[136:143], v1
    ds_read_b128 v[116:119], v4 offset:29696
    s_nop 0
    v_add_f32 v24, v24, v26
    v_smfmac_f32_16x16x64_bf16 v[36:39], v[72:75], a[224:231], v1
    ds_read_b128 v[120:123], v4 offset:30720
    v_add_f32 v25, v25, v27
    v_smfmac_f32_16x16x64_bf16 v[36:39], v[76:79], a[232:239], v1
    ds_read_b128 v[124:127], v4 offset:31744
    v_add_f32 v28, v28, v30
    v_add_f32 v29, v29, v31
    v_cvt_pk_bf16_f32 v56, v24, v28
    v_cvt_pk_bf16_f32 v58, v25, v29
    v_bfi_b32 v56, 1, s65, v56
    v_pk_add_f32 v[32:33], v[32:33], v[34:35]
    ds_read_b128 v[128:131], v4 offset:32768
    ds_read_b128 v[132:135], v4 offset:33792
    v_pk_add_f32 v[36:37], v[36:37], v[38:39]
    v_cvt_pk_bf16_f32 v57, v32, v36
    v_cvt_pk_bf16_f32 v59, v33, v37
    buffer_store_dwordx4 v[56:59], v5, s[8:11], s70 offen sc1
    v_smfmac_f32_16x16x64_bf16 v[40:43], v[72:75], a[240:247], v1
    ds_read_b128 v[136:139], v4 offset:34816
    v_smfmac_f32_16x16x64_bf16 v[40:43], v[76:79], a[248:255], v1
    ds_read_b128 v[140:143], v4 offset:35840
    s_waitcnt lgkmcnt(8)
    v_smfmac_f32_16x16x64_bf16 v[44:47], v[72:75], v[96:103], v1
    s_mov_b32 s79, s78
    s_add_u32 s78, s78, 131072
    s_mov_b32 s83, 0
    v_smfmac_f32_16x16x64_bf16 v[44:47], v[76:79], v[104:111], v1
    s_waitcnt lgkmcnt(4)
    s_add_u32 s64, s64, 1
    v_smfmac_f32_16x16x64_bf16 v[48:51], v[72:75], v[112:119], v1
    ds_read_b128 v[96:99], v4 offset:0
    v_add_f32 v40, v40, v42
    v_smfmac_f32_16x16x64_bf16 v[48:51], v[76:79], v[120:127], v1
    s_waitcnt lgkmcnt(1)
    v_add_f32 v41, v41, v43
    v_smfmac_f32_16x16x64_bf16 v[52:55], v[72:75], v[128:135], v1
    ds_read_b128 v[100:103], v4 offset:1024
    v_add_f32 v44, v44, v46
    v_smfmac_f32_16x16x64_bf16 v[52:55], v[76:79], v[136:143], v1
    ds_read_b128 v[104:107], v4 offset:2048
    v_add_f32 v45, v45, v47
    v_cvt_pk_bf16_f32 v60, v40, v44
    v_cvt_pk_bf16_f32 v62, v41, v45
    v_bfi_b32 v60, 1, s65, v60
    v_pk_add_f32 v[48:49], v[48:49], v[50:51]
    ds_read_b128 v[108:111], v4 offset:3072
    s_cmp_ge_u32 s61, 2
    v_pk_add_f32 v[52:53], v[52:53], v[54:55]
    v_cvt_pk_bf16_f32 v61, v48, v52
    v_cvt_pk_bf16_f32 v63, v49, v53
    buffer_store_dwordx4 v[60:63], v5, s[8:11], s71 offen sc1
    s_cbranch_scc1 RS_late
    s_nop 15
    s_nop 15
    s_nop 7
    buffer_load_dwordx4 v[80:83], v3, s[8:11], s72 offen offset:0 sc1
    buffer_load_dwordx4 v[84:87], v3, s[8:11], s72 offen offset:1024 sc1
RS_late:
    ds_read_b128 v[112:115], v4 offset:4096
    ds_read_b128 v[116:119], v4 offset:5120
    ds_read_b128 v[120:123], v4 offset:6144
    ds_read_b128 v[124:127], v4 offset:7168
    ds_read_b128 v[128:131], v4 offset:8192
    ds_read_b128 v[132:135], v4 offset:9216
    ds_read_b128 v[136:139], v4 offset:10240
    ds_read_b128 v[140:143], v4 offset:11264
    v_mov_b32 v68, 0x3f80
    v_cndmask_b32 v68, v68, 1.0, s[28:29]
    v_cndmask_b32 v64, 0, v68, s[24:25]
    v_cndmask_b32 v65, 0, v68, s[26:27]
    v_cndmask_b32 v66, 0, v68, s[24:25]
    v_cndmask_b32 v67, 0, v68, s[26:27]
    v_mov_b64 v[68:69], 0
    v_mov_b64 v[70:71], 0
    s_cbranch_scc0 RS_early
    s_nop 15
    s_nop 15
    s_nop 15
    buffer_load_dwordx4 v[80:83], v3, s[8:11], s72 offen offset:0 sc1
    buffer_load_dwordx4 v[84:87], v3, s[8:11], s72 offen offset:1024 sc1
RS_early:
    v_mov_b64 v[76:77], 0
    v_mov_b64 v[78:79], 0
    v_mov_b64 v[56:57], 0
    v_mov_b64 v[58:59], 0
    v_mov_b64 v[60:61], 0
    v_mov_b64 v[62:63], 0
    v_mov_b32 v74, -1
    v_mov_b32 v75, -1
    s_nop 15
    s_nop 7
    buffer_load_dwordx4 v[32:35], v3, s[8:11], s72 offen offset:0 sc1
    buffer_load_dwordx4 v[36:39], v3, s[8:11], s72 offen offset:1024 sc1
    s_waitcnt vmcnt(2) lgkmcnt(0)
RS_chk1:
    v_smfmac_f32_16x16x64_bf16 v[68:71], v[64:67], v[80:87], v1
    v_bitop3_b32 v72, v80, v84, s65 bitop3:0x7e
    v_and_b32 v72, 1, v72
    v_cmp_ne_u32 vcc, 0, v72
    s_nop 4
    v_add_f32_dpp v88, v68, v68 row_ror:4 row_mask:0xf bank_mask:0xf
    v_add_f32_dpp v89, v69, v69 row_ror:4 row_mask:0xf bank_mask:0xf
    v_add_f32_dpp v90, v70, v70 row_ror:4 row_mask:0xf bank_mask:0xf
    v_add_f32_dpp v91, v71, v71 row_ror:4 row_mask:0xf bank_mask:0xf
    s_cbranch_vccnz RS_slow1
RS_ok1:
    v_add_f32_dpp v92, v88, v88 row_ror:8 row_mask:0xf bank_mask:0xf
    v_add_f32_dpp v93, v89, v89 row_ror:8 row_mask:0xf bank_mask:0xf
    v_add_f32_dpp v94, v90, v90 row_ror:8 row_mask:0xf bank_mask:0xf
    v_add_f32_dpp v95, v91, v91 row_ror:8 row_mask:0xf bank_mask:0xf
    s_mov_b64 exec, 0x000f000f
    v_cvt_pk_bf16_f32 v72, v92, v93
    v_cvt_pk_bf16_f32 v73, v94, v95
    v_min_u32 v72, -2, v72
    buffer_store_dwordx2 v[72:73], v7, s[8:11], s88 offen sc1
    buffer_store_dwordx2 v[74:75], v7, s[8:11], s90 offen sc1
    s_mov_b64 exec, -1
    s_add_u32 s67, s67, s83
    s_mov_b32 s83, 0
    v_mov_b64 v[64:65], 0
    v_mov_b64 v[66:67], 0
    v_mov_b64 v[68:69], 0
    v_mov_b64 v[70:71], 0
    v_mov_b64 v[72:73], 0
    v_mov_b64 v[74:75], 0
    s_nop 15
    s_barrier
    s_branch RS_loop
RS_slow1:
    buffer_load_dwordx4 v[80:83], v3, s[8:11], s72 offen offset:0 sc1
    buffer_load_dwordx4 v[84:87], v3, s[8:11], s72 offen offset:1024 sc1
    s_add_u32 s83, s83, 1
    s_cmp_gt_u32 s83, 0x100000
    s_cbranch_scc1 RS_fail
    v_mov_b64 v[68:69], 0
    v_mov_b64 v[70:71], 0
    s_waitcnt vmcnt(2)
    s_nop 0
    v_smfmac_f32_16x16x64_bf16 v[68:71], v[64:67], v[32:39], v1
    v_bitop3_b32 v72, v32, v36, s65 bitop3:0x7e
    v_and_b32 v72, 1, v72
    v_cmp_ne_u32 vcc, 0, v72
    s_nop 4
    v_add_f32_dpp v88, v68, v68 row_ror:4 row_mask:0xf bank_mask:0xf
    v_add_f32_dpp v89, v69, v69 row_ror:4 row_mask:0xf bank_mask:0xf
    v_add_f32_dpp v90, v70, v70 row_ror:4 row_mask:0xf bank_mask:0xf
    v_add_f32_dpp v91, v71, v71 row_ror:4 row_mask:0xf bank_mask:0xf
    s_cbranch_vccnz RS_slow2
    s_branch RS_ok1
RS_slow2:
    buffer_load_dwordx4 v[32:35], v3, s[8:11], s72 offen offset:0 sc1
    buffer_load_dwordx4 v[36:39], v3, s[8:11], s72 offen offset:1024 sc1
    s_add_u32 s83, s83, 1
    s_cmp_gt_u32 s83, 0x100000
    s_cbranch_scc1 RS_fail
    v_mov_b64 v[68:69], 0
    v_mov_b64 v[70:71], 0
    s_waitcnt vmcnt(2)
    s_branch RS_chk1
RS_kvwait:
    buffer_load_dword v17, v3, s[8:11], s73 offen sc1
    s_add_u32 s83, s83, 1
    s_cmp_gt_u32 s83, 0x100000
    s_cbranch_scc1 RS_fail
    s_waitcnt vmcnt(0)
    v_cmp_eq_u32 vcc, 0, v17
    s_nop 1
    s_and_b32 s84, vcc_lo, 3
    s_cbranch_scc1 RS_kvwait
    s_branch RS_kvok
RS_done:
    buffer_store_dwordx4 v[20:23], v3, s[8:11], s79 offen sc1
    s_waitcnt lgkmcnt(0)
    v_smfmac_f32_16x16x64_bf16 v[64:67], v[28:31], a[0:7], v1
    v_smfmac_f32_16x16x64_bf16 v[68:71], v[28:31], a[8:15], v1
    v_smfmac_f32_16x16x64_bf16 v[72:75], v[28:31], a[112:119], v1
    v_smfmac_f32_16x16x64_bf16 v[76:79], v[28:31], a[120:127], v1
    v_smfmac_f32_16x16x64_bf16 v[64:67], v[32:35], a[16:23], v1
    v_smfmac_f32_16x16x64_bf16 v[68:71], v[32:35], a[24:31], v1
    v_smfmac_f32_16x16x64_bf16 v[72:75], v[32:35], a[128:135], v1
    v_smfmac_f32_16x16x64_bf16 v[76:79], v[32:35], a[136:143], v1
    v_smfmac_f32_16x16x64_bf16 v[64:67], v[36:39], a[32:39], v1
    v_smfmac_f32_16x16x64_bf16 v[68:71], v[36:39], a[40:47], v1
    v_smfmac_f32_16x16x64_bf16 v[72:75], v[36:39], a[144:151], v1
    v_smfmac_f32_16x16x64_bf16 v[76:79], v[36:39], a[152:159], v1
    v_smfmac_f32_16x16x64_bf16 v[64:67], v[44:47], a[64:71], v1
    v_smfmac_f32_16x16x64_bf16 v[68:71], v[44:47], a[72:79], v1
    v_smfmac_f32_16x16x64_bf16 v[72:75], v[44:47], a[176:183], v1
    v_smfmac_f32_16x16x64_bf16 v[76:79], v[44:47], a[184:191], v1
    v_smfmac_f32_16x16x64_bf16 v[64:67], v[48:51], a[80:87], v1
    v_smfmac_f32_16x16x64_bf16 v[68:71], v[48:51], a[88:95], v1
    v_smfmac_f32_16x16x64_bf16 v[72:75], v[48:51], a[192:199], v1
    v_smfmac_f32_16x16x64_bf16 v[76:79], v[48:51], a[200:207], v1
    v_smfmac_f32_16x16x64_bf16 v[64:67], v[52:55], a[96:103], v1
    v_smfmac_f32_16x16x64_bf16 v[68:71], v[52:55], a[104:111], v1
    v_smfmac_f32_16x16x64_bf16 v[72:75], v[52:55], a[208:215], v1
    v_smfmac_f32_16x16x64_bf16 v[76:79], v[52:55], a[216:223], v1
    s_nop 4
    v_pk_add_f32 v[96:97], v[64:65], v[66:67]
    v_pk_add_f32 v[98:99], v[68:69], v[70:71]
    v_pk_add_f32 v[100:101], v[72:73], v[74:75]
    v_pk_add_f32 v[102:103], v[76:77], v[78:79]
    v_cvt_pk_bf16_f32 v105, v96, v98
    v_cvt_pk_bf16_f32 v106, v97, v99
    v_cvt_pk_bf16_f32 v104, v100, v101
    v_cvt_pk_bf16_f32 v107, v102, v103
    buffer_store_dwordx4 v[104:107], v3, s[8:11], s78 offen sc1
    s_waitcnt vmcnt(0)
    v_mov_b32 v21, 64
    s_mov_b64 exec, 1
    buffer_store_dword v21, v3, s[8:11], s94 offen sc1
    s_endpgm
RS_fail:
    s_mov_b64 exec, 1
    v_mov_b32 v22, 16
    v_mov_b32 v23, s64
    v_or_b32 v23, 0x40000000, v23
    buffer_store_dword v23, v22, s[12:15], 0 offen sc1
    s_endpgm
R_dwait:
    buffer_load_dwordx4 v[20:23], v18, s[12:15], 0 offen offset:8 sc1
    s_add_u32 s83, s83, 1
    s_cmp_gt_u32 s83, 0x100000
    s_cbranch_scc1 R_fail
    s_waitcnt vmcnt(0)
    s_branch R_dchk
K_end:
.section .rodata,"a"
.p2align 6
.amdhsa_kernel recurrent_scan__memory_aug_recurrent_mem_tr__glu_gated_bilinear__prompt_kernel
  .amdhsa_next_free_vgpr 512
  .amdhsa_next_free_sgpr 102
  .amdhsa_accum_offset 256
  .amdhsa_group_segment_fixed_size 0
  .amdhsa_kernarg_size 112
  .amdhsa_user_sgpr_count 2
  .amdhsa_user_sgpr_kernarg_segment_ptr 1
  .amdhsa_system_sgpr_workgroup_id_x 1
  .amdhsa_float_denorm_mode_32 3
.end_amdhsa_kernel
```
